```python
import torch

def _softmax(x, axis=-1):
    return torch.softmax(x, dim=axis)

def _gelu(x):
    return torch.nn.functional.gelu(x, approximate='tanh')

def _silu(x):
    return torch.nn.functional.silu(x)

def _sigmoid(x):
    return torch.sigmoid(x)

def _layernorm(x, axis=-1, eps=1e-05):
    m = x.mean(dim=axis, keepdim=True)
    v = x.var(dim=axis, keepdim=True, unbiased=False)
    return (x - m) / torch.sqrt(v + eps)

def _scatter_add(tgt, idx, src, axis=0):
    return tgt.clone().index_add_(axis, idx, src)

def _segment_sum(src, seg, n):
    out = torch.zeros((n,) + src.shape[1:], dtype=src.dtype)
    return out.index_add_(0, seg, src)

def _pad(x, pw):
    flat = tuple((v for pair in reversed(pw) for v in pair))
    return torch.nn.functional.pad(x, flat)
kernel_name = 'adaLN_cond__gqa_block_cached__moe_arch_mod__prompt'

def setup_inputs():

    _w = lambda a: (lambda t: t.to(torch.bfloat16) if t.is_floating_point() else t)(torch.as_tensor(a))

    def _A_setup():
        B, Sq, D = (1, 2048, 448)
        Hq, Hkv, Sk, Dh = (16, 8, 2048, 256)
        assert Hq % Hkv == 0, (Hq, Hkv)
        return {'x': _w((lambda *s: torch.randn(*s, dtype=torch.bfloat16) * 0.1)(B, Sq, D)), 'k_cache': _w((lambda *s: torch.randn(*s, dtype=torch.bfloat16) * 0.8)(B, Hkv, Sk, Dh)), 'v_cache': _w((lambda *s: torch.randn(*s, dtype=torch.bfloat16) * 1.6)(B, Hkv, Sk, Dh)), 'wq': _w((lambda *s: torch.randn(*s, dtype=torch.bfloat16) * 0.8)(D, Hq * Dh) * D ** (-0.5)), 'wo': _w((lambda *s: torch.randn(*s, dtype=torch.bfloat16) * 1.6)(Hq * Dh, D) * (Hq * Dh) ** (-0.5))}
    _A_in = _A_setup()

    def _B_setup():
        B, S, D, F, C = (1, 2048, 448, 1792, 8)
        return {'x': _w((lambda *s: torch.randn(*s, dtype=torch.bfloat16) * 0.1)(B, S, D)), 'w_r': _w((lambda *s: torch.randn(*s, dtype=torch.bfloat16) * 0.2)(D)), 'w_gate': _w((lambda *s: torch.randn(*s, dtype=torch.bfloat16) * 0.2)(D, F)), 'w_up': _w((lambda *s: torch.randn(*s, dtype=torch.bfloat16) * 0.2)(D, F)), 'w_down': _w((lambda *s: torch.randn(*s, dtype=torch.bfloat16) * 0.2)(F, D))}
    _B_in = _B_setup()
    return {'A_x': _A_in['x'], 'A_k_cache': _A_in['k_cache'], 'A_v_cache': _A_in['v_cache'], 'A_wq': _A_in['wq'], 'A_wo': _A_in['wo'], 'B_x': _B_in['x'], 'B_w_r': _B_in['w_r'], 'B_w_gate': _B_in['w_gate'], 'B_w_up': _B_in['w_up'], 'B_w_down': _B_in['w_down'], 'c': _w((lambda *s: torch.randn(*s, dtype=torch.bfloat16) * 0.2)(1, 448) * 8.0), 'w_mod': _w((lambda *s: torch.randn(*s, dtype=torch.bfloat16) * 0.2)(448, 6 * 448) * 448 ** (-0.5) * 8.0)}

def reference(A_x, A_k_cache, A_v_cache, A_wq, A_wo, B_x, B_w_r, B_w_gate, B_w_up, B_w_down, c, w_mod):

    def _A_ref(x, k_cache, v_cache, wq, wo):
        B, Sq, D = x.shape
        Hq, Dh = (16, 256)
        Hkv = k_cache.shape[1]
        rep = Hq // Hkv
        q = (lambda x, *d: x.permute(*d))((x @ wq).reshape(B, Sq, Hq, Dh), 0, 2, 1, 3)
        k = (lambda x, n, axis: torch.repeat_interleave(x, n, dim=axis))(k_cache, rep, axis=1)
        v = (lambda x, n, axis: torch.repeat_interleave(x, n, dim=axis))(v_cache, rep, axis=1)
        scores = torch.einsum('bhqd,bhkd->bhqk', q, k) * Dh ** (-0.5)
        p = _softmax(scores, axis=-1)
        o = torch.einsum('bhqk,bhkd->bhqd', p, v)
        return (lambda x, *d: x.permute(*d))(o, 0, 2, 1, 3).reshape(B, Sq, Hq * Dh) @ wo

    def _B_ref(x, w_r, w_gate, w_up, w_down):
        B, S, D = x.shape
        C = 8
        r = x @ w_r
        idx = torch.argsort(-r, axis=-1)[:, :C]
        idx_e = (lambda x, n, axis: torch.repeat_interleave(x, n, dim=axis))(idx.reshape(B, C, 1), D, axis=2)
        x_sel = (lambda x, i, axis: torch.take_along_dim(x, i, dim=axis))(x, idx_e, axis=1)
        g = _silu(x_sel @ w_gate)
        u = x_sel @ w_up
        y = g * u @ w_down
        r_sel = _sigmoid((lambda x, i, axis: torch.take_along_dim(x, i, dim=axis))(r, idx, axis=1))
        y = y * r_sel.reshape(B, C, 1)
        b_off = (torch.arange(B) * S).reshape(B, 1)
        flat_idx = (idx + b_off).reshape(B * C)
        zero = (x * 0.0).reshape(B * S, D)
        upd = _scatter_add(zero, flat_idx, y.reshape(B * C, D), axis=0)
        return x + upd.reshape(B, S, D)
    x = A_x
    mod = (_silu(c) @ w_mod).reshape(c.shape[0], 6, 1, -1)
    sa, ca, ga, sb, cb, gb = (mod[:, 0].clone(), mod[:, 1].clone(), mod[:, 2].clone(), mod[:, 3].clone(), mod[:, 4].clone(), mod[:, 5].clone())
    h = _layernorm(x, axis=-1) * (1 + ca) + sa
    x = x + ga * _A_ref(h, A_k_cache, A_v_cache, A_wq, A_wo)
    h = _layernorm(x, axis=-1) * (1 + cb) + sb
    x = x + gb * _B_ref(h, B_w_r, B_w_gate, B_w_up, B_w_down)
    return x
```

```asm
; @launch grid=(256,1,1) block=(256,1,1) lds=163840
.amdgcn_target "amdgcn-amd-amdhsa--gfx950"
.text
.globl adaLN_cond__gqa_block_cached__moe_arch_mod__prompt_kernel
.p2align 8
.type adaLN_cond__gqa_block_cached__moe_arch_mod__prompt_kernel,@function
adaLN_cond__gqa_block_cached__moe_arch_mod__prompt_kernel:
    s_cmp_ge_u32 s2, 256
    s_cbranch_scc1 L_end_k1
    s_load_dwordx2 s[40:41], s[0:1], 0
    s_load_dwordx4 s[4:7], s[0:1], 8
    s_load_dwordx4 s[44:47], s[0:1], 24
    s_load_dwordx4 s[64:67], s[0:1], 80
    s_load_dwordx4 s[88:91], s[0:1], 104
    s_load_dwordx4 s[96:99], s[0:1], 56
    s_load_dwordx2 s[100:101], s[0:1], 72
    v_lshrrev_b32 v1, 6, v0
    v_and_b32 v252, 63, v0
    s_nop 0
    v_readfirstlane_b32 s34, v1
    s_and_b32 s36, s2, 7
    s_lshr_b32 s37, s2, 3
    s_lshr_b32 s38, s34, 1
    s_and_b32 s39, s34, 1
    v_and_b32 v200, 15, v252
    v_lshrrev_b32 v201, 4, v252
    s_lshl_b32 s60, s34, 4
    v_add_u32 v202, s60, v200
    v_mul_u32_u24 v202, 896, v202
    v_lshl_add_u32 v202, v201, 4, v202
    s_mul_i32 s60, s37, 57344
    s_waitcnt lgkmcnt(0)
    s_mov_b32 s24, s90
    s_mov_b32 s25, s91
    s_mov_b32 s26, 0x10000000
    s_mov_b32 s27, 0x20000
    s_mov_b32 s90, 256
    s_mov_b32 s91, 0x20000
    s_add_u32 s40, s40, s60
    s_addc_u32 s41, s41, 0
    s_mov_b32 s42, 57344
    s_mov_b32 s43, 0x20000
    s_cmp_ge_u32 s2, 168
    s_cbranch_scc1 L_noprod_a
    s_mov_b32 s68, s64
    s_mov_b32 s69, s65
    s_mov_b32 s70, 896
    s_mov_b32 s71, 0x20000
    s_mov_b32 s64, s66
    s_mov_b32 s65, s67
    s_mov_b32 s66, 2408448
    s_mov_b32 s67, 0x20000
    s_cmp_ge_u32 s2, 56
    s_cbranch_scc1 L_prod_late
    s_mul_i32 s57, s2, 74
    s_lshr_b32 s57, s57, 10
    s_mul_i32 s58, s57, 14
    s_sub_u32 s58, s2, s58
    s_mul_i32 s56, s57, 3584
    s_lshl_b32 s59, s58, 8
    s_add_u32 s56, s56, s59
    s_add_u32 s56, s56, 196608
    s_branch L_prod_map
L_prod_late:
    s_sub_u32 s59, s2, 56
    s_mul_i32 s57, s59, 147
    s_lshr_b32 s57, s57, 12
    s_mul_i32 s58, s57, 28
    s_sub_u32 s58, s59, s58
    s_mul_i32 s56, s57, 7168
    s_lshl_b32 s59, s58, 8
    s_add_u32 s56, s56, s59
    s_add_u32 s56, s56, 229376
    s_add_u32 s58, s58, 14
L_prod_map:
    s_mul_i32 s62, s57, 112
    s_mul_i32 s63, s34, 28
    s_add_u32 s62, s62, s63
    v_and_b32 v206, 7, v252
    v_lshrrev_b32 v207, 3, v252
    v_add_u32 v209, s62, v207
    v_mul_u32_u24 v208, 5376, v209
    v_lshl_add_u32 v208, v206, 4, v208
    s_lshl_b32 s63, s58, 7
    v_add_u32 v208, s63, v208
    v_lshlrev_b32 v209, 1, v209
    v_mov_b32 v210, 0x40000000
    v_cmp_gt_u32 vcc, 4, v207
    s_nop 1
    v_cndmask_b32 v211, v210, v209, vcc
    v_cndmask_b32 v212, v210, v208, vcc
    s_mov_b32 s63, 43008
    buffer_load_ushort v60, v209, s[68:71], 0 offen offset:0
    buffer_load_ushort v61, v209, s[68:71], 0 offen offset:16
    buffer_load_ushort v62, v209, s[68:71], 0 offen offset:32
    buffer_load_ushort v63, v211, s[68:71], 0 offen offset:48
    buffer_load_dwordx4 v[76:79], v208, s[64:67], 0 offen
    v_add_u32 v208, s63, v208
    v_add_u32 v212, s63, v212
    buffer_load_dwordx4 v[80:83], v208, s[64:67], 0 offen
    v_add_u32 v208, s63, v208
    v_add_u32 v212, s63, v212
    buffer_load_dwordx4 v[84:87], v208, s[64:67], 0 offen
    v_add_u32 v208, s63, v208
    v_add_u32 v212, s63, v212
    buffer_load_dwordx4 v[88:91], v212, s[64:67], 0 offen
    buffer_load_dwordx4 v[0:3], v202, s[40:43], 0 offen offset:0
    buffer_load_dwordx4 v[4:7], v202, s[40:43], 0 offen offset:64
    buffer_load_dwordx4 v[8:11], v202, s[40:43], 0 offen offset:128
    buffer_load_dwordx4 v[12:15], v202, s[40:43], 0 offen offset:192
    buffer_load_dwordx4 v[16:19], v202, s[40:43], 0 offen offset:256
    buffer_load_dwordx4 v[20:23], v202, s[40:43], 0 offen offset:320
    buffer_load_dwordx4 v[24:27], v202, s[40:43], 0 offen offset:384
    buffer_load_dwordx4 v[28:31], v202, s[40:43], 0 offen offset:448
    buffer_load_dwordx4 v[32:35], v202, s[40:43], 0 offen offset:512
    buffer_load_dwordx4 v[36:39], v202, s[40:43], 0 offen offset:576
    buffer_load_dwordx4 v[40:43], v202, s[40:43], 0 offen offset:640
    buffer_load_dwordx4 v[44:47], v202, s[40:43], 0 offen offset:704
    buffer_load_dwordx4 v[48:51], v202, s[40:43], 0 offen offset:768
    buffer_load_dwordx4 v[52:55], v202, s[40:43], 0 offen offset:832
    s_waitcnt vmcnt(18)
    v_lshlrev_b32 v168, 16, v60
    v_lshlrev_b32 v169, 16, v61
    v_lshlrev_b32 v170, 16, v62
    v_lshlrev_b32 v171, 16, v63
    v_mul_f32 v132, 0xbfb8aa3b, v168
    v_mul_f32 v133, 0xbfb8aa3b, v169
    v_mul_f32 v134, 0xbfb8aa3b, v170
    v_mul_f32 v135, 0xbfb8aa3b, v171
    v_exp_f32 v132, v132
    v_exp_f32 v133, v133
    v_exp_f32 v134, v134
    v_exp_f32 v135, v135
    s_nop 0
    v_add_f32 v132, 1.0, v132
    v_add_f32 v133, 1.0, v133
    v_add_f32 v134, 1.0, v134
    v_add_f32 v135, 1.0, v135
    v_rcp_f32 v132, v132
    v_rcp_f32 v133, v133
    v_rcp_f32 v134, v134
    v_rcp_f32 v135, v135
    s_nop 0
    v_mul_f32 v168, v168, v132
    v_mul_f32 v169, v169, v133
    v_mul_f32 v170, v170, v134
    v_mul_f32 v171, v171, v135
    v_cvt_pk_bf16_f32 v168, v168, 0
    v_cvt_pk_bf16_f32 v169, v169, 0
    v_cvt_pk_bf16_f32 v170, v170, 0
    v_cvt_pk_bf16_f32 v171, v171, 0
    v_lshlrev_b32 v132, 16, v168
    v_lshlrev_b32 v133, 16, v169
    v_lshlrev_b32 v134, 16, v170
    v_lshlrev_b32 v135, 16, v171
    v_mov_b32 v148, 0
    v_mov_b32 v149, 0
    v_mov_b32 v150, 0
    v_mov_b32 v151, 0
    v_mov_b32 v152, 0
    v_mov_b32 v153, 0
    v_mov_b32 v154, 0
    v_mov_b32 v155, 0
    s_waitcnt vmcnt(14)
    v_dot2_f32_bf16 v148, v76, v168, v148
    v_dot2_f32_bf16 v149, v76, v132, v149
    v_dot2_f32_bf16 v150, v77, v168, v150
    v_dot2_f32_bf16 v151, v77, v132, v151
    v_dot2_f32_bf16 v152, v78, v168, v152
    v_dot2_f32_bf16 v153, v78, v132, v153
    v_dot2_f32_bf16 v154, v79, v168, v154
    v_dot2_f32_bf16 v155, v79, v132, v155
    v_dot2_f32_bf16 v148, v80, v169, v148
    v_dot2_f32_bf16 v149, v80, v133, v149
    v_dot2_f32_bf16 v150, v81, v169, v150
    v_dot2_f32_bf16 v151, v81, v133, v151
    v_dot2_f32_bf16 v152, v82, v169, v152
    v_dot2_f32_bf16 v153, v82, v133, v153
    v_dot2_f32_bf16 v154, v83, v169, v154
    v_dot2_f32_bf16 v155, v83, v133, v155
    v_dot2_f32_bf16 v148, v84, v170, v148
    v_dot2_f32_bf16 v149, v84, v134, v149
    v_dot2_f32_bf16 v150, v85, v170, v150
    v_dot2_f32_bf16 v151, v85, v134, v151
    v_dot2_f32_bf16 v152, v86, v170, v152
    v_dot2_f32_bf16 v153, v86, v134, v153
    v_dot2_f32_bf16 v154, v87, v170, v154
    v_dot2_f32_bf16 v155, v87, v134, v155
    v_dot2_f32_bf16 v148, v88, v171, v148
    v_dot2_f32_bf16 v149, v88, v135, v149
    v_dot2_f32_bf16 v150, v89, v171, v150
    v_dot2_f32_bf16 v151, v89, v135, v151
    v_dot2_f32_bf16 v152, v90, v171, v152
    v_dot2_f32_bf16 v153, v90, v135, v153
    v_dot2_f32_bf16 v154, v91, v171, v154
    v_dot2_f32_bf16 v155, v91, v135, v155
    s_nop 2
    v_add_f32_dpp v148, v148, v148 row_ror:8 row_mask:0xf bank_mask:0xf
    v_add_f32_dpp v149, v149, v149 row_ror:8 row_mask:0xf bank_mask:0xf
    v_add_f32_dpp v150, v150, v150 row_ror:8 row_mask:0xf bank_mask:0xf
    v_add_f32_dpp v151, v151, v151 row_ror:8 row_mask:0xf bank_mask:0xf
    v_add_f32_dpp v152, v152, v152 row_ror:8 row_mask:0xf bank_mask:0xf
    v_add_f32_dpp v153, v153, v153 row_ror:8 row_mask:0xf bank_mask:0xf
    v_add_f32_dpp v154, v154, v154 row_ror:8 row_mask:0xf bank_mask:0xf
    v_add_f32_dpp v155, v155, v155 row_ror:8 row_mask:0xf bank_mask:0xf
    v_mov_b32 v156, v148
    v_mov_b32 v157, v149
    v_mov_b32 v158, v150
    v_mov_b32 v159, v151
    v_mov_b32 v160, v152
    v_mov_b32 v161, v153
    v_mov_b32 v162, v154
    v_mov_b32 v163, v155
    s_nop 1
    v_permlane16_swap_b32 v148, v156
    v_permlane16_swap_b32 v149, v157
    v_permlane16_swap_b32 v150, v158
    v_permlane16_swap_b32 v151, v159
    v_permlane16_swap_b32 v152, v160
    v_permlane16_swap_b32 v153, v161
    v_permlane16_swap_b32 v154, v162
    v_permlane16_swap_b32 v155, v163
    s_nop 1
    v_add_f32 v148, v148, v156
    v_add_f32 v149, v149, v157
    v_add_f32 v150, v150, v158
    v_add_f32 v151, v151, v159
    v_add_f32 v152, v152, v160
    v_add_f32 v153, v153, v161
    v_add_f32 v154, v154, v162
    v_add_f32 v155, v155, v163
    v_mov_b32 v156, v148
    v_mov_b32 v157, v149
    v_mov_b32 v158, v150
    v_mov_b32 v159, v151
    v_mov_b32 v160, v152
    v_mov_b32 v161, v153
    v_mov_b32 v162, v154
    v_mov_b32 v163, v155
    s_nop 1
    v_permlane32_swap_b32 v148, v156
    v_permlane32_swap_b32 v149, v157
    v_permlane32_swap_b32 v150, v158
    v_permlane32_swap_b32 v151, v159
    v_permlane32_swap_b32 v152, v160
    v_permlane32_swap_b32 v153, v161
    v_permlane32_swap_b32 v154, v162
    v_permlane32_swap_b32 v155, v163
    s_nop 1
    v_add_f32 v148, v148, v156
    v_add_f32 v149, v149, v157
    v_add_f32 v150, v150, v158
    v_add_f32 v151, v151, v159
    v_add_f32 v152, v152, v160
    v_add_f32 v153, v153, v161
    v_add_f32 v154, v154, v162
    v_add_f32 v155, v155, v163
    v_and_b32 v164, 7, v252
    s_lshl_b32 s60, s34, 8
    v_lshlrev_b32 v164, 5, v164
    v_add_u32 v164, s60, v164
    ds_write_b128 v164, v[148:151] offset:61440
    ds_write_b128 v164, v[152:155] offset:61456
    s_waitcnt lgkmcnt(0)
    s_barrier
    s_cmp_lg_u32 s34, 0
    s_cbranch_scc1 L_prod_done_u
    v_lshlrev_b32 v164, 2, v252
    ds_read_b32 v165, v164 offset:61440
    ds_read_b32 v166, v164 offset:61696
    ds_read_b32 v167, v164 offset:61952
    ds_read_b32 v168, v164 offset:62208
    s_waitcnt lgkmcnt(0)
    v_add_f32 v165, v165, v166
    v_add_f32 v167, v167, v168
    v_add_f32 v165, v165, v167
    v_add_u32 v164, s56, v164
    buffer_store_dword v165, v164, s[24:27], 0 offen sc1
    s_cmp_ge_u32 s2, 56
    s_cbranch_scc1 L_prod_done_u
    s_cmp_lg_u32 s2, 0
    s_cbranch_scc1 L_nozero
    v_lshlrev_b32 v166, 7, v252
    v_add_u32 v166, 131072, v166
    v_mov_b32 v167, 0x40000000
    v_cmp_gt_u32 vcc, 40, v252
    s_nop 1
    v_cndmask_b32 v166, v167, v166, vcc
    v_mov_b32 v167, 0
    buffer_store_dword v167, v166, s[24:27], 0 offen sc1
L_nozero:
    v_mov_b32 v156, -1
    v_mov_b32 v157, -1
    v_mov_b32 v158, -1
    v_mov_b32 v159, -1
    v_lshlrev_b32 v166, 4, v252
    s_lshl_b32 s60, s2, 9
    s_add_u32 s60, s60, 65536
    v_add_u32 v160, s60, v166
    v_mov_b32 v167, 0x40000000
    v_cmp_gt_u32 vcc, 32, v252
    s_lshl_b32 s60, s2, 8
    s_add_u32 s60, s60, 16384
    v_cndmask_b32 v160, v167, v160, vcc
    v_add_u32 v161, s60, v166
    v_cmp_gt_u32 vcc, 16, v252
    buffer_store_dwordx4 v[156:159], v160, s[24:27], 0 offen sc1
    s_cmp_ge_u32 s2, 32
    s_cbranch_scc1 L_nokeyfill
    v_cndmask_b32 v161, v167, v161, vcc
    buffer_store_dwordx4 v[156:159], v161, s[24:27], 0 offen sc1
L_nokeyfill:
    s_waitcnt vmcnt(0)
    v_mov_b32 v165, 1
    v_mov_b32 v164, 0
    v_cmp_eq_u32 vcc, 0, v252
    s_and_saveexec_b64 s[62:63], vcc
    buffer_atomic_add v165, v164, s[88:91], 0 offen sc0 sc1
    s_waitcnt vmcnt(0)
    v_readfirstlane_b32 s60, v165
    s_cmp_eq_u32 s60, 55
    s_cbranch_scc0 L_prod_notlast
    v_mov_b32 v165, 1
    buffer_store_dword v165, v164, s[88:91], 0 offen offset:128 sc1
L_prod_notlast:
    s_mov_b64 exec, s[62:63]
L_prod_done_u:
    s_branch L_noprod_b
L_noprod_a:
    buffer_load_dwordx4 v[0:3], v202, s[40:43], 0 offen offset:0
    buffer_load_dwordx4 v[4:7], v202, s[40:43], 0 offen offset:64
    buffer_load_dwordx4 v[8:11], v202, s[40:43], 0 offen offset:128
    buffer_load_dwordx4 v[12:15], v202, s[40:43], 0 offen offset:192
    buffer_load_dwordx4 v[16:19], v202, s[40:43], 0 offen offset:256
    buffer_load_dwordx4 v[20:23], v202, s[40:43], 0 offen offset:320
    buffer_load_dwordx4 v[24:27], v202, s[40:43], 0 offen offset:384
    buffer_load_dwordx4 v[28:31], v202, s[40:43], 0 offen offset:448
    buffer_load_dwordx4 v[32:35], v202, s[40:43], 0 offen offset:512
    buffer_load_dwordx4 v[36:39], v202, s[40:43], 0 offen offset:576
    buffer_load_dwordx4 v[40:43], v202, s[40:43], 0 offen offset:640
    buffer_load_dwordx4 v[44:47], v202, s[40:43], 0 offen offset:704
    buffer_load_dwordx4 v[48:51], v202, s[40:43], 0 offen offset:768
    buffer_load_dwordx4 v[52:55], v202, s[40:43], 0 offen offset:832
L_noprod_b:
    s_mov_b32 s48, s46
    s_mov_b32 s49, s47
    s_mul_i32 s60, s36, 458752
    s_add_u32 s48, s48, s60
    s_addc_u32 s49, s49, 0
    s_mov_b32 s50, 458752
    s_mov_b32 s51, 0x20000
    s_lshl_b32 s60, s36, 10
    s_add_u32 s44, s44, s60
    s_addc_u32 s45, s45, 0
    s_sub_u32 s46, 3670016, s60
    s_mov_b32 s47, 0x20000
    s_lshl_b32 s60, s36, 20
    s_cmp_lt_u32 s37, 16
    s_cselect_b32 s92, s4, s6
    s_cselect_b32 s93, s5, s7
    s_add_u32 s92, s92, s60
    s_addc_u32 s93, s93, 0
    s_mov_b32 s94, 0x100000
    s_mov_b32 s95, 0x20000
    s_and_b32 s60, s37, 15
    s_lshl_b32 s60, s60, 4
    s_lshl_b32 s61, s34, 2
    s_add_u32 s60, s60, s61
    v_and_b32 v206, 3, v252
    v_add_u32 v206, s60, v206
    v_lshlrev_b32 v206, 7, v206
    v_lshrrev_b32 v207, 2, v252
    v_lshl_add_u32 v207, v207, 15, v206
    v_mov_b32 v208, 0x40000000
    v_cmp_gt_u32 vcc, 12, v252
    s_nop 1
    v_cndmask_b32 v207, v208, v207, vcc
    v_cmp_gt_u32 vcc, 4, v252
    v_add_u32 v206, 98304, v206
    s_nop 0
    v_cndmask_b32 v227, v208, v206, vcc
    s_mul_i32 s60, s37, 112
    s_mul_i32 s61, s34, 28
    s_add_u32 s60, s60, s61
    v_add_u32 v206, s60, v252
    v_lshrrev_b32 v209, 3, v206
    v_lshlrev_b32 v209, 13, v209
    v_and_b32 v210, 7, v206
    v_lshl_add_u32 v209, v210, 7, v209
    v_lshlrev_b32 v206, 7, v206
    v_cmp_gt_u32 vcc, 28, v252
    s_nop 1
    v_cndmask_b32 v209, v208, v209, vcc
    v_cndmask_b32 v242, v208, v206, vcc
    v_mov_b32 v240, v209
    v_mov_b32 v241, v207
    s_mul_i32 s60, s2, 49
    s_mul_i32 s61, s34, 13
    s_add_u32 s60, s60, s61
    v_add_u32 v206, s60, v252
    v_min_u32 v206, 12543, v206
    v_lshlrev_b32 v243, 7, v206
    v_lshlrev_b32 v206, 1, v201
    v_xor_b32 v206, v206, v200
    v_lshlrev_b32 v206, 4, v206
    v_lshl_add_u32 v206, v201, 13, v206
    s_lshl_b32 s60, s34, 8
    v_add_u32 v204, s60, v206
    v_xor_b32 v205, 0x80, v204
    s_lshl_b32 s32, s34, 13
    s_mov_b32 s52, 0
    s_mov_b32 s53, 31744
    s_mov_b32 s54, 63488
    s_mov_b32 s55, 95232
    s_mov_b32 s56, 131072
    s_mov_b32 s57, 162816
    s_mov_b32 s58, 194560
    s_mov_b32 s59, 226304
    s_lshl_b32 s60, s36, 20
    s_add_u32 s8, s4, s60
    s_addc_u32 s9, s5, 0
    s_sub_u32 s8, s8, 96
    s_subb_u32 s9, s9, 0
    s_mov_b32 s10, 1048672
    s_mov_b32 s11, 0x20000
    s_add_u32 s12, s8, 4096
    s_addc_u32 s13, s9, 0
    s_mov_b32 s14, 1044576
    s_mov_b32 s15, 0x20000
    s_add_u32 s16, s6, s60
    s_addc_u32 s17, s7, 0
    s_sub_u32 s16, s16, 96
    s_subb_u32 s17, s17, 0
    s_mov_b32 s18, 1048672
    s_mov_b32 s19, 0x20000
    s_add_u32 s20, s16, 4096
    s_addc_u32 s21, s17, 0
    s_mov_b32 s22, 1044576
    s_mov_b32 s23, 0x20000
    s_mov_b32 s35, 96
    s_mul_i32 s61, s38, 16896
    s_mul_i32 s62, s39, 8448
    s_add_u32 s28, s61, s62
    s_mov_b32 s29, 0x53800000
    v_mov_b32 v210, 0x3f803f80
    v_mov_b32 v211, 0x00003f80
    v_mov_b32 v212, 0x3f800000
    v_mov_b32 v214, 0
    v_mov_b32 v215, 0
    v_mov_b32 v216, 0
    v_mov_b32 v217, 0
    s_waitcnt vmcnt(0)
    buffer_load_dword v253, v240, s[44:47], 0 offen
    v_dot2_f32_bf16 v214, v0, v210, v214
    v_dot2_f32_bf16 v215, v1, v210, v215
    v_dot2_f32_bf16 v216, v2, v210, v216
    v_dot2_f32_bf16 v217, v3, v210, v217
    v_dot2_f32_bf16 v214, v4, v210, v214
    v_dot2_f32_bf16 v215, v5, v210, v215
    s_add_u32 m0, s32, 98304
    s_nop 0
    buffer_load_dwordx4 v204, s[44:47], s52 offen offset:0 lds
    v_dot2_f32_bf16 v216, v6, v210, v216
    v_dot2_f32_bf16 v217, v7, v210, v217
    v_dot2_f32_bf16 v214, v8, v210, v214
    v_dot2_f32_bf16 v215, v9, v210, v215
    v_dot2_f32_bf16 v216, v10, v210, v216
    v_dot2_f32_bf16 v217, v11, v210, v217
    buffer_load_dwordx4 v204, s[44:47], s53 offen offset:1024 lds
    v_dot2_f32_bf16 v214, v12, v210, v214
    v_dot2_f32_bf16 v215, v13, v210, v215
    v_dot2_f32_bf16 v216, v14, v210, v216
    v_dot2_f32_bf16 v217, v15, v210, v217
    v_dot2_f32_bf16 v214, v16, v210, v214
    v_dot2_f32_bf16 v215, v17, v210, v215
    buffer_load_dwordx4 v205, s[44:47], s54 offen offset:2048 lds
    v_dot2_f32_bf16 v216, v18, v210, v216
    v_dot2_f32_bf16 v217, v19, v210, v217
    v_dot2_f32_bf16 v214, v20, v210, v214
    v_dot2_f32_bf16 v215, v21, v210, v215
    v_dot2_f32_bf16 v216, v22, v210, v216
    v_dot2_f32_bf16 v217, v23, v210, v217
    buffer_load_dwordx4 v205, s[44:47], s55 offen offset:3072 lds
    v_dot2_f32_bf16 v214, v24, v210, v214
    v_dot2_f32_bf16 v215, v25, v210, v215
    v_dot2_f32_bf16 v216, v26, v210, v216
    v_dot2_f32_bf16 v217, v27, v210, v217
    v_dot2_f32_bf16 v214, v28, v210, v214
    v_dot2_f32_bf16 v215, v29, v210, v215
    s_add_u32 m0, s32, 102400
    s_nop 0
    buffer_load_dwordx4 v204, s[44:47], s56 offen offset:0 lds
    v_dot2_f32_bf16 v216, v30, v210, v216
    v_dot2_f32_bf16 v217, v31, v210, v217
    v_dot2_f32_bf16 v214, v32, v210, v214
    v_dot2_f32_bf16 v215, v33, v210, v215
    v_dot2_f32_bf16 v216, v34, v210, v216
    v_dot2_f32_bf16 v217, v35, v210, v217
    buffer_load_dwordx4 v204, s[44:47], s57 offen offset:1024 lds
    v_dot2_f32_bf16 v214, v36, v210, v214
    v_dot2_f32_bf16 v215, v37, v210, v215
    v_dot2_f32_bf16 v216, v38, v210, v216
    v_dot2_f32_bf16 v217, v39, v210, v217
    v_dot2_f32_bf16 v214, v40, v210, v214
    v_dot2_f32_bf16 v215, v41, v210, v215
    buffer_load_dwordx4 v205, s[44:47], s58 offen offset:2048 lds
    v_dot2_f32_bf16 v216, v42, v210, v216
    v_dot2_f32_bf16 v217, v43, v210, v217
    v_dot2_f32_bf16 v214, v44, v210, v214
    v_dot2_f32_bf16 v215, v45, v210, v215
    v_dot2_f32_bf16 v216, v46, v210, v216
    v_dot2_f32_bf16 v217, v47, v210, v217
    buffer_load_dwordx4 v205, s[44:47], s59 offen offset:3072 lds
    v_dot2_f32_bf16 v214, v48, v210, v214
    v_dot2_f32_bf16 v215, v49, v210, v215
    v_dot2_f32_bf16 v216, v50, v210, v216
    v_dot2_f32_bf16 v217, v51, v210, v217
    v_dot2_f32_bf16 v214, v52, v210, v214
    v_dot2_f32_bf16 v215, v53, v210, v215
    v_add_u32 v204, 0x40000, v204
    v_add_u32 v205, 0x40000, v205
    s_add_u32 m0, s32, 131072
    s_nop 0
    buffer_load_dwordx4 v204, s[44:47], s52 offen offset:0 lds
    v_dot2_f32_bf16 v216, v54, v210, v216
    v_dot2_f32_bf16 v217, v55, v210, v217
    s_nop 2
    v_add_f32 v214, v214, v215
    v_add_f32 v216, v216, v217
    v_add_f32 v214, v214, v216
    v_mov_b32 v215, v214
    s_nop 1
    v_permlane16_swap_b32 v214, v215
    s_nop 1
    v_add_f32 v214, v214, v215
    v_mov_b32 v215, v214
    s_nop 1
    v_permlane32_swap_b32 v214, v215
    s_nop 1
    v_add_f32 v214, v214, v215
    v_mul_f32 v214, 0xbb124925, v214
    v_dot2_f32_bf16 v56, v0, v211, v214
    v_dot2_f32_bf16 v57, v0, v212, v214
    v_dot2_f32_bf16 v58, v1, v211, v214
    buffer_load_dwordx4 v204, s[44:47], s53 offen offset:1024 lds
    v_dot2_f32_bf16 v59, v1, v212, v214
    v_dot2_f32_bf16 v60, v2, v211, v214
    v_dot2_f32_bf16 v61, v2, v212, v214
    v_dot2_f32_bf16 v62, v3, v211, v214
    v_dot2_f32_bf16 v63, v3, v212, v214
    v_dot2_f32_bf16 v64, v4, v211, v214
    buffer_load_dwordx4 v205, s[44:47], s54 offen offset:2048 lds
    v_dot2_f32_bf16 v65, v4, v212, v214
    v_dot2_f32_bf16 v66, v5, v211, v214
    v_dot2_f32_bf16 v67, v5, v212, v214
    v_dot2_f32_bf16 v68, v6, v211, v214
    v_dot2_f32_bf16 v69, v6, v212, v214
    v_dot2_f32_bf16 v70, v7, v211, v214
    buffer_load_dwordx4 v205, s[44:47], s55 offen offset:3072 lds
    v_dot2_f32_bf16 v71, v7, v212, v214
    v_dot2_f32_bf16 v72, v8, v211, v214
    v_dot2_f32_bf16 v73, v8, v212, v214
    v_dot2_f32_bf16 v74, v9, v211, v214
    v_dot2_f32_bf16 v75, v9, v212, v214
    v_dot2_f32_bf16 v76, v10, v211, v214
    s_add_u32 m0, s32, 135168
    s_nop 0
    buffer_load_dwordx4 v204, s[44:47], s56 offen offset:0 lds
    v_dot2_f32_bf16 v77, v10, v212, v214
    v_dot2_f32_bf16 v78, v11, v211, v214
    v_dot2_f32_bf16 v79, v11, v212, v214
    v_dot2_f32_bf16 v80, v12, v211, v214
    v_dot2_f32_bf16 v81, v12, v212, v214
    v_dot2_f32_bf16 v82, v13, v211, v214
    buffer_load_dwordx4 v204, s[44:47], s57 offen offset:1024 lds
    v_dot2_f32_bf16 v83, v13, v212, v214
    v_dot2_f32_bf16 v84, v14, v211, v214
    v_dot2_f32_bf16 v85, v14, v212, v214
    v_dot2_f32_bf16 v86, v15, v211, v214
    v_dot2_f32_bf16 v87, v15, v212, v214
    v_dot2_f32_bf16 v88, v16, v211, v214
    buffer_load_dwordx4 v205, s[44:47], s58 offen offset:2048 lds
    v_dot2_f32_bf16 v89, v16, v212, v214
    v_dot2_f32_bf16 v90, v17, v211, v214
    v_dot2_f32_bf16 v91, v17, v212, v214
    v_dot2_f32_bf16 v92, v18, v211, v214
    v_dot2_f32_bf16 v93, v18, v212, v214
    v_dot2_f32_bf16 v94, v19, v211, v214
    buffer_load_dwordx4 v205, s[44:47], s59 offen offset:3072 lds
    v_dot2_f32_bf16 v95, v19, v212, v214
    v_dot2_f32_bf16 v96, v20, v211, v214
    v_dot2_f32_bf16 v97, v20, v212, v214
    v_dot2_f32_bf16 v98, v21, v211, v214
    v_dot2_f32_bf16 v99, v21, v212, v214
    v_dot2_f32_bf16 v100, v22, v211, v214
    v_add_u32 v204, 0x40000, v204
    v_add_u32 v205, 0x40000, v205
    s_add_u32 m0, s32, 65536
    s_nop 0
    buffer_load_dwordx4 v204, s[44:47], s52 offen offset:0 lds
    v_dot2_f32_bf16 v101, v22, v212, v214
    v_dot2_f32_bf16 v102, v23, v211, v214
    v_dot2_f32_bf16 v103, v23, v212, v214
    v_dot2_f32_bf16 v104, v24, v211, v214
    v_dot2_f32_bf16 v105, v24, v212, v214
    v_dot2_f32_bf16 v106, v25, v211, v214
    buffer_load_dwordx4 v204, s[44:47], s53 offen offset:1024 lds
    v_dot2_f32_bf16 v107, v25, v212, v214
    v_dot2_f32_bf16 v108, v26, v211, v214
    v_dot2_f32_bf16 v109, v26, v212, v214
    v_dot2_f32_bf16 v110, v27, v211, v214
    v_dot2_f32_bf16 v111, v27, v212, v214
    v_dot2_f32_bf16 v112, v28, v211, v214
    buffer_load_dwordx4 v205, s[44:47], s54 offen offset:2048 lds
    v_dot2_f32_bf16 v113, v28, v212, v214
    v_dot2_f32_bf16 v114, v29, v211, v214
    v_dot2_f32_bf16 v115, v29, v212, v214
    v_dot2_f32_bf16 v116, v30, v211, v214
    v_dot2_f32_bf16 v117, v30, v212, v214
    v_dot2_f32_bf16 v118, v31, v211, v214
    buffer_load_dwordx4 v205, s[44:47], s55 offen offset:3072 lds
    v_dot2_f32_bf16 v119, v31, v212, v214
    v_dot2_f32_bf16 v120, v32, v211, v214
    v_dot2_f32_bf16 v121, v32, v212, v214
    v_dot2_f32_bf16 v122, v33, v211, v214
    v_dot2_f32_bf16 v123, v33, v212, v214
    v_dot2_f32_bf16 v124, v34, v211, v214
    s_add_u32 m0, s32, 69632
    s_nop 0
    buffer_load_dwordx4 v204, s[44:47], s56 offen offset:0 lds
    v_dot2_f32_bf16 v125, v34, v212, v214
    v_dot2_f32_bf16 v126, v35, v211, v214
    v_dot2_f32_bf16 v127, v35, v212, v214
    v_dot2_f32_bf16 v128, v36, v211, v214
    v_dot2_f32_bf16 v129, v36, v212, v214
    v_dot2_f32_bf16 v130, v37, v211, v214
    buffer_load_dwordx4 v204, s[44:47], s57 offen offset:1024 lds
    v_dot2_f32_bf16 v131, v37, v212, v214
    v_dot2_f32_bf16 v132, v38, v211, v214
    v_dot2_f32_bf16 v133, v38, v212, v214
    v_dot2_f32_bf16 v134, v39, v211, v214
    v_dot2_f32_bf16 v135, v39, v212, v214
    v_dot2_f32_bf16 v136, v40, v211, v214
    buffer_load_dwordx4 v205, s[44:47], s58 offen offset:2048 lds
    v_dot2_f32_bf16 v137, v40, v212, v214
    v_dot2_f32_bf16 v138, v41, v211, v214
    v_dot2_f32_bf16 v139, v41, v212, v214
    v_dot2_f32_bf16 v140, v42, v211, v214
    v_dot2_f32_bf16 v141, v42, v212, v214
    v_dot2_f32_bf16 v142, v43, v211, v214
    buffer_load_dwordx4 v205, s[44:47], s59 offen offset:3072 lds
    v_dot2_f32_bf16 v143, v43, v212, v214
    v_dot2_f32_bf16 v144, v44, v211, v214
    v_dot2_f32_bf16 v145, v44, v212, v214
    v_dot2_f32_bf16 v146, v45, v211, v214
    v_dot2_f32_bf16 v147, v45, v212, v214
    v_dot2_f32_bf16 v148, v46, v211, v214
    v_add_u32 v204, 0x40000, v204
    v_add_u32 v205, 0x40000, v205
    v_dot2_f32_bf16 v149, v46, v212, v214
    v_dot2_f32_bf16 v150, v47, v211, v214
    v_dot2_f32_bf16 v151, v47, v212, v214
    v_dot2_f32_bf16 v152, v48, v211, v214
    v_dot2_f32_bf16 v153, v48, v212, v214
    v_dot2_f32_bf16 v154, v49, v211, v214
    v_dot2_f32_bf16 v155, v49, v212, v214
    v_dot2_f32_bf16 v156, v50, v211, v214
    v_dot2_f32_bf16 v157, v50, v212, v214
    v_dot2_f32_bf16 v158, v51, v211, v214
    v_dot2_f32_bf16 v159, v51, v212, v214
    v_dot2_f32_bf16 v160, v52, v211, v214
    v_dot2_f32_bf16 v161, v52, v212, v214
    v_dot2_f32_bf16 v162, v53, v211, v214
    v_dot2_f32_bf16 v163, v53, v212, v214
    v_dot2_f32_bf16 v164, v54, v211, v214
    v_dot2_f32_bf16 v165, v54, v212, v214
    v_dot2_f32_bf16 v166, v55, v211, v214
    v_dot2_f32_bf16 v167, v55, v212, v214
    v_mov_b32 v216, 0
    v_mov_b32 v217, 0
    v_mov_b32 v218, 0
    v_mov_b32 v219, 0
    v_pk_fma_f32 v[216:217], v[56:57], v[56:57], v[216:217]
    v_pk_fma_f32 v[218:219], v[58:59], v[58:59], v[218:219]
    v_pk_fma_f32 v[216:217], v[60:61], v[60:61], v[216:217]
    v_pk_fma_f32 v[218:219], v[62:63], v[62:63], v[218:219]
    v_pk_fma_f32 v[216:217], v[64:65], v[64:65], v[216:217]
    v_pk_fma_f32 v[218:219], v[66:67], v[66:67], v[218:219]
    v_pk_fma_f32 v[216:217], v[68:69], v[68:69], v[216:217]
    v_pk_fma_f32 v[218:219], v[70:71], v[70:71], v[218:219]
    v_pk_fma_f32 v[216:217], v[72:73], v[72:73], v[216:217]
    v_pk_fma_f32 v[218:219], v[74:75], v[74:75], v[218:219]
    v_pk_fma_f32 v[216:217], v[76:77], v[76:77], v[216:217]
    v_pk_fma_f32 v[218:219], v[78:79], v[78:79], v[218:219]
    v_pk_fma_f32 v[216:217], v[80:81], v[80:81], v[216:217]
    v_pk_fma_f32 v[218:219], v[82:83], v[82:83], v[218:219]
    v_pk_fma_f32 v[216:217], v[84:85], v[84:85], v[216:217]
    v_pk_fma_f32 v[218:219], v[86:87], v[86:87], v[218:219]
    v_pk_fma_f32 v[216:217], v[88:89], v[88:89], v[216:217]
    v_pk_fma_f32 v[218:219], v[90:91], v[90:91], v[218:219]
    v_pk_fma_f32 v[216:217], v[92:93], v[92:93], v[216:217]
    v_pk_fma_f32 v[218:219], v[94:95], v[94:95], v[218:219]
    v_pk_fma_f32 v[216:217], v[96:97], v[96:97], v[216:217]
    v_pk_fma_f32 v[218:219], v[98:99], v[98:99], v[218:219]
    v_pk_fma_f32 v[216:217], v[100:101], v[100:101], v[216:217]
    v_pk_fma_f32 v[218:219], v[102:103], v[102:103], v[218:219]
    v_pk_fma_f32 v[216:217], v[104:105], v[104:105], v[216:217]
    v_pk_fma_f32 v[218:219], v[106:107], v[106:107], v[218:219]
    v_pk_fma_f32 v[216:217], v[108:109], v[108:109], v[216:217]
    v_pk_fma_f32 v[218:219], v[110:111], v[110:111], v[218:219]
    v_pk_fma_f32 v[216:217], v[112:113], v[112:113], v[216:217]
    v_pk_fma_f32 v[218:219], v[114:115], v[114:115], v[218:219]
    v_pk_fma_f32 v[216:217], v[116:117], v[116:117], v[216:217]
    v_pk_fma_f32 v[218:219], v[118:119], v[118:119], v[218:219]
    v_pk_fma_f32 v[216:217], v[120:121], v[120:121], v[216:217]
    v_pk_fma_f32 v[218:219], v[122:123], v[122:123], v[218:219]
    v_pk_fma_f32 v[216:217], v[124:125], v[124:125], v[216:217]
    v_pk_fma_f32 v[218:219], v[126:127], v[126:127], v[218:219]
    v_pk_fma_f32 v[216:217], v[128:129], v[128:129], v[216:217]
    v_pk_fma_f32 v[218:219], v[130:131], v[130:131], v[218:219]
    v_pk_fma_f32 v[216:217], v[132:133], v[132:133], v[216:217]
    v_pk_fma_f32 v[218:219], v[134:135], v[134:135], v[218:219]
    v_pk_fma_f32 v[216:217], v[136:137], v[136:137], v[216:217]
    v_pk_fma_f32 v[218:219], v[138:139], v[138:139], v[218:219]
    v_pk_fma_f32 v[216:217], v[140:141], v[140:141], v[216:217]
    v_pk_fma_f32 v[218:219], v[142:143], v[142:143], v[218:219]
    v_pk_fma_f32 v[216:217], v[144:145], v[144:145], v[216:217]
    v_pk_fma_f32 v[218:219], v[146:147], v[146:147], v[218:219]
    v_pk_fma_f32 v[216:217], v[148:149], v[148:149], v[216:217]
    v_pk_fma_f32 v[218:219], v[150:151], v[150:151], v[218:219]
    v_pk_fma_f32 v[216:217], v[152:153], v[152:153], v[216:217]
    v_pk_fma_f32 v[218:219], v[154:155], v[154:155], v[218:219]
    v_pk_fma_f32 v[216:217], v[156:157], v[156:157], v[216:217]
    v_pk_fma_f32 v[218:219], v[158:159], v[158:159], v[218:219]
    v_pk_fma_f32 v[216:217], v[160:161], v[160:161], v[216:217]
    v_pk_fma_f32 v[218:219], v[162:163], v[162:163], v[218:219]
    v_pk_fma_f32 v[216:217], v[164:165], v[164:165], v[216:217]
    v_pk_fma_f32 v[218:219], v[166:167], v[166:167], v[218:219]
    v_add_f32 v216, v216, v217
    v_add_f32 v218, v218, v219
    v_add_f32 v216, v216, v218
    v_mov_b32 v217, v216
    s_nop 1
    v_permlane16_swap_b32 v216, v217
    s_nop 1
    v_add_f32 v216, v216, v217
    v_mov_b32 v217, v216
    s_nop 1
    v_permlane32_swap_b32 v216, v217
    s_nop 1
    v_add_f32 v216, v216, v217
    v_mov_b32 v217, 0x3727c5ac
    v_fmac_f32 v217, 0x3b124925, v216
    v_rsq_f32 v216, v217
    s_nop 0
    v_mov_b32 v217, v216
    v_pk_mul_f32 v[56:57], v[56:57], v[216:217]
    v_pk_mul_f32 v[58:59], v[58:59], v[216:217]
    v_pk_mul_f32 v[60:61], v[60:61], v[216:217]
    v_pk_mul_f32 v[62:63], v[62:63], v[216:217]
    v_pk_mul_f32 v[64:65], v[64:65], v[216:217]
    v_pk_mul_f32 v[66:67], v[66:67], v[216:217]
    v_pk_mul_f32 v[68:69], v[68:69], v[216:217]
    v_pk_mul_f32 v[70:71], v[70:71], v[216:217]
    v_pk_mul_f32 v[72:73], v[72:73], v[216:217]
    v_pk_mul_f32 v[74:75], v[74:75], v[216:217]
    v_pk_mul_f32 v[76:77], v[76:77], v[216:217]
    v_pk_mul_f32 v[78:79], v[78:79], v[216:217]
    v_pk_mul_f32 v[80:81], v[80:81], v[216:217]
    v_pk_mul_f32 v[82:83], v[82:83], v[216:217]
    v_pk_mul_f32 v[84:85], v[84:85], v[216:217]
    v_pk_mul_f32 v[86:87], v[86:87], v[216:217]
    v_pk_mul_f32 v[88:89], v[88:89], v[216:217]
    v_pk_mul_f32 v[90:91], v[90:91], v[216:217]
    v_pk_mul_f32 v[92:93], v[92:93], v[216:217]
    v_pk_mul_f32 v[94:95], v[94:95], v[216:217]
    v_pk_mul_f32 v[96:97], v[96:97], v[216:217]
    v_pk_mul_f32 v[98:99], v[98:99], v[216:217]
    v_pk_mul_f32 v[100:101], v[100:101], v[216:217]
    v_pk_mul_f32 v[102:103], v[102:103], v[216:217]
    v_pk_mul_f32 v[104:105], v[104:105], v[216:217]
    v_pk_mul_f32 v[106:107], v[106:107], v[216:217]
    v_pk_mul_f32 v[108:109], v[108:109], v[216:217]
    v_pk_mul_f32 v[110:111], v[110:111], v[216:217]
    v_pk_mul_f32 v[112:113], v[112:113], v[216:217]
    v_pk_mul_f32 v[114:115], v[114:115], v[216:217]
    v_pk_mul_f32 v[116:117], v[116:117], v[216:217]
    v_pk_mul_f32 v[118:119], v[118:119], v[216:217]
    v_pk_mul_f32 v[120:121], v[120:121], v[216:217]
    v_pk_mul_f32 v[122:123], v[122:123], v[216:217]
    v_pk_mul_f32 v[124:125], v[124:125], v[216:217]
    v_pk_mul_f32 v[126:127], v[126:127], v[216:217]
    v_pk_mul_f32 v[128:129], v[128:129], v[216:217]
    v_pk_mul_f32 v[130:131], v[130:131], v[216:217]
    v_pk_mul_f32 v[132:133], v[132:133], v[216:217]
    v_pk_mul_f32 v[134:135], v[134:135], v[216:217]
    v_pk_mul_f32 v[136:137], v[136:137], v[216:217]
    v_pk_mul_f32 v[138:139], v[138:139], v[216:217]
    v_pk_mul_f32 v[140:141], v[140:141], v[216:217]
    v_pk_mul_f32 v[142:143], v[142:143], v[216:217]
    v_pk_mul_f32 v[144:145], v[144:145], v[216:217]
    v_pk_mul_f32 v[146:147], v[146:147], v[216:217]
    v_pk_mul_f32 v[148:149], v[148:149], v[216:217]
    v_pk_mul_f32 v[150:151], v[150:151], v[216:217]
    v_pk_mul_f32 v[152:153], v[152:153], v[216:217]
    v_pk_mul_f32 v[154:155], v[154:155], v[216:217]
    v_pk_mul_f32 v[156:157], v[156:157], v[216:217]
    v_pk_mul_f32 v[158:159], v[158:159], v[216:217]
    v_pk_mul_f32 v[160:161], v[160:161], v[216:217]
    v_pk_mul_f32 v[162:163], v[162:163], v[216:217]
    v_pk_mul_f32 v[164:165], v[164:165], v[216:217]
    v_pk_mul_f32 v[166:167], v[166:167], v[216:217]
    s_cmp_lg_u32 s34, 0
    s_cbranch_scc1 L_modwait_done
    v_mov_b32 v206, 0
L_poll:
    buffer_load_dword v207, v206, s[88:91], 0 offen offset:128 sc1
    s_waitcnt vmcnt(0)
    v_readfirstlane_b32 s60, v207
    s_cmp_eq_u32 s60, 1
    s_cbranch_scc1 L_poll_done
    s_sleep 8
    s_branch L_poll
L_poll_done:
L_modwait_done:
    s_barrier
    v_lshlrev_b32 v206, 4, v252
    s_lshl_b32 s60, s34, 10
    v_add_u32 v206, s60, v206
    v_add_u32 v207, 196608, v206
    buffer_load_dwordx4 v[168:171], v207, s[24:27], 0 offen sc1
    v_add_u32 v207, 3584, v207
    buffer_load_dwordx4 v[172:175], v207, s[24:27], 0 offen sc1
    v_add_u32 v207, 3584, v207
    buffer_load_dwordx4 v[176:179], v207, s[24:27], 0 offen sc1
    v_add_u32 v207, 3584, v207
    buffer_load_dwordx4 v[180:183], v207, s[24:27], 0 offen sc1
    s_lshl_b32 s60, s34, 8
    v_lshl_add_u32 v208, v252, 2, s60
    v_cmp_le_u32 vcc, 448, v208
    s_waitcnt vmcnt(0)
    v_add_f32 v168, v168, v172
    v_add_f32 v176, v176, v180
    v_add_f32 v169, v169, v173
    v_add_f32 v177, v177, v181
    v_add_f32 v170, v170, v174
    v_add_f32 v178, v178, v182
    v_add_f32 v171, v171, v175
    v_add_f32 v179, v179, v183
    v_add_f32 v168, v168, v176
    v_add_f32 v169, v169, v177
    v_add_f32 v170, v170, v178
    v_add_f32 v171, v171, v179
    v_cvt_pk_bf16_f32 v168, v168, 0
    v_cvt_pk_bf16_f32 v169, v169, 0
    v_cvt_pk_bf16_f32 v170, v170, 0
    v_cvt_pk_bf16_f32 v171, v171, 0
    v_lshlrev_b32 v168, 16, v168
    v_lshlrev_b32 v169, 16, v169
    v_lshlrev_b32 v170, 16, v170
    v_lshlrev_b32 v171, 16, v171
    v_add_f32 v172, 1.0, v168
    v_add_f32 v173, 1.0, v169
    v_add_f32 v174, 1.0, v170
    v_add_f32 v175, 1.0, v171
    v_cvt_pk_bf16_f32 v172, v172, 0
    v_cvt_pk_bf16_f32 v173, v173, 0
    v_cvt_pk_bf16_f32 v174, v174, 0
    v_cvt_pk_bf16_f32 v175, v175, 0
    v_lshlrev_b32 v172, 16, v172
    v_lshlrev_b32 v173, 16, v173
    v_lshlrev_b32 v174, 16, v174
    v_lshlrev_b32 v175, 16, v175
    v_cndmask_b32 v168, v168, v172, vcc
    v_cndmask_b32 v169, v169, v173, vcc
    v_cndmask_b32 v170, v170, v174, vcc
    v_cndmask_b32 v171, v171, v175, vcc
    v_mul_f32 v168, 0x3db8aa3b, v168
    v_mul_f32 v169, 0x3db8aa3b, v169
    v_mul_f32 v170, 0x3db8aa3b, v170
    v_mul_f32 v171, 0x3db8aa3b, v171
    ds_write_b128 v206, v[168:171] offset:57344
    s_waitcnt lgkmcnt(0)
    s_barrier
    s_cmp_lt_u32 s2, 56
    s_cbranch_scc1 L_noa2
    s_cmp_ge_u32 s2, 168
    s_cbranch_scc1 L_noa2
    s_cmp_lg_u32 s34, 0
    s_cbranch_scc1 L_noa2
    v_mov_b32 v209, 1
    v_mov_b32 v208, 0
    v_cmp_eq_u32 vcc, 0, v252
    s_and_saveexec_b64 s[62:63], vcc
    buffer_atomic_add v209, v208, s[88:91], 0 offen offset:64 sc1
    s_mov_b64 exec, s[62:63]
L_noa2:
    buffer_load_dword v254, v241, s[92:95], 0 offen
    v_lshlrev_b32 v222, 5, v201
    v_add_u32 v222, 57344, v222
    s_mul_i32 s60, s34, 14336
    v_lshlrev_b32 v223, 4, v252
    v_add_u32 v223, s60, v223
    ds_read_b128 v[16:19], v222 offset:0
    ds_read_b128 v[20:23], v222 offset:16
    ds_read_b128 v[24:27], v222 offset:1792
    ds_read_b128 v[28:31], v222 offset:1808
    ds_read_b128 v[32:35], v222 offset:128
    ds_read_b128 v[36:39], v222 offset:144
    ds_read_b128 v[40:43], v222 offset:1920
    ds_read_b128 v[44:47], v222 offset:1936
    ds_read_b128 v[168:171], v222 offset:256
    ds_read_b128 v[172:175], v222 offset:272
    ds_read_b128 v[176:179], v222 offset:2048
    ds_read_b128 v[180:183], v222 offset:2064
    ds_read_b128 v[184:187], v222 offset:384
    ds_read_b128 v[188:191], v222 offset:400
    ds_read_b128 v[192:195], v222 offset:2176
    ds_read_b128 v[196:199], v222 offset:2192
    s_waitcnt lgkmcnt(13)
    v_pk_fma_f32 v[16:17], v[56:57], v[24:25], v[16:17]
    v_pk_fma_f32 v[18:19], v[58:59], v[26:27], v[18:19]
    s_waitcnt lgkmcnt(12)
    v_pk_fma_f32 v[20:21], v[60:61], v[28:29], v[20:21]
    v_pk_fma_f32 v[22:23], v[62:63], v[30:31], v[22:23]
    v_cvt_pk_bf16_f32 v0, v16, v17
    v_cvt_pk_bf16_f32 v1, v18, v19
    v_cvt_pk_bf16_f32 v2, v20, v21
    v_cvt_pk_bf16_f32 v3, v22, v23
    ds_write_b128 v223, v[0:3] offset:0
    ds_read_b128 v[16:19], v222 offset:512
    ds_read_b128 v[20:23], v222 offset:528
    ds_read_b128 v[24:27], v222 offset:2304
    ds_read_b128 v[28:31], v222 offset:2320
    s_waitcnt lgkmcnt(14)
    v_pk_fma_f32 v[32:33], v[64:65], v[40:41], v[32:33]
    v_pk_fma_f32 v[34:35], v[66:67], v[42:43], v[34:35]
    s_waitcnt lgkmcnt(13)
    v_pk_fma_f32 v[36:37], v[68:69], v[44:45], v[36:37]
    v_pk_fma_f32 v[38:39], v[70:71], v[46:47], v[38:39]
    v_cvt_pk_bf16_f32 v4, v32, v33
    v_cvt_pk_bf16_f32 v5, v34, v35
    v_cvt_pk_bf16_f32 v6, v36, v37
    v_cvt_pk_bf16_f32 v7, v38, v39
    ds_write_b128 v223, v[4:7] offset:1024
    ds_read_b128 v[32:35], v222 offset:640
    ds_read_b128 v[36:39], v222 offset:656
    ds_read_b128 v[40:43], v222 offset:2432
    ds_read_b128 v[44:47], v222 offset:2448
    s_waitcnt lgkmcnt(15)
    v_pk_fma_f32 v[168:169], v[72:73], v[176:177], v[168:169]
    v_pk_fma_f32 v[170:171], v[74:75], v[178:179], v[170:171]
    s_waitcnt lgkmcnt(14)
    v_pk_fma_f32 v[172:173], v[76:77], v[180:181], v[172:173]
    v_pk_fma_f32 v[174:175], v[78:79], v[182:183], v[174:175]
    v_cvt_pk_bf16_f32 v8, v168, v169
    v_cvt_pk_bf16_f32 v9, v170, v171
    v_cvt_pk_bf16_f32 v10, v172, v173
    v_cvt_pk_bf16_f32 v11, v174, v175
    ds_write_b128 v223, v[8:11] offset:2048
    ds_read_b128 v[168:171], v222 offset:768
    ds_read_b128 v[172:175], v222 offset:784
    ds_read_b128 v[176:179], v222 offset:2560
    ds_read_b128 v[180:183], v222 offset:2576
    s_waitcnt lgkmcnt(15)
    v_pk_fma_f32 v[184:185], v[80:81], v[192:193], v[184:185]
    v_pk_fma_f32 v[186:187], v[82:83], v[194:195], v[186:187]
    v_pk_fma_f32 v[188:189], v[84:85], v[196:197], v[188:189]
    v_pk_fma_f32 v[190:191], v[86:87], v[198:199], v[190:191]
    v_cvt_pk_bf16_f32 v12, v184, v185
    v_cvt_pk_bf16_f32 v13, v186, v187
    v_cvt_pk_bf16_f32 v14, v188, v189
    v_cvt_pk_bf16_f32 v15, v190, v191
    ds_write_b128 v223, v[12:15] offset:3072
    ds_read_b128 v[184:187], v222 offset:896
    ds_read_b128 v[188:191], v222 offset:912
    ds_read_b128 v[192:195], v222 offset:2688
    ds_read_b128 v[196:199], v222 offset:2704
    s_waitcnt lgkmcnt(15)
    v_pk_fma_f32 v[16:17], v[88:89], v[24:25], v[16:17]
    v_pk_fma_f32 v[18:19], v[90:91], v[26:27], v[18:19]
    v_pk_fma_f32 v[20:21], v[92:93], v[28:29], v[20:21]
    v_pk_fma_f32 v[22:23], v[94:95], v[30:31], v[22:23]
    v_cvt_pk_bf16_f32 v0, v16, v17
    v_cvt_pk_bf16_f32 v1, v18, v19
    v_cvt_pk_bf16_f32 v2, v20, v21
    v_cvt_pk_bf16_f32 v3, v22, v23
    ds_write_b128 v223, v[0:3] offset:4096
    ds_read_b128 v[16:19], v222 offset:1024
    ds_read_b128 v[20:23], v222 offset:1040
    ds_read_b128 v[24:27], v222 offset:2816
    ds_read_b128 v[28:31], v222 offset:2832
    s_waitcnt lgkmcnt(15)
    v_pk_fma_f32 v[32:33], v[96:97], v[40:41], v[32:33]
    v_pk_fma_f32 v[34:35], v[98:99], v[42:43], v[34:35]
    v_pk_fma_f32 v[36:37], v[100:101], v[44:45], v[36:37]
    v_pk_fma_f32 v[38:39], v[102:103], v[46:47], v[38:39]
    v_cvt_pk_bf16_f32 v4, v32, v33
    v_cvt_pk_bf16_f32 v5, v34, v35
    v_cvt_pk_bf16_f32 v6, v36, v37
    v_cvt_pk_bf16_f32 v7, v38, v39
    ds_write_b128 v223, v[4:7] offset:5120
    ds_read_b128 v[32:35], v222 offset:1152
    ds_read_b128 v[36:39], v222 offset:1168
    ds_read_b128 v[40:43], v222 offset:2944
    ds_read_b128 v[44:47], v222 offset:2960
    s_waitcnt lgkmcnt(15)
    v_pk_fma_f32 v[168:169], v[104:105], v[176:177], v[168:169]
    v_pk_fma_f32 v[170:171], v[106:107], v[178:179], v[170:171]
    v_pk_fma_f32 v[172:173], v[108:109], v[180:181], v[172:173]
    v_pk_fma_f32 v[174:175], v[110:111], v[182:183], v[174:175]
    v_cvt_pk_bf16_f32 v8, v168, v169
    v_cvt_pk_bf16_f32 v9, v170, v171
    v_cvt_pk_bf16_f32 v10, v172, v173
    v_cvt_pk_bf16_f32 v11, v174, v175
    ds_write_b128 v223, v[8:11] offset:6144
    ds_read_b128 v[168:171], v222 offset:1280
    ds_read_b128 v[172:175], v222 offset:1296
    ds_read_b128 v[176:179], v222 offset:3072
    ds_read_b128 v[180:183], v222 offset:3088
    s_waitcnt lgkmcnt(15)
    v_pk_fma_f32 v[184:185], v[112:113], v[192:193], v[184:185]
    v_pk_fma_f32 v[186:187], v[114:115], v[194:195], v[186:187]
    v_pk_fma_f32 v[188:189], v[116:117], v[196:197], v[188:189]
    v_pk_fma_f32 v[190:191], v[118:119], v[198:199], v[190:191]
    v_cvt_pk_bf16_f32 v12, v184, v185
    v_cvt_pk_bf16_f32 v13, v186, v187
    v_cvt_pk_bf16_f32 v14, v188, v189
    v_cvt_pk_bf16_f32 v15, v190, v191
    ds_write_b128 v223, v[12:15] offset:7168
    ds_read_b128 v[184:187], v222 offset:1408
    ds_read_b128 v[188:191], v222 offset:1424
    ds_read_b128 v[192:195], v222 offset:3200
    ds_read_b128 v[196:199], v222 offset:3216
    s_waitcnt lgkmcnt(15)
    v_pk_fma_f32 v[16:17], v[120:121], v[24:25], v[16:17]
    v_pk_fma_f32 v[18:19], v[122:123], v[26:27], v[18:19]
    v_pk_fma_f32 v[20:21], v[124:125], v[28:29], v[20:21]
    v_pk_fma_f32 v[22:23], v[126:127], v[30:31], v[22:23]
    v_cvt_pk_bf16_f32 v0, v16, v17
    v_cvt_pk_bf16_f32 v1, v18, v19
    v_cvt_pk_bf16_f32 v2, v20, v21
    v_cvt_pk_bf16_f32 v3, v22, v23
    ds_write_b128 v223, v[0:3] offset:8192
    ds_read_b128 v[16:19], v222 offset:1536
    ds_read_b128 v[20:23], v222 offset:1552
    ds_read_b128 v[24:27], v222 offset:3328
    ds_read_b128 v[28:31], v222 offset:3344
    s_waitcnt lgkmcnt(15)
    v_pk_fma_f32 v[32:33], v[128:129], v[40:41], v[32:33]
    v_pk_fma_f32 v[34:35], v[130:131], v[42:43], v[34:35]
    v_pk_fma_f32 v[36:37], v[132:133], v[44:45], v[36:37]
    v_pk_fma_f32 v[38:39], v[134:135], v[46:47], v[38:39]
    v_cvt_pk_bf16_f32 v4, v32, v33
    v_cvt_pk_bf16_f32 v5, v34, v35
    v_cvt_pk_bf16_f32 v6, v36, v37
    v_cvt_pk_bf16_f32 v7, v38, v39
    ds_write_b128 v223, v[4:7] offset:9216
    ds_read_b128 v[32:35], v222 offset:1664
    ds_read_b128 v[36:39], v222 offset:1680
    ds_read_b128 v[40:43], v222 offset:3456
    ds_read_b128 v[44:47], v222 offset:3472
    s_waitcnt lgkmcnt(15)
    v_pk_fma_f32 v[168:169], v[136:137], v[176:177], v[168:169]
    v_pk_fma_f32 v[170:171], v[138:139], v[178:179], v[170:171]
    v_pk_fma_f32 v[172:173], v[140:141], v[180:181], v[172:173]
    v_pk_fma_f32 v[174:175], v[142:143], v[182:183], v[174:175]
    v_cvt_pk_bf16_f32 v8, v168, v169
    v_cvt_pk_bf16_f32 v9, v170, v171
    v_cvt_pk_bf16_f32 v10, v172, v173
    v_cvt_pk_bf16_f32 v11, v174, v175
    ds_write_b128 v223, v[8:11] offset:10240
    s_waitcnt lgkmcnt(12)
    v_pk_fma_f32 v[184:185], v[144:145], v[192:193], v[184:185]
    v_pk_fma_f32 v[186:187], v[146:147], v[194:195], v[186:187]
    s_waitcnt lgkmcnt(11)
    v_pk_fma_f32 v[188:189], v[148:149], v[196:197], v[188:189]
    v_pk_fma_f32 v[190:191], v[150:151], v[198:199], v[190:191]
    v_cvt_pk_bf16_f32 v12, v184, v185
    v_cvt_pk_bf16_f32 v13, v186, v187
    v_cvt_pk_bf16_f32 v14, v188, v189
    v_cvt_pk_bf16_f32 v15, v190, v191
    ds_write_b128 v223, v[12:15] offset:11264
    s_waitcnt lgkmcnt(8)
    v_pk_fma_f32 v[16:17], v[152:153], v[24:25], v[16:17]
    v_pk_fma_f32 v[18:19], v[154:155], v[26:27], v[18:19]
    s_waitcnt lgkmcnt(7)
    v_pk_fma_f32 v[20:21], v[156:157], v[28:29], v[20:21]
    v_pk_fma_f32 v[22:23], v[158:159], v[30:31], v[22:23]
    v_cvt_pk_bf16_f32 v0, v16, v17
    v_cvt_pk_bf16_f32 v1, v18, v19
    v_cvt_pk_bf16_f32 v2, v20, v21
    v_cvt_pk_bf16_f32 v3, v22, v23
    ds_write_b128 v223, v[0:3] offset:12288
    s_waitcnt lgkmcnt(4)
    v_pk_fma_f32 v[32:33], v[160:161], v[40:41], v[32:33]
    v_pk_fma_f32 v[34:35], v[162:163], v[42:43], v[34:35]
    s_waitcnt lgkmcnt(3)
    v_pk_fma_f32 v[36:37], v[164:165], v[44:45], v[36:37]
    v_pk_fma_f32 v[38:39], v[166:167], v[46:47], v[38:39]
    v_cvt_pk_bf16_f32 v4, v32, v33
    v_cvt_pk_bf16_f32 v5, v34, v35
    v_cvt_pk_bf16_f32 v6, v36, v37
    v_cvt_pk_bf16_f32 v7, v38, v39
    ds_write_b128 v223, v[4:7] offset:13312
    s_waitcnt lgkmcnt(0)
    s_barrier
    v_lshlrev_b32 v223, 4, v252
    ds_read_b128 a[0:3], v223 offset:0
    ds_read_b128 a[56:59], v223 offset:14336
    ds_read_b128 a[112:115], v223 offset:28672
    ds_read_b128 a[168:171], v223 offset:43008
    ds_read_b128 a[4:7], v223 offset:1024
    ds_read_b128 a[60:63], v223 offset:15360
    ds_read_b128 a[116:119], v223 offset:29696
    ds_read_b128 a[172:175], v223 offset:44032
    ds_read_b128 a[8:11], v223 offset:2048
    ds_read_b128 a[64:67], v223 offset:16384
    ds_read_b128 a[120:123], v223 offset:30720
    ds_read_b128 a[176:179], v223 offset:45056
    ds_read_b128 a[12:15], v223 offset:3072
    ds_read_b128 a[68:71], v223 offset:17408
    ds_read_b128 a[124:127], v223 offset:31744
    ds_read_b128 a[180:183], v223 offset:46080
    ds_read_b128 a[16:19], v223 offset:4096
    ds_read_b128 a[72:75], v223 offset:18432
    ds_read_b128 a[128:131], v223 offset:32768
    ds_read_b128 a[184:187], v223 offset:47104
    ds_read_b128 a[20:23], v223 offset:5120
    ds_read_b128 a[76:79], v223 offset:19456
    ds_read_b128 a[132:135], v223 offset:33792
    ds_read_b128 a[188:191], v223 offset:48128
    ds_read_b128 a[24:27], v223 offset:6144
    ds_read_b128 a[80:83], v223 offset:20480
    ds_read_b128 a[136:139], v223 offset:34816
    ds_read_b128 a[192:195], v223 offset:49152
    ds_read_b128 a[28:31], v223 offset:7168
    ds_read_b128 a[84:87], v223 offset:21504
    ds_read_b128 a[140:143], v223 offset:35840
    ds_read_b128 a[196:199], v223 offset:50176
    ds_read_b128 a[32:35], v223 offset:8192
    ds_read_b128 a[88:91], v223 offset:22528
    ds_read_b128 a[144:147], v223 offset:36864
    ds_read_b128 a[200:203], v223 offset:51200
    ds_read_b128 a[36:39], v223 offset:9216
    ds_read_b128 a[92:95], v223 offset:23552
    ds_read_b128 a[148:151], v223 offset:37888
    ds_read_b128 a[204:207], v223 offset:52224
    ds_read_b128 a[40:43], v223 offset:10240
    ds_read_b128 a[96:99], v223 offset:24576
    ds_read_b128 a[152:155], v223 offset:38912
    ds_read_b128 a[208:211], v223 offset:53248
    ds_read_b128 a[44:47], v223 offset:11264
    ds_read_b128 a[100:103], v223 offset:25600
    ds_read_b128 a[156:159], v223 offset:39936
    ds_read_b128 a[212:215], v223 offset:54272
    ds_read_b128 a[48:51], v223 offset:12288
    ds_read_b128 a[104:107], v223 offset:26624
    ds_read_b128 a[160:163], v223 offset:40960
    ds_read_b128 a[216:219], v223 offset:55296
    ds_read_b128 a[52:55], v223 offset:13312
    ds_read_b128 a[108:111], v223 offset:27648
    ds_read_b128 a[164:167], v223 offset:41984
    ds_read_b128 a[220:223], v223 offset:56320
    v_bfe_u32 v206, v252, 2, 2
    v_and_b32 v207, 1, v201
    v_lshl_add_u32 v207, v207, 2, v206
    v_lshlrev_b32 v208, 11, v201
    v_lshl_add_u32 v208, v206, 8, v208
    v_and_b32 v209, 3, v252
    v_lshl_add_u32 v208, v209, 3, v208
    v_add_u32 v208, s32, v208
    v_xor_b32 v209, 0, v207
    v_lshl_add_u32 v232, v209, 5, v208
    v_xor_b32 v209, 1, v207
    v_lshl_add_u32 v233, v209, 5, v208
    v_xor_b32 v209, 2, v207
    v_lshl_add_u32 v234, v209, 5, v208
    v_xor_b32 v209, 3, v207
    v_lshl_add_u32 v235, v209, 5, v208
    v_xor_b32 v209, 4, v207
    v_lshl_add_u32 v236, v209, 5, v208
    v_xor_b32 v209, 5, v207
    v_lshl_add_u32 v237, v209, 5, v208
    v_xor_b32 v209, 6, v207
    v_lshl_add_u32 v238, v209, 5, v208
    v_xor_b32 v209, 7, v207
    v_lshl_add_u32 v239, v209, 5, v208
    s_waitcnt lgkmcnt(0)
    s_barrier
    s_mul_i32 s61, s38, 16896
    s_lshl_b32 s62, s38, 14
    s_lshl_b32 s63, s39, 13
    s_add_u32 s62, s62, s63
    v_lshlrev_b32 v226, 4, v252
    v_add_u32 v226, s62, v226
    v_and_b32 v240, 7, v252
    v_mul_u32_u24 v240, 1056, v240
    v_bfe_u32 v241, v252, 3, 1
    v_lshlrev_b32 v241, 9, v241
    v_add_u32 v240, v240, v241
    v_lshrrev_b32 v241, 4, v252
    v_lshlrev_b32 v241, 4, v241
    v_add_u32 v240, v240, v241
    v_add_u32 v224, s61, v240
    v_lshrrev_b32 v240, 2, v252
    v_and_b32 v241, 7, v240
    v_mul_u32_u24 v241, 1056, v241
    v_lshrrev_b32 v240, 3, v240
    v_lshlrev_b32 v240, 9, v240
    v_add_u32 v240, v240, v241
    v_and_b32 v241, 3, v252
    v_lshlrev_b32 v241, 3, v241
    v_add_u32 v240, v240, v241
    v_add_u32 v240, s61, v240
    v_add_u32 v225, 67584, v240
    v_add_u32 v232, 98304, v232
    v_add_u32 v233, 98304, v233
    v_add_u32 v234, 98304, v234
    v_add_u32 v235, 98304, v235
    v_add_u32 v236, 98304, v236
    v_add_u32 v237, 98304, v237
    v_add_u32 v238, 98304, v238
    v_add_u32 v239, 98304, v239
    s_waitcnt vmcnt(17)
    ds_read_b64_tr_b16 v[208:209], v232 offset:0
    ds_read_b64_tr_b16 v[210:211], v232 offset:1024
    ds_read_b64_tr_b16 v[212:213], v233 offset:0
    ds_read_b64_tr_b16 v[214:215], v233 offset:1024
    ds_read_b64_tr_b16 v[216:217], v234 offset:0
    ds_read_b64_tr_b16 v[218:219], v234 offset:1024
    s_waitcnt lgkmcnt(4)
    v_mfma_f32_16x16x32_bf16 v[0:3], v[208:211], a[0:3], 0
    ds_read_b64_tr_b16 v[220:221], v235 offset:0
    ds_read_b64_tr_b16 v[222:223], v235 offset:1024
    v_mfma_f32_16x16x32_bf16 v[4:7], v[208:211], a[56:59], 0
    s_add_u32 m0, s32, 32768
    v_add_u32 v232, 0x8000, v232
    v_add_u32 v235, 0x8000, v235
    v_mfma_f32_16x16x32_bf16 v[8:11], v[208:211], a[112:115], 0
    buffer_load_dwordx4 v204, s[44:47], s52 offen offset:0 lds
    v_add_u32 v233, 0x8000, v233
    v_mfma_f32_16x16x32_bf16 v[12:15], v[208:211], a[168:171], 0
    s_waitcnt lgkmcnt(4)
    v_add_u32 v234, 0x8000, v234
    v_mfma_f32_16x16x32_bf16 v[16:19], v[212:215], a[0:3], 0
    ds_read_b64_tr_b16 v[208:209], v236 offset:0
    ds_read_b64_tr_b16 v[210:211], v236 offset:1024
    v_mfma_f32_16x16x32_bf16 v[20:23], v[212:215], a[56:59], 0
    v_add_u32 v236, 0x8000, v236
    v_mfma_f32_16x16x32_bf16 v[24:27], v[212:215], a[112:115], 0
    buffer_load_dwordx4 v204, s[44:47], s53 offen offset:1024 lds
    v_mfma_f32_16x16x32_bf16 v[28:31], v[212:215], a[168:171], 0
    s_waitcnt lgkmcnt(4)
    v_mfma_f32_16x16x32_bf16 v[32:35], v[216:219], a[0:3], 0
    ds_read_b64_tr_b16 v[212:213], v237 offset:0
    ds_read_b64_tr_b16 v[214:215], v237 offset:1024
    v_mfma_f32_16x16x32_bf16 v[36:39], v[216:219], a[56:59], 0
    v_add_u32 v237, 0x8000, v237
    v_mfma_f32_16x16x32_bf16 v[40:43], v[216:219], a[112:115], 0
    buffer_load_dwordx4 v205, s[44:47], s54 offen offset:2048 lds
    v_mfma_f32_16x16x32_bf16 v[44:47], v[216:219], a[168:171], 0
    s_waitcnt lgkmcnt(4)
    v_mfma_f32_16x16x32_bf16 v[48:51], v[220:223], a[0:3], 0
    ds_read_b64_tr_b16 v[216:217], v238 offset:0
    ds_read_b64_tr_b16 v[218:219], v238 offset:1024
    v_mfma_f32_16x16x32_bf16 v[52:55], v[220:223], a[56:59], 0
    v_add_u32 v238, 0x8000, v238
    v_mfma_f32_16x16x32_bf16 v[56:59], v[220:223], a[112:115], 0
    buffer_load_dwordx4 v205, s[44:47], s55 offen offset:3072 lds
    v_mfma_f32_16x16x32_bf16 v[60:63], v[220:223], a[168:171], 0
    s_waitcnt lgkmcnt(4)
    v_mfma_f32_16x16x32_bf16 v[64:67], v[208:211], a[0:3], 0
    ds_read_b64_tr_b16 v[220:221], v239 offset:0
    ds_read_b64_tr_b16 v[222:223], v239 offset:1024
    v_mfma_f32_16x16x32_bf16 v[68:71], v[208:211], a[56:59], 0
    s_add_u32 m0, s32, 36864
    v_add_u32 v239, 0x8000, v239
    v_mfma_f32_16x16x32_bf16 v[72:75], v[208:211], a[112:115], 0
    buffer_load_dwordx4 v204, s[44:47], s56 offen offset:0 lds
    v_mfma_f32_16x16x32_bf16 v[76:79], v[208:211], a[168:171], 0
    s_waitcnt lgkmcnt(4)
    v_mfma_f32_16x16x32_bf16 v[80:83], v[212:215], a[0:3], 0
    s_waitcnt vmcnt(14)
    ds_read_b64_tr_b16 v[208:209], v232 offset:0
    ds_read_b64_tr_b16 v[210:211], v232 offset:1024
    v_mfma_f32_16x16x32_bf16 v[84:87], v[212:215], a[56:59], 0
    v_add_u32 v232, 0xffff0000, v232
    v_mfma_f32_16x16x32_bf16 v[88:91], v[212:215], a[112:115], 0
    buffer_load_dwordx4 v204, s[44:47], s57 offen offset:1024 lds
    v_mfma_f32_16x16x32_bf16 v[92:95], v[212:215], a[168:171], 0
    s_waitcnt lgkmcnt(4)
    v_mfma_f32_16x16x32_bf16 v[96:99], v[216:219], a[0:3], 0
    ds_read_b64_tr_b16 v[212:213], v233 offset:0
    ds_read_b64_tr_b16 v[214:215], v233 offset:1024
    v_mfma_f32_16x16x32_bf16 v[100:103], v[216:219], a[56:59], 0
    v_add_u32 v233, 0xffff0000, v233
    v_mfma_f32_16x16x32_bf16 v[104:107], v[216:219], a[112:115], 0
    buffer_load_dwordx4 v205, s[44:47], s58 offen offset:2048 lds
    v_mfma_f32_16x16x32_bf16 v[108:111], v[216:219], a[168:171], 0
    s_waitcnt lgkmcnt(4)
    v_mfma_f32_16x16x32_bf16 v[112:115], v[220:223], a[0:3], 0
    ds_read_b64_tr_b16 v[216:217], v234 offset:0
    ds_read_b64_tr_b16 v[218:219], v234 offset:1024
    v_mfma_f32_16x16x32_bf16 v[116:119], v[220:223], a[56:59], 0
    v_add_u32 v234, 0xffff0000, v234
    v_mfma_f32_16x16x32_bf16 v[120:123], v[220:223], a[112:115], 0
    buffer_load_dwordx4 v205, s[44:47], s59 offen offset:3072 lds
    v_mfma_f32_16x16x32_bf16 v[124:127], v[220:223], a[168:171], 0
    s_waitcnt lgkmcnt(4)
    v_add_u32 v204, 0x40000, v204
    v_add_u32 v205, 0x40000, v205
    v_mfma_f32_16x16x32_bf16 v[0:3], v[208:211], a[4:7], v[0:3]
    ds_read_b64_tr_b16 v[220:221], v235 offset:0
    ds_read_b64_tr_b16 v[222:223], v235 offset:1024
    v_mfma_f32_16x16x32_bf16 v[4:7], v[208:211], a[60:63], v[4:7]
    s_add_u32 m0, s32, 98304
    v_add_u32 v235, 0xffff0000, v235
    v_mfma_f32_16x16x32_bf16 v[8:11], v[208:211], a[116:119], v[8:11]
    buffer_load_dwordx4 v204, s[44:47], s52 offen offset:0 lds
    v_mfma_f32_16x16x32_bf16 v[12:15], v[208:211], a[172:175], v[12:15]
    s_waitcnt lgkmcnt(4)
    v_mfma_f32_16x16x32_bf16 v[16:19], v[212:215], a[4:7], v[16:19]
    ds_read_b64_tr_b16 v[208:209], v236 offset:0
    ds_read_b64_tr_b16 v[210:211], v236 offset:1024
    v_mfma_f32_16x16x32_bf16 v[20:23], v[212:215], a[60:63], v[20:23]
    v_add_u32 v236, 0xffff0000, v236
    v_mfma_f32_16x16x32_bf16 v[24:27], v[212:215], a[116:119], v[24:27]
    buffer_load_dwordx4 v204, s[44:47], s53 offen offset:1024 lds
    v_mfma_f32_16x16x32_bf16 v[28:31], v[212:215], a[172:175], v[28:31]
    s_waitcnt lgkmcnt(4)
    v_mfma_f32_16x16x32_bf16 v[32:35], v[216:219], a[4:7], v[32:35]
    ds_read_b64_tr_b16 v[212:213], v237 offset:0
    ds_read_b64_tr_b16 v[214:215], v237 offset:1024
    v_mfma_f32_16x16x32_bf16 v[36:39], v[216:219], a[60:63], v[36:39]
    v_add_u32 v237, 0xffff0000, v237
    v_mfma_f32_16x16x32_bf16 v[40:43], v[216:219], a[116:119], v[40:43]
    buffer_load_dwordx4 v205, s[44:47], s54 offen offset:2048 lds
    v_mfma_f32_16x16x32_bf16 v[44:47], v[216:219], a[172:175], v[44:47]
    s_waitcnt lgkmcnt(4)
    v_mfma_f32_16x16x32_bf16 v[48:51], v[220:223], a[4:7], v[48:51]
    ds_read_b64_tr_b16 v[216:217], v238 offset:0
    ds_read_b64_tr_b16 v[218:219], v238 offset:1024
    v_mfma_f32_16x16x32_bf16 v[52:55], v[220:223], a[60:63], v[52:55]
    v_add_u32 v238, 0xffff0000, v238
    v_mfma_f32_16x16x32_bf16 v[56:59], v[220:223], a[116:119], v[56:59]
    buffer_load_dwordx4 v205, s[44:47], s55 offen offset:3072 lds
    v_mfma_f32_16x16x32_bf16 v[60:63], v[220:223], a[172:175], v[60:63]
    s_waitcnt lgkmcnt(4)
    v_mfma_f32_16x16x32_bf16 v[64:67], v[208:211], a[4:7], v[64:67]
    ds_read_b64_tr_b16 v[220:221], v239 offset:0
    ds_read_b64_tr_b16 v[222:223], v239 offset:1024
    v_mfma_f32_16x16x32_bf16 v[68:71], v[208:211], a[60:63], v[68:71]
    s_add_u32 m0, s32, 102400
    v_add_u32 v239, 0xffff0000, v239
    v_mfma_f32_16x16x32_bf16 v[72:75], v[208:211], a[116:119], v[72:75]
    buffer_load_dwordx4 v204, s[44:47], s56 offen offset:0 lds
    v_mfma_f32_16x16x32_bf16 v[76:79], v[208:211], a[172:175], v[76:79]
    s_waitcnt lgkmcnt(4)
    v_mfma_f32_16x16x32_bf16 v[80:83], v[212:215], a[4:7], v[80:83]
    s_waitcnt vmcnt(14)
    ds_read_b64_tr_b16 v[208:209], v232 offset:0
    ds_read_b64_tr_b16 v[210:211], v232 offset:1024
    v_mfma_f32_16x16x32_bf16 v[84:87], v[212:215], a[60:63], v[84:87]
    v_add_u32 v232, 0xffff8000, v232
    v_mfma_f32_16x16x32_bf16 v[88:91], v[212:215], a[116:119], v[88:91]
    buffer_load_dwordx4 v204, s[44:47], s57 offen offset:1024 lds
    v_mfma_f32_16x16x32_bf16 v[92:95], v[212:215], a[172:175], v[92:95]
    s_waitcnt lgkmcnt(4)
    v_mfma_f32_16x16x32_bf16 v[96:99], v[216:219], a[4:7], v[96:99]
    ds_read_b64_tr_b16 v[212:213], v233 offset:0
    ds_read_b64_tr_b16 v[214:215], v233 offset:1024
    v_mfma_f32_16x16x32_bf16 v[100:103], v[216:219], a[60:63], v[100:103]
    v_add_u32 v233, 0xffff8000, v233
    v_mfma_f32_16x16x32_bf16 v[104:107], v[216:219], a[116:119], v[104:107]
    buffer_load_dwordx4 v205, s[44:47], s58 offen offset:2048 lds
    v_mfma_f32_16x16x32_bf16 v[108:111], v[216:219], a[172:175], v[108:111]
    s_waitcnt lgkmcnt(4)
    v_mfma_f32_16x16x32_bf16 v[112:115], v[220:223], a[4:7], v[112:115]
    ds_read_b64_tr_b16 v[216:217], v234 offset:0
    ds_read_b64_tr_b16 v[218:219], v234 offset:1024
    v_mfma_f32_16x16x32_bf16 v[116:119], v[220:223], a[60:63], v[116:119]
    v_add_u32 v234, 0xffff8000, v234
    v_mfma_f32_16x16x32_bf16 v[120:123], v[220:223], a[116:119], v[120:123]
    buffer_load_dwordx4 v205, s[44:47], s59 offen offset:3072 lds
    v_mfma_f32_16x16x32_bf16 v[124:127], v[220:223], a[172:175], v[124:127]
    s_waitcnt lgkmcnt(4)
    v_add_u32 v204, 0x40000, v204
    v_add_u32 v205, 0x40000, v205
    v_mfma_f32_16x16x32_bf16 v[0:3], v[208:211], a[8:11], v[0:3]
    ds_read_b64_tr_b16 v[220:221], v235 offset:0
    ds_read_b64_tr_b16 v[222:223], v235 offset:1024
    v_mfma_f32_16x16x32_bf16 v[4:7], v[208:211], a[64:67], v[4:7]
    s_add_u32 m0, s32, 131072
    v_add_u32 v235, 0xffff8000, v235
    v_mfma_f32_16x16x32_bf16 v[8:11], v[208:211], a[120:123], v[8:11]
    buffer_load_dwordx4 v204, s[44:47], s52 offen offset:0 lds
    v_mfma_f32_16x16x32_bf16 v[12:15], v[208:211], a[176:179], v[12:15]
    s_waitcnt lgkmcnt(4)
    v_mfma_f32_16x16x32_bf16 v[16:19], v[212:215], a[8:11], v[16:19]
    ds_read_b64_tr_b16 v[208:209], v236 offset:0
    ds_read_b64_tr_b16 v[210:211], v236 offset:1024
    v_mfma_f32_16x16x32_bf16 v[20:23], v[212:215], a[64:67], v[20:23]
    v_add_u32 v236, 0xffff8000, v236
    v_mfma_f32_16x16x32_bf16 v[24:27], v[212:215], a[120:123], v[24:27]
    buffer_load_dwordx4 v204, s[44:47], s53 offen offset:1024 lds
    v_mfma_f32_16x16x32_bf16 v[28:31], v[212:215], a[176:179], v[28:31]
    s_waitcnt lgkmcnt(4)
    v_mfma_f32_16x16x32_bf16 v[32:35], v[216:219], a[8:11], v[32:35]
    ds_read_b64_tr_b16 v[212:213], v237 offset:0
    ds_read_b64_tr_b16 v[214:215], v237 offset:1024
    v_mfma_f32_16x16x32_bf16 v[36:39], v[216:219], a[64:67], v[36:39]
    v_add_u32 v237, 0xffff8000, v237
    v_mfma_f32_16x16x32_bf16 v[40:43], v[216:219], a[120:123], v[40:43]
    buffer_load_dwordx4 v205, s[44:47], s54 offen offset:2048 lds
    v_mfma_f32_16x16x32_bf16 v[44:47], v[216:219], a[176:179], v[44:47]
    s_waitcnt lgkmcnt(4)
    v_mfma_f32_16x16x32_bf16 v[48:51], v[220:223], a[8:11], v[48:51]
    ds_read_b64_tr_b16 v[216:217], v238 offset:0
    ds_read_b64_tr_b16 v[218:219], v238 offset:1024
    v_mfma_f32_16x16x32_bf16 v[52:55], v[220:223], a[64:67], v[52:55]
    v_add_u32 v238, 0xffff8000, v238
    v_mfma_f32_16x16x32_bf16 v[56:59], v[220:223], a[120:123], v[56:59]
    buffer_load_dwordx4 v205, s[44:47], s55 offen offset:3072 lds
    v_mfma_f32_16x16x32_bf16 v[60:63], v[220:223], a[176:179], v[60:63]
    s_waitcnt lgkmcnt(4)
    v_mfma_f32_16x16x32_bf16 v[64:67], v[208:211], a[8:11], v[64:67]
    ds_read_b64_tr_b16 v[220:221], v239 offset:0
    ds_read_b64_tr_b16 v[222:223], v239 offset:1024
    v_mfma_f32_16x16x32_bf16 v[68:71], v[208:211], a[64:67], v[68:71]
    s_add_u32 m0, s32, 135168
    v_add_u32 v239, 0xffff8000, v239
    v_mfma_f32_16x16x32_bf16 v[72:75], v[208:211], a[120:123], v[72:75]
    buffer_load_dwordx4 v204, s[44:47], s56 offen offset:0 lds
    v_mfma_f32_16x16x32_bf16 v[76:79], v[208:211], a[176:179], v[76:79]
    s_waitcnt lgkmcnt(4)
    v_mfma_f32_16x16x32_bf16 v[80:83], v[212:215], a[8:11], v[80:83]
    s_waitcnt vmcnt(13)
    ds_read_b64_tr_b16 v[208:209], v232 offset:0
    ds_read_b64_tr_b16 v[210:211], v232 offset:1024
    v_mfma_f32_16x16x32_bf16 v[84:87], v[212:215], a[64:67], v[84:87]
    v_add_u32 v232, 0x10000, v232
    v_mfma_f32_16x16x32_bf16 v[88:91], v[212:215], a[120:123], v[88:91]
    buffer_load_dwordx4 v204, s[44:47], s57 offen offset:1024 lds
    v_mfma_f32_16x16x32_bf16 v[92:95], v[212:215], a[176:179], v[92:95]
    s_waitcnt lgkmcnt(4)
    v_mfma_f32_16x16x32_bf16 v[96:99], v[216:219], a[8:11], v[96:99]
    ds_read_b64_tr_b16 v[212:213], v233 offset:0
    ds_read_b64_tr_b16 v[214:215], v233 offset:1024
    v_mfma_f32_16x16x32_bf16 v[100:103], v[216:219], a[64:67], v[100:103]
    v_add_u32 v233, 0x10000, v233
    v_mfma_f32_16x16x32_bf16 v[104:107], v[216:219], a[120:123], v[104:107]
    buffer_load_dwordx4 v205, s[44:47], s58 offen offset:2048 lds
    v_mfma_f32_16x16x32_bf16 v[108:111], v[216:219], a[176:179], v[108:111]
    s_waitcnt lgkmcnt(4)
    v_mfma_f32_16x16x32_bf16 v[112:115], v[220:223], a[8:11], v[112:115]
    ds_read_b64_tr_b16 v[216:217], v234 offset:0
    ds_read_b64_tr_b16 v[218:219], v234 offset:1024
    v_mfma_f32_16x16x32_bf16 v[116:119], v[220:223], a[64:67], v[116:119]
    v_add_u32 v234, 0x10000, v234
    v_mfma_f32_16x16x32_bf16 v[120:123], v[220:223], a[120:123], v[120:123]
    buffer_load_dwordx4 v205, s[44:47], s59 offen offset:3072 lds
    v_mfma_f32_16x16x32_bf16 v[124:127], v[220:223], a[176:179], v[124:127]
    s_waitcnt lgkmcnt(4)
    v_add_u32 v204, 0x40000, v204
    v_add_u32 v205, 0x40000, v205
    v_mfma_f32_16x16x32_bf16 v[0:3], v[208:211], a[12:15], v[0:3]
    ds_read_b64_tr_b16 v[220:221], v235 offset:0
    ds_read_b64_tr_b16 v[222:223], v235 offset:1024
    v_mfma_f32_16x16x32_bf16 v[4:7], v[208:211], a[68:71], v[4:7]
    s_add_u32 m0, s32, 65536
    v_add_u32 v235, 0x10000, v235
    v_mfma_f32_16x16x32_bf16 v[8:11], v[208:211], a[124:127], v[8:11]
    buffer_load_dwordx4 v204, s[44:47], s52 offen offset:0 lds
    v_mfma_f32_16x16x32_bf16 v[12:15], v[208:211], a[180:183], v[12:15]
    s_waitcnt lgkmcnt(4)
    v_mfma_f32_16x16x32_bf16 v[16:19], v[212:215], a[12:15], v[16:19]
    ds_read_b64_tr_b16 v[208:209], v236 offset:0
    ds_read_b64_tr_b16 v[210:211], v236 offset:1024
    v_mfma_f32_16x16x32_bf16 v[20:23], v[212:215], a[68:71], v[20:23]
    v_add_u32 v236, 0x10000, v236
    v_mfma_f32_16x16x32_bf16 v[24:27], v[212:215], a[124:127], v[24:27]
    buffer_load_dwordx4 v204, s[44:47], s53 offen offset:1024 lds
    v_mfma_f32_16x16x32_bf16 v[28:31], v[212:215], a[180:183], v[28:31]
    s_waitcnt lgkmcnt(4)
    v_mfma_f32_16x16x32_bf16 v[32:35], v[216:219], a[12:15], v[32:35]
    ds_read_b64_tr_b16 v[212:213], v237 offset:0
    ds_read_b64_tr_b16 v[214:215], v237 offset:1024
    v_mfma_f32_16x16x32_bf16 v[36:39], v[216:219], a[68:71], v[36:39]
    v_add_u32 v237, 0x10000, v237
    v_mfma_f32_16x16x32_bf16 v[40:43], v[216:219], a[124:127], v[40:43]
    buffer_load_dwordx4 v205, s[44:47], s54 offen offset:2048 lds
    v_mfma_f32_16x16x32_bf16 v[44:47], v[216:219], a[180:183], v[44:47]
    s_waitcnt lgkmcnt(4)
    v_mfma_f32_16x16x32_bf16 v[48:51], v[220:223], a[12:15], v[48:51]
    ds_read_b64_tr_b16 v[216:217], v238 offset:0
    ds_read_b64_tr_b16 v[218:219], v238 offset:1024
    v_mfma_f32_16x16x32_bf16 v[52:55], v[220:223], a[68:71], v[52:55]
    v_add_u32 v238, 0x10000, v238
    v_mfma_f32_16x16x32_bf16 v[56:59], v[220:223], a[124:127], v[56:59]
    buffer_load_dwordx4 v205, s[44:47], s55 offen offset:3072 lds
    v_mfma_f32_16x16x32_bf16 v[60:63], v[220:223], a[180:183], v[60:63]
    s_waitcnt lgkmcnt(4)
    v_mfma_f32_16x16x32_bf16 v[64:67], v[208:211], a[12:15], v[64:67]
    ds_read_b64_tr_b16 v[220:221], v239 offset:0
    ds_read_b64_tr_b16 v[222:223], v239 offset:1024
    v_mfma_f32_16x16x32_bf16 v[68:71], v[208:211], a[68:71], v[68:71]
    s_add_u32 m0, s32, 69632
    v_add_u32 v239, 0x10000, v239
    v_mfma_f32_16x16x32_bf16 v[72:75], v[208:211], a[124:127], v[72:75]
    buffer_load_dwordx4 v204, s[44:47], s56 offen offset:0 lds
    v_mfma_f32_16x16x32_bf16 v[76:79], v[208:211], a[180:183], v[76:79]
    s_waitcnt lgkmcnt(4)
    v_mfma_f32_16x16x32_bf16 v[80:83], v[212:215], a[12:15], v[80:83]
    s_waitcnt vmcnt(13)
    ds_read_b64_tr_b16 v[208:209], v232 offset:0
    ds_read_b64_tr_b16 v[210:211], v232 offset:1024
    v_mfma_f32_16x16x32_bf16 v[84:87], v[212:215], a[68:71], v[84:87]
    v_add_u32 v232, 0x8000, v232
    v_mfma_f32_16x16x32_bf16 v[88:91], v[212:215], a[124:127], v[88:91]
    buffer_load_dwordx4 v204, s[44:47], s57 offen offset:1024 lds
    v_mfma_f32_16x16x32_bf16 v[92:95], v[212:215], a[180:183], v[92:95]
    s_waitcnt lgkmcnt(4)
    v_mfma_f32_16x16x32_bf16 v[96:99], v[216:219], a[12:15], v[96:99]
    ds_read_b64_tr_b16 v[212:213], v233 offset:0
    ds_read_b64_tr_b16 v[214:215], v233 offset:1024
    v_mfma_f32_16x16x32_bf16 v[100:103], v[216:219], a[68:71], v[100:103]
    v_add_u32 v233, 0x8000, v233
    v_mfma_f32_16x16x32_bf16 v[104:107], v[216:219], a[124:127], v[104:107]
    buffer_load_dwordx4 v205, s[44:47], s58 offen offset:2048 lds
    v_mfma_f32_16x16x32_bf16 v[108:111], v[216:219], a[180:183], v[108:111]
    s_waitcnt lgkmcnt(4)
    v_mfma_f32_16x16x32_bf16 v[112:115], v[220:223], a[12:15], v[112:115]
    ds_read_b64_tr_b16 v[216:217], v234 offset:0
    ds_read_b64_tr_b16 v[218:219], v234 offset:1024
    v_mfma_f32_16x16x32_bf16 v[116:119], v[220:223], a[68:71], v[116:119]
    v_add_u32 v234, 0x8000, v234
    v_mfma_f32_16x16x32_bf16 v[120:123], v[220:223], a[124:127], v[120:123]
    buffer_load_dwordx4 v205, s[44:47], s59 offen offset:3072 lds
    v_mfma_f32_16x16x32_bf16 v[124:127], v[220:223], a[180:183], v[124:127]
    s_waitcnt lgkmcnt(4)
    v_add_u32 v204, 0x40000, v204
    v_add_u32 v205, 0x40000, v205
    v_mfma_f32_16x16x32_bf16 v[0:3], v[208:211], a[16:19], v[0:3]
    ds_read_b64_tr_b16 v[220:221], v235 offset:0
    ds_read_b64_tr_b16 v[222:223], v235 offset:1024
    v_mfma_f32_16x16x32_bf16 v[4:7], v[208:211], a[72:75], v[4:7]
    s_add_u32 m0, s32, 32768
    v_add_u32 v235, 0x8000, v235
    v_mfma_f32_16x16x32_bf16 v[8:11], v[208:211], a[128:131], v[8:11]
    buffer_load_dwordx4 v204, s[44:47], s52 offen offset:0 lds
    v_mfma_f32_16x16x32_bf16 v[12:15], v[208:211], a[184:187], v[12:15]
    s_waitcnt lgkmcnt(4)
    v_mfma_f32_16x16x32_bf16 v[16:19], v[212:215], a[16:19], v[16:19]
    ds_read_b64_tr_b16 v[208:209], v236 offset:0
    ds_read_b64_tr_b16 v[210:211], v236 offset:1024
    v_mfma_f32_16x16x32_bf16 v[20:23], v[212:215], a[72:75], v[20:23]
    v_add_u32 v236, 0x8000, v236
    v_mfma_f32_16x16x32_bf16 v[24:27], v[212:215], a[128:131], v[24:27]
    buffer_load_dwordx4 v204, s[44:47], s53 offen offset:1024 lds
    v_mfma_f32_16x16x32_bf16 v[28:31], v[212:215], a[184:187], v[28:31]
    s_waitcnt lgkmcnt(4)
    v_mfma_f32_16x16x32_bf16 v[32:35], v[216:219], a[16:19], v[32:35]
    ds_read_b64_tr_b16 v[212:213], v237 offset:0
    ds_read_b64_tr_b16 v[214:215], v237 offset:1024
    v_mfma_f32_16x16x32_bf16 v[36:39], v[216:219], a[72:75], v[36:39]
    v_add_u32 v237, 0x8000, v237
    v_mfma_f32_16x16x32_bf16 v[40:43], v[216:219], a[128:131], v[40:43]
    buffer_load_dwordx4 v205, s[44:47], s54 offen offset:2048 lds
    v_mfma_f32_16x16x32_bf16 v[44:47], v[216:219], a[184:187], v[44:47]
    s_waitcnt lgkmcnt(4)
    v_mfma_f32_16x16x32_bf16 v[48:51], v[220:223], a[16:19], v[48:51]
    ds_read_b64_tr_b16 v[216:217], v238 offset:0
    ds_read_b64_tr_b16 v[218:219], v238 offset:1024
    v_mfma_f32_16x16x32_bf16 v[52:55], v[220:223], a[72:75], v[52:55]
    v_add_u32 v238, 0x8000, v238
    v_mfma_f32_16x16x32_bf16 v[56:59], v[220:223], a[128:131], v[56:59]
    buffer_load_dwordx4 v205, s[44:47], s55 offen offset:3072 lds
    v_mfma_f32_16x16x32_bf16 v[60:63], v[220:223], a[184:187], v[60:63]
    s_waitcnt lgkmcnt(4)
    v_mfma_f32_16x16x32_bf16 v[64:67], v[208:211], a[16:19], v[64:67]
    ds_read_b64_tr_b16 v[220:221], v239 offset:0
    ds_read_b64_tr_b16 v[222:223], v239 offset:1024
    v_mfma_f32_16x16x32_bf16 v[68:71], v[208:211], a[72:75], v[68:71]
    s_add_u32 m0, s32, 36864
    v_add_u32 v239, 0x8000, v239
    v_mfma_f32_16x16x32_bf16 v[72:75], v[208:211], a[128:131], v[72:75]
    buffer_load_dwordx4 v204, s[44:47], s56 offen offset:0 lds
    v_mfma_f32_16x16x32_bf16 v[76:79], v[208:211], a[184:187], v[76:79]
    s_waitcnt lgkmcnt(4)
    v_mfma_f32_16x16x32_bf16 v[80:83], v[212:215], a[16:19], v[80:83]
    s_waitcnt vmcnt(13)
    ds_read_b64_tr_b16 v[208:209], v232 offset:0
    ds_read_b64_tr_b16 v[210:211], v232 offset:1024
    v_mfma_f32_16x16x32_bf16 v[84:87], v[212:215], a[72:75], v[84:87]
    v_add_u32 v232, 0xffff0000, v232
    v_mfma_f32_16x16x32_bf16 v[88:91], v[212:215], a[128:131], v[88:91]
    buffer_load_dwordx4 v204, s[44:47], s57 offen offset:1024 lds
    v_mfma_f32_16x16x32_bf16 v[92:95], v[212:215], a[184:187], v[92:95]
    s_waitcnt lgkmcnt(4)
    v_mfma_f32_16x16x32_bf16 v[96:99], v[216:219], a[16:19], v[96:99]
    ds_read_b64_tr_b16 v[212:213], v233 offset:0
    ds_read_b64_tr_b16 v[214:215], v233 offset:1024
    v_mfma_f32_16x16x32_bf16 v[100:103], v[216:219], a[72:75], v[100:103]
    v_add_u32 v233, 0xffff0000, v233
    v_mfma_f32_16x16x32_bf16 v[104:107], v[216:219], a[128:131], v[104:107]
    buffer_load_dwordx4 v205, s[44:47], s58 offen offset:2048 lds
    v_mfma_f32_16x16x32_bf16 v[108:111], v[216:219], a[184:187], v[108:111]
    s_waitcnt lgkmcnt(4)
    v_mfma_f32_16x16x32_bf16 v[112:115], v[220:223], a[16:19], v[112:115]
    ds_read_b64_tr_b16 v[216:217], v234 offset:0
    ds_read_b64_tr_b16 v[218:219], v234 offset:1024
    v_mfma_f32_16x16x32_bf16 v[116:119], v[220:223], a[72:75], v[116:119]
    v_add_u32 v234, 0xffff0000, v234
    v_mfma_f32_16x16x32_bf16 v[120:123], v[220:223], a[128:131], v[120:123]
    buffer_load_dwordx4 v205, s[44:47], s59 offen offset:3072 lds
    v_mfma_f32_16x16x32_bf16 v[124:127], v[220:223], a[184:187], v[124:127]
    s_waitcnt lgkmcnt(4)
    v_add_u32 v204, 0x40000, v204
    v_add_u32 v205, 0x40000, v205
    v_mfma_f32_16x16x32_bf16 v[0:3], v[208:211], a[20:23], v[0:3]
    ds_read_b64_tr_b16 v[220:221], v235 offset:0
    ds_read_b64_tr_b16 v[222:223], v235 offset:1024
    v_mfma_f32_16x16x32_bf16 v[4:7], v[208:211], a[76:79], v[4:7]
    s_add_u32 m0, s32, 98304
    v_add_u32 v235, 0xffff0000, v235
    v_mfma_f32_16x16x32_bf16 v[8:11], v[208:211], a[132:135], v[8:11]
    buffer_load_dwordx4 v204, s[44:47], s52 offen offset:0 lds
    v_mfma_f32_16x16x32_bf16 v[12:15], v[208:211], a[188:191], v[12:15]
    s_waitcnt lgkmcnt(4)
    v_mfma_f32_16x16x32_bf16 v[16:19], v[212:215], a[20:23], v[16:19]
    ds_read_b64_tr_b16 v[208:209], v236 offset:0
    ds_read_b64_tr_b16 v[210:211], v236 offset:1024
    v_mfma_f32_16x16x32_bf16 v[20:23], v[212:215], a[76:79], v[20:23]
    v_add_u32 v236, 0xffff0000, v236
    v_mfma_f32_16x16x32_bf16 v[24:27], v[212:215], a[132:135], v[24:27]
    buffer_load_dwordx4 v204, s[44:47], s53 offen offset:1024 lds
    v_mfma_f32_16x16x32_bf16 v[28:31], v[212:215], a[188:191], v[28:31]
    s_waitcnt lgkmcnt(4)
    v_mfma_f32_16x16x32_bf16 v[32:35], v[216:219], a[20:23], v[32:35]
    ds_read_b64_tr_b16 v[212:213], v237 offset:0
    ds_read_b64_tr_b16 v[214:215], v237 offset:1024
    v_mfma_f32_16x16x32_bf16 v[36:39], v[216:219], a[76:79], v[36:39]
    v_add_u32 v237, 0xffff0000, v237
    v_mfma_f32_16x16x32_bf16 v[40:43], v[216:219], a[132:135], v[40:43]
    buffer_load_dwordx4 v205, s[44:47], s54 offen offset:2048 lds
    v_mfma_f32_16x16x32_bf16 v[44:47], v[216:219], a[188:191], v[44:47]
    s_waitcnt lgkmcnt(4)
    v_mfma_f32_16x16x32_bf16 v[48:51], v[220:223], a[20:23], v[48:51]
    ds_read_b64_tr_b16 v[216:217], v238 offset:0
    ds_read_b64_tr_b16 v[218:219], v238 offset:1024
    v_mfma_f32_16x16x32_bf16 v[52:55], v[220:223], a[76:79], v[52:55]
    v_add_u32 v238, 0xffff0000, v238
    v_mfma_f32_16x16x32_bf16 v[56:59], v[220:223], a[132:135], v[56:59]
    buffer_load_dwordx4 v205, s[44:47], s55 offen offset:3072 lds
    v_mfma_f32_16x16x32_bf16 v[60:63], v[220:223], a[188:191], v[60:63]
    s_waitcnt lgkmcnt(4)
    v_mfma_f32_16x16x32_bf16 v[64:67], v[208:211], a[20:23], v[64:67]
    ds_read_b64_tr_b16 v[220:221], v239 offset:0
    ds_read_b64_tr_b16 v[222:223], v239 offset:1024
    v_mfma_f32_16x16x32_bf16 v[68:71], v[208:211], a[76:79], v[68:71]
    s_add_u32 m0, s32, 102400
    v_add_u32 v239, 0xffff0000, v239
    v_mfma_f32_16x16x32_bf16 v[72:75], v[208:211], a[132:135], v[72:75]
    buffer_load_dwordx4 v204, s[44:47], s56 offen offset:0 lds
    v_mfma_f32_16x16x32_bf16 v[76:79], v[208:211], a[188:191], v[76:79]
    s_waitcnt lgkmcnt(4)
    v_mfma_f32_16x16x32_bf16 v[80:83], v[212:215], a[20:23], v[80:83]
    s_waitcnt vmcnt(13)
    ds_read_b64_tr_b16 v[208:209], v232 offset:0
    ds_read_b64_tr_b16 v[210:211], v232 offset:1024
    v_mfma_f32_16x16x32_bf16 v[84:87], v[212:215], a[76:79], v[84:87]
    v_add_u32 v232, 0xffff8000, v232
    v_mfma_f32_16x16x32_bf16 v[88:91], v[212:215], a[132:135], v[88:91]
    buffer_load_dwordx4 v204, s[44:47], s57 offen offset:1024 lds
    v_mfma_f32_16x16x32_bf16 v[92:95], v[212:215], a[188:191], v[92:95]
    s_waitcnt lgkmcnt(4)
    v_mfma_f32_16x16x32_bf16 v[96:99], v[216:219], a[20:23], v[96:99]
    ds_read_b64_tr_b16 v[212:213], v233 offset:0
    ds_read_b64_tr_b16 v[214:215], v233 offset:1024
    v_mfma_f32_16x16x32_bf16 v[100:103], v[216:219], a[76:79], v[100:103]
    v_add_u32 v233, 0xffff8000, v233
    v_mfma_f32_16x16x32_bf16 v[104:107], v[216:219], a[132:135], v[104:107]
    buffer_load_dwordx4 v205, s[44:47], s58 offen offset:2048 lds
    v_mfma_f32_16x16x32_bf16 v[108:111], v[216:219], a[188:191], v[108:111]
    s_waitcnt lgkmcnt(4)
    v_mfma_f32_16x16x32_bf16 v[112:115], v[220:223], a[20:23], v[112:115]
    ds_read_b64_tr_b16 v[216:217], v234 offset:0
    ds_read_b64_tr_b16 v[218:219], v234 offset:1024
    v_mfma_f32_16x16x32_bf16 v[116:119], v[220:223], a[76:79], v[116:119]
    v_add_u32 v234, 0xffff8000, v234
    v_mfma_f32_16x16x32_bf16 v[120:123], v[220:223], a[132:135], v[120:123]
    buffer_load_dwordx4 v205, s[44:47], s59 offen offset:3072 lds
    v_mfma_f32_16x16x32_bf16 v[124:127], v[220:223], a[188:191], v[124:127]
    s_waitcnt lgkmcnt(4)
    v_add_u32 v204, 0x40000, v204
    v_add_u32 v205, 0x40000, v205
    v_mfma_f32_16x16x32_bf16 v[0:3], v[208:211], a[24:27], v[0:3]
    ds_read_b64_tr_b16 v[220:221], v235 offset:0
    ds_read_b64_tr_b16 v[222:223], v235 offset:1024
    v_mfma_f32_16x16x32_bf16 v[4:7], v[208:211], a[80:83], v[4:7]
    s_add_u32 m0, s32, 131072
    v_add_u32 v235, 0xffff8000, v235
    v_mfma_f32_16x16x32_bf16 v[8:11], v[208:211], a[136:139], v[8:11]
    buffer_load_dwordx4 v204, s[44:47], s52 offen offset:0 lds
    v_mfma_f32_16x16x32_bf16 v[12:15], v[208:211], a[192:195], v[12:15]
    s_waitcnt lgkmcnt(4)
    v_mfma_f32_16x16x32_bf16 v[16:19], v[212:215], a[24:27], v[16:19]
    ds_read_b64_tr_b16 v[208:209], v236 offset:0
    ds_read_b64_tr_b16 v[210:211], v236 offset:1024
    v_mfma_f32_16x16x32_bf16 v[20:23], v[212:215], a[80:83], v[20:23]
    v_add_u32 v236, 0xffff8000, v236
    v_mfma_f32_16x16x32_bf16 v[24:27], v[212:215], a[136:139], v[24:27]
    buffer_load_dwordx4 v204, s[44:47], s53 offen offset:1024 lds
    v_mfma_f32_16x16x32_bf16 v[28:31], v[212:215], a[192:195], v[28:31]
    s_waitcnt lgkmcnt(4)
    v_mfma_f32_16x16x32_bf16 v[32:35], v[216:219], a[24:27], v[32:35]
    ds_read_b64_tr_b16 v[212:213], v237 offset:0
    ds_read_b64_tr_b16 v[214:215], v237 offset:1024
    v_mfma_f32_16x16x32_bf16 v[36:39], v[216:219], a[80:83], v[36:39]
    v_add_u32 v237, 0xffff8000, v237
    v_mfma_f32_16x16x32_bf16 v[40:43], v[216:219], a[136:139], v[40:43]
    buffer_load_dwordx4 v205, s[44:47], s54 offen offset:2048 lds
    v_mfma_f32_16x16x32_bf16 v[44:47], v[216:219], a[192:195], v[44:47]
    s_waitcnt lgkmcnt(4)
    v_mfma_f32_16x16x32_bf16 v[48:51], v[220:223], a[24:27], v[48:51]
    ds_read_b64_tr_b16 v[216:217], v238 offset:0
    ds_read_b64_tr_b16 v[218:219], v238 offset:1024
    v_mfma_f32_16x16x32_bf16 v[52:55], v[220:223], a[80:83], v[52:55]
    v_add_u32 v238, 0xffff8000, v238
    v_mfma_f32_16x16x32_bf16 v[56:59], v[220:223], a[136:139], v[56:59]
    buffer_load_dwordx4 v205, s[44:47], s55 offen offset:3072 lds
    v_mfma_f32_16x16x32_bf16 v[60:63], v[220:223], a[192:195], v[60:63]
    s_waitcnt lgkmcnt(4)
    v_mfma_f32_16x16x32_bf16 v[64:67], v[208:211], a[24:27], v[64:67]
    ds_read_b64_tr_b16 v[220:221], v239 offset:0
    ds_read_b64_tr_b16 v[222:223], v239 offset:1024
    v_mfma_f32_16x16x32_bf16 v[68:71], v[208:211], a[80:83], v[68:71]
    s_add_u32 m0, s32, 135168
    v_add_u32 v239, 0xffff8000, v239
    v_mfma_f32_16x16x32_bf16 v[72:75], v[208:211], a[136:139], v[72:75]
    buffer_load_dwordx4 v204, s[44:47], s56 offen offset:0 lds
    v_mfma_f32_16x16x32_bf16 v[76:79], v[208:211], a[192:195], v[76:79]
    s_waitcnt lgkmcnt(4)
    v_mfma_f32_16x16x32_bf16 v[80:83], v[212:215], a[24:27], v[80:83]
    s_waitcnt vmcnt(13)
    ds_read_b64_tr_b16 v[208:209], v232 offset:0
    ds_read_b64_tr_b16 v[210:211], v232 offset:1024
    v_mfma_f32_16x16x32_bf16 v[84:87], v[212:215], a[80:83], v[84:87]
    v_add_u32 v232, 0x10000, v232
    v_mfma_f32_16x16x32_bf16 v[88:91], v[212:215], a[136:139], v[88:91]
    buffer_load_dwordx4 v204, s[44:47], s57 offen offset:1024 lds
    v_mfma_f32_16x16x32_bf16 v[92:95], v[212:215], a[192:195], v[92:95]
    s_waitcnt lgkmcnt(4)
    v_mfma_f32_16x16x32_bf16 v[96:99], v[216:219], a[24:27], v[96:99]
    ds_read_b64_tr_b16 v[212:213], v233 offset:0
    ds_read_b64_tr_b16 v[214:215], v233 offset:1024
    v_mfma_f32_16x16x32_bf16 v[100:103], v[216:219], a[80:83], v[100:103]
    v_add_u32 v233, 0x10000, v233
    v_mfma_f32_16x16x32_bf16 v[104:107], v[216:219], a[136:139], v[104:107]
    buffer_load_dwordx4 v205, s[44:47], s58 offen offset:2048 lds
    v_mfma_f32_16x16x32_bf16 v[108:111], v[216:219], a[192:195], v[108:111]
    s_waitcnt lgkmcnt(4)
    v_mfma_f32_16x16x32_bf16 v[112:115], v[220:223], a[24:27], v[112:115]
    ds_read_b64_tr_b16 v[216:217], v234 offset:0
    ds_read_b64_tr_b16 v[218:219], v234 offset:1024
    v_mfma_f32_16x16x32_bf16 v[116:119], v[220:223], a[80:83], v[116:119]
    v_add_u32 v234, 0x10000, v234
    v_mfma_f32_16x16x32_bf16 v[120:123], v[220:223], a[136:139], v[120:123]
    buffer_load_dwordx4 v205, s[44:47], s59 offen offset:3072 lds
    v_mfma_f32_16x16x32_bf16 v[124:127], v[220:223], a[192:195], v[124:127]
    s_waitcnt lgkmcnt(4)
    v_add_u32 v204, 0x40000, v204
    v_add_u32 v205, 0x40000, v205
    v_mfma_f32_16x16x32_bf16 v[0:3], v[208:211], a[28:31], v[0:3]
    ds_read_b64_tr_b16 v[220:221], v235 offset:0
    ds_read_b64_tr_b16 v[222:223], v235 offset:1024
    v_mfma_f32_16x16x32_bf16 v[4:7], v[208:211], a[84:87], v[4:7]
    s_add_u32 m0, s32, 65536
    v_add_u32 v235, 0x10000, v235
    v_mfma_f32_16x16x32_bf16 v[8:11], v[208:211], a[140:143], v[8:11]
    buffer_load_dwordx4 v204, s[44:47], s52 offen offset:0 lds
    v_mfma_f32_16x16x32_bf16 v[12:15], v[208:211], a[196:199], v[12:15]
    s_waitcnt lgkmcnt(4)
    v_mfma_f32_16x16x32_bf16 v[16:19], v[212:215], a[28:31], v[16:19]
    ds_read_b64_tr_b16 v[208:209], v236 offset:0
    ds_read_b64_tr_b16 v[210:211], v236 offset:1024
    v_mfma_f32_16x16x32_bf16 v[20:23], v[212:215], a[84:87], v[20:23]
    v_add_u32 v236, 0x10000, v236
    v_mfma_f32_16x16x32_bf16 v[24:27], v[212:215], a[140:143], v[24:27]
    buffer_load_dwordx4 v204, s[44:47], s53 offen offset:1024 lds
    v_mfma_f32_16x16x32_bf16 v[28:31], v[212:215], a[196:199], v[28:31]
    s_waitcnt lgkmcnt(4)
    v_mfma_f32_16x16x32_bf16 v[32:35], v[216:219], a[28:31], v[32:35]
    ds_read_b64_tr_b16 v[212:213], v237 offset:0
    ds_read_b64_tr_b16 v[214:215], v237 offset:1024
    v_mfma_f32_16x16x32_bf16 v[36:39], v[216:219], a[84:87], v[36:39]
    v_add_u32 v237, 0x10000, v237
    v_mfma_f32_16x16x32_bf16 v[40:43], v[216:219], a[140:143], v[40:43]
    buffer_load_dwordx4 v205, s[44:47], s54 offen offset:2048 lds
    v_mfma_f32_16x16x32_bf16 v[44:47], v[216:219], a[196:199], v[44:47]
    s_waitcnt lgkmcnt(4)
    v_mfma_f32_16x16x32_bf16 v[48:51], v[220:223], a[28:31], v[48:51]
    ds_read_b64_tr_b16 v[216:217], v238 offset:0
    ds_read_b64_tr_b16 v[218:219], v238 offset:1024
    v_mfma_f32_16x16x32_bf16 v[52:55], v[220:223], a[84:87], v[52:55]
    v_add_u32 v238, 0x10000, v238
    v_mfma_f32_16x16x32_bf16 v[56:59], v[220:223], a[140:143], v[56:59]
    buffer_load_dwordx4 v205, s[44:47], s55 offen offset:3072 lds
    v_mfma_f32_16x16x32_bf16 v[60:63], v[220:223], a[196:199], v[60:63]
    s_waitcnt lgkmcnt(4)
    v_mfma_f32_16x16x32_bf16 v[64:67], v[208:211], a[28:31], v[64:67]
    ds_read_b64_tr_b16 v[220:221], v239 offset:0
    ds_read_b64_tr_b16 v[222:223], v239 offset:1024
    v_mfma_f32_16x16x32_bf16 v[68:71], v[208:211], a[84:87], v[68:71]
    s_add_u32 m0, s32, 69632
    v_add_u32 v239, 0x10000, v239
    v_mfma_f32_16x16x32_bf16 v[72:75], v[208:211], a[140:143], v[72:75]
    buffer_load_dwordx4 v204, s[44:47], s56 offen offset:0 lds
    v_mfma_f32_16x16x32_bf16 v[76:79], v[208:211], a[196:199], v[76:79]
    s_waitcnt lgkmcnt(4)
    v_mfma_f32_16x16x32_bf16 v[80:83], v[212:215], a[28:31], v[80:83]
    s_waitcnt vmcnt(13)
    ds_read_b64_tr_b16 v[208:209], v232 offset:0
    ds_read_b64_tr_b16 v[210:211], v232 offset:1024
    v_mfma_f32_16x16x32_bf16 v[84:87], v[212:215], a[84:87], v[84:87]
    v_add_u32 v232, 0x8000, v232
    v_mfma_f32_16x16x32_bf16 v[88:91], v[212:215], a[140:143], v[88:91]
    buffer_load_dwordx4 v204, s[44:47], s57 offen offset:1024 lds
    v_mfma_f32_16x16x32_bf16 v[92:95], v[212:215], a[196:199], v[92:95]
    s_waitcnt lgkmcnt(4)
    v_mfma_f32_16x16x32_bf16 v[96:99], v[216:219], a[28:31], v[96:99]
    ds_read_b64_tr_b16 v[212:213], v233 offset:0
    ds_read_b64_tr_b16 v[214:215], v233 offset:1024
    v_mfma_f32_16x16x32_bf16 v[100:103], v[216:219], a[84:87], v[100:103]
    v_add_u32 v233, 0x8000, v233
    v_mfma_f32_16x16x32_bf16 v[104:107], v[216:219], a[140:143], v[104:107]
    buffer_load_dwordx4 v205, s[44:47], s58 offen offset:2048 lds
    v_mfma_f32_16x16x32_bf16 v[108:111], v[216:219], a[196:199], v[108:111]
    s_waitcnt lgkmcnt(4)
    v_mfma_f32_16x16x32_bf16 v[112:115], v[220:223], a[28:31], v[112:115]
    ds_read_b64_tr_b16 v[216:217], v234 offset:0
    ds_read_b64_tr_b16 v[218:219], v234 offset:1024
    v_mfma_f32_16x16x32_bf16 v[116:119], v[220:223], a[84:87], v[116:119]
    v_add_u32 v234, 0x8000, v234
    v_mfma_f32_16x16x32_bf16 v[120:123], v[220:223], a[140:143], v[120:123]
    buffer_load_dwordx4 v205, s[44:47], s59 offen offset:3072 lds
    v_mfma_f32_16x16x32_bf16 v[124:127], v[220:223], a[196:199], v[124:127]
    s_waitcnt lgkmcnt(4)
    v_add_u32 v204, 0x40000, v204
    v_add_u32 v205, 0x40000, v205
    v_mfma_f32_16x16x32_bf16 v[0:3], v[208:211], a[32:35], v[0:3]
    ds_read_b64_tr_b16 v[220:221], v235 offset:0
    ds_read_b64_tr_b16 v[222:223], v235 offset:1024
    v_mfma_f32_16x16x32_bf16 v[4:7], v[208:211], a[88:91], v[4:7]
    s_add_u32 m0, s32, 32768
    v_add_u32 v235, 0x8000, v235
    v_mfma_f32_16x16x32_bf16 v[8:11], v[208:211], a[144:147], v[8:11]
    buffer_load_dwordx4 v204, s[44:47], s52 offen offset:0 lds
    v_mfma_f32_16x16x32_bf16 v[12:15], v[208:211], a[200:203], v[12:15]
    s_waitcnt lgkmcnt(4)
    v_mfma_f32_16x16x32_bf16 v[16:19], v[212:215], a[32:35], v[16:19]
    ds_read_b64_tr_b16 v[208:209], v236 offset:0
    ds_read_b64_tr_b16 v[210:211], v236 offset:1024
    v_mfma_f32_16x16x32_bf16 v[20:23], v[212:215], a[88:91], v[20:23]
    v_add_u32 v236, 0x8000, v236
    v_mfma_f32_16x16x32_bf16 v[24:27], v[212:215], a[144:147], v[24:27]
    buffer_load_dwordx4 v204, s[44:47], s53 offen offset:1024 lds
    v_mfma_f32_16x16x32_bf16 v[28:31], v[212:215], a[200:203], v[28:31]
    s_waitcnt lgkmcnt(4)
    v_mfma_f32_16x16x32_bf16 v[32:35], v[216:219], a[32:35], v[32:35]
    ds_read_b64_tr_b16 v[212:213], v237 offset:0
    ds_read_b64_tr_b16 v[214:215], v237 offset:1024
    v_mfma_f32_16x16x32_bf16 v[36:39], v[216:219], a[88:91], v[36:39]
    v_add_u32 v237, 0x8000, v237
    v_mfma_f32_16x16x32_bf16 v[40:43], v[216:219], a[144:147], v[40:43]
    buffer_load_dwordx4 v205, s[44:47], s54 offen offset:2048 lds
    v_mfma_f32_16x16x32_bf16 v[44:47], v[216:219], a[200:203], v[44:47]
    s_waitcnt lgkmcnt(4)
    v_mfma_f32_16x16x32_bf16 v[48:51], v[220:223], a[32:35], v[48:51]
    ds_read_b64_tr_b16 v[216:217], v238 offset:0
    ds_read_b64_tr_b16 v[218:219], v238 offset:1024
    v_mfma_f32_16x16x32_bf16 v[52:55], v[220:223], a[88:91], v[52:55]
    v_add_u32 v238, 0x8000, v238
    v_mfma_f32_16x16x32_bf16 v[56:59], v[220:223], a[144:147], v[56:59]
    buffer_load_dwordx4 v205, s[44:47], s55 offen offset:3072 lds
    v_mfma_f32_16x16x32_bf16 v[60:63], v[220:223], a[200:203], v[60:63]
    s_waitcnt lgkmcnt(4)
    v_mfma_f32_16x16x32_bf16 v[64:67], v[208:211], a[32:35], v[64:67]
    ds_read_b64_tr_b16 v[220:221], v239 offset:0
    ds_read_b64_tr_b16 v[222:223], v239 offset:1024
    v_mfma_f32_16x16x32_bf16 v[68:71], v[208:211], a[88:91], v[68:71]
    s_add_u32 m0, s32, 36864
    v_add_u32 v239, 0x8000, v239
    v_mfma_f32_16x16x32_bf16 v[72:75], v[208:211], a[144:147], v[72:75]
    buffer_load_dwordx4 v204, s[44:47], s56 offen offset:0 lds
    v_mfma_f32_16x16x32_bf16 v[76:79], v[208:211], a[200:203], v[76:79]
    s_waitcnt lgkmcnt(4)
    v_mfma_f32_16x16x32_bf16 v[80:83], v[212:215], a[32:35], v[80:83]
    s_waitcnt vmcnt(13)
    ds_read_b64_tr_b16 v[208:209], v232 offset:0
    ds_read_b64_tr_b16 v[210:211], v232 offset:1024
    v_mfma_f32_16x16x32_bf16 v[84:87], v[212:215], a[88:91], v[84:87]
    v_add_u32 v232, 0xffff0000, v232
    v_mfma_f32_16x16x32_bf16 v[88:91], v[212:215], a[144:147], v[88:91]
    buffer_load_dwordx4 v204, s[44:47], s57 offen offset:1024 lds
    v_mfma_f32_16x16x32_bf16 v[92:95], v[212:215], a[200:203], v[92:95]
    s_waitcnt lgkmcnt(4)
    v_mfma_f32_16x16x32_bf16 v[96:99], v[216:219], a[32:35], v[96:99]
    ds_read_b64_tr_b16 v[212:213], v233 offset:0
    ds_read_b64_tr_b16 v[214:215], v233 offset:1024
    v_mfma_f32_16x16x32_bf16 v[100:103], v[216:219], a[88:91], v[100:103]
    v_add_u32 v233, 0xffff0000, v233
    v_mfma_f32_16x16x32_bf16 v[104:107], v[216:219], a[144:147], v[104:107]
    buffer_load_dwordx4 v205, s[44:47], s58 offen offset:2048 lds
    v_mfma_f32_16x16x32_bf16 v[108:111], v[216:219], a[200:203], v[108:111]
    s_waitcnt lgkmcnt(4)
    v_mfma_f32_16x16x32_bf16 v[112:115], v[220:223], a[32:35], v[112:115]
    ds_read_b64_tr_b16 v[216:217], v234 offset:0
    ds_read_b64_tr_b16 v[218:219], v234 offset:1024
    v_mfma_f32_16x16x32_bf16 v[116:119], v[220:223], a[88:91], v[116:119]
    v_add_u32 v234, 0xffff0000, v234
    v_mfma_f32_16x16x32_bf16 v[120:123], v[220:223], a[144:147], v[120:123]
    buffer_load_dwordx4 v205, s[44:47], s59 offen offset:3072 lds
    v_mfma_f32_16x16x32_bf16 v[124:127], v[220:223], a[200:203], v[124:127]
    s_waitcnt lgkmcnt(4)
    v_add_u32 v204, 0x40000, v204
    v_add_u32 v205, 0x40000, v205
    v_mfma_f32_16x16x32_bf16 v[0:3], v[208:211], a[36:39], v[0:3]
    ds_read_b64_tr_b16 v[220:221], v235 offset:0
    ds_read_b64_tr_b16 v[222:223], v235 offset:1024
    v_mfma_f32_16x16x32_bf16 v[4:7], v[208:211], a[92:95], v[4:7]
    s_add_u32 m0, s32, 98304
    v_add_u32 v235, 0xffff0000, v235
    v_mfma_f32_16x16x32_bf16 v[8:11], v[208:211], a[148:151], v[8:11]
    buffer_load_dwordx4 v204, s[44:47], s52 offen offset:0 lds
    v_mfma_f32_16x16x32_bf16 v[12:15], v[208:211], a[204:207], v[12:15]
    s_waitcnt lgkmcnt(4)
    v_mfma_f32_16x16x32_bf16 v[16:19], v[212:215], a[36:39], v[16:19]
    ds_read_b64_tr_b16 v[208:209], v236 offset:0
    ds_read_b64_tr_b16 v[210:211], v236 offset:1024
    v_mfma_f32_16x16x32_bf16 v[20:23], v[212:215], a[92:95], v[20:23]
    v_add_u32 v236, 0xffff0000, v236
    v_mfma_f32_16x16x32_bf16 v[24:27], v[212:215], a[148:151], v[24:27]
    buffer_load_dwordx4 v204, s[44:47], s53 offen offset:1024 lds
    v_mfma_f32_16x16x32_bf16 v[28:31], v[212:215], a[204:207], v[28:31]
    s_waitcnt lgkmcnt(4)
    v_mfma_f32_16x16x32_bf16 v[32:35], v[216:219], a[36:39], v[32:35]
    ds_read_b64_tr_b16 v[212:213], v237 offset:0
    ds_read_b64_tr_b16 v[214:215], v237 offset:1024
    v_mfma_f32_16x16x32_bf16 v[36:39], v[216:219], a[92:95], v[36:39]
    v_add_u32 v237, 0xffff0000, v237
    v_mfma_f32_16x16x32_bf16 v[40:43], v[216:219], a[148:151], v[40:43]
    buffer_load_dwordx4 v205, s[44:47], s54 offen offset:2048 lds
    v_mfma_f32_16x16x32_bf16 v[44:47], v[216:219], a[204:207], v[44:47]
    s_waitcnt lgkmcnt(4)
    v_mfma_f32_16x16x32_bf16 v[48:51], v[220:223], a[36:39], v[48:51]
    ds_read_b64_tr_b16 v[216:217], v238 offset:0
    ds_read_b64_tr_b16 v[218:219], v238 offset:1024
    v_mfma_f32_16x16x32_bf16 v[52:55], v[220:223], a[92:95], v[52:55]
    v_add_u32 v238, 0xffff0000, v238
    v_mfma_f32_16x16x32_bf16 v[56:59], v[220:223], a[148:151], v[56:59]
    buffer_load_dwordx4 v205, s[44:47], s55 offen offset:3072 lds
    v_mfma_f32_16x16x32_bf16 v[60:63], v[220:223], a[204:207], v[60:63]
    s_waitcnt lgkmcnt(4)
    v_mfma_f32_16x16x32_bf16 v[64:67], v[208:211], a[36:39], v[64:67]
    ds_read_b64_tr_b16 v[220:221], v239 offset:0
    ds_read_b64_tr_b16 v[222:223], v239 offset:1024
    v_mfma_f32_16x16x32_bf16 v[68:71], v[208:211], a[92:95], v[68:71]
    s_add_u32 m0, s32, 102400
    v_add_u32 v239, 0xffff0000, v239
    v_mfma_f32_16x16x32_bf16 v[72:75], v[208:211], a[148:151], v[72:75]
    buffer_load_dwordx4 v204, s[44:47], s56 offen offset:0 lds
    v_mfma_f32_16x16x32_bf16 v[76:79], v[208:211], a[204:207], v[76:79]
    s_waitcnt lgkmcnt(4)
    v_mfma_f32_16x16x32_bf16 v[80:83], v[212:215], a[36:39], v[80:83]
    s_waitcnt vmcnt(13)
    ds_read_b64_tr_b16 v[208:209], v232 offset:0
    ds_read_b64_tr_b16 v[210:211], v232 offset:1024
    v_mfma_f32_16x16x32_bf16 v[84:87], v[212:215], a[92:95], v[84:87]
    v_add_u32 v232, 0xffff8000, v232
    v_mfma_f32_16x16x32_bf16 v[88:91], v[212:215], a[148:151], v[88:91]
    buffer_load_dwordx4 v204, s[44:47], s57 offen offset:1024 lds
    v_mfma_f32_16x16x32_bf16 v[92:95], v[212:215], a[204:207], v[92:95]
    s_waitcnt lgkmcnt(4)
    v_mfma_f32_16x16x32_bf16 v[96:99], v[216:219], a[36:39], v[96:99]
    ds_read_b64_tr_b16 v[212:213], v233 offset:0
    ds_read_b64_tr_b16 v[214:215], v233 offset:1024
    v_mfma_f32_16x16x32_bf16 v[100:103], v[216:219], a[92:95], v[100:103]
    v_add_u32 v233, 0xffff8000, v233
    v_mfma_f32_16x16x32_bf16 v[104:107], v[216:219], a[148:151], v[104:107]
    buffer_load_dwordx4 v205, s[44:47], s58 offen offset:2048 lds
    v_mfma_f32_16x16x32_bf16 v[108:111], v[216:219], a[204:207], v[108:111]
    s_waitcnt lgkmcnt(4)
    v_mfma_f32_16x16x32_bf16 v[112:115], v[220:223], a[36:39], v[112:115]
    ds_read_b64_tr_b16 v[216:217], v234 offset:0
    ds_read_b64_tr_b16 v[218:219], v234 offset:1024
    v_mfma_f32_16x16x32_bf16 v[116:119], v[220:223], a[92:95], v[116:119]
    v_add_u32 v234, 0xffff8000, v234
    v_mfma_f32_16x16x32_bf16 v[120:123], v[220:223], a[148:151], v[120:123]
    buffer_load_dwordx4 v205, s[44:47], s59 offen offset:3072 lds
    v_mfma_f32_16x16x32_bf16 v[124:127], v[220:223], a[204:207], v[124:127]
    s_waitcnt lgkmcnt(4)
    v_add_u32 v204, 0x40000, v204
    v_add_u32 v205, 0x40000, v205
    v_mfma_f32_16x16x32_bf16 v[0:3], v[208:211], a[40:43], v[0:3]
    ds_read_b64_tr_b16 v[220:221], v235 offset:0
    ds_read_b64_tr_b16 v[222:223], v235 offset:1024
    v_mfma_f32_16x16x32_bf16 v[4:7], v[208:211], a[96:99], v[4:7]
    s_add_u32 m0, s32, 131072
    v_add_u32 v235, 0xffff8000, v235
    v_mfma_f32_16x16x32_bf16 v[8:11], v[208:211], a[152:155], v[8:11]
    buffer_load_dwordx4 v204, s[44:47], s52 offen offset:0 lds
    v_mfma_f32_16x16x32_bf16 v[12:15], v[208:211], a[208:211], v[12:15]
    s_waitcnt lgkmcnt(4)
    v_mfma_f32_16x16x32_bf16 v[16:19], v[212:215], a[40:43], v[16:19]
    ds_read_b64_tr_b16 v[208:209], v236 offset:0
    ds_read_b64_tr_b16 v[210:211], v236 offset:1024
    v_mfma_f32_16x16x32_bf16 v[20:23], v[212:215], a[96:99], v[20:23]
    v_add_u32 v236, 0xffff8000, v236
    v_mfma_f32_16x16x32_bf16 v[24:27], v[212:215], a[152:155], v[24:27]
    buffer_load_dwordx4 v204, s[44:47], s53 offen offset:1024 lds
    v_mfma_f32_16x16x32_bf16 v[28:31], v[212:215], a[208:211], v[28:31]
    s_waitcnt lgkmcnt(4)
    v_mfma_f32_16x16x32_bf16 v[32:35], v[216:219], a[40:43], v[32:35]
    ds_read_b64_tr_b16 v[212:213], v237 offset:0
    ds_read_b64_tr_b16 v[214:215], v237 offset:1024
    v_mfma_f32_16x16x32_bf16 v[36:39], v[216:219], a[96:99], v[36:39]
    v_add_u32 v237, 0xffff8000, v237
    v_mfma_f32_16x16x32_bf16 v[40:43], v[216:219], a[152:155], v[40:43]
    buffer_load_dwordx4 v205, s[44:47], s54 offen offset:2048 lds
    v_mfma_f32_16x16x32_bf16 v[44:47], v[216:219], a[208:211], v[44:47]
    s_waitcnt lgkmcnt(4)
    v_mfma_f32_16x16x32_bf16 v[48:51], v[220:223], a[40:43], v[48:51]
    ds_read_b64_tr_b16 v[216:217], v238 offset:0
    ds_read_b64_tr_b16 v[218:219], v238 offset:1024
    v_mfma_f32_16x16x32_bf16 v[52:55], v[220:223], a[96:99], v[52:55]
    v_add_u32 v238, 0xffff8000, v238
    v_mfma_f32_16x16x32_bf16 v[56:59], v[220:223], a[152:155], v[56:59]
    buffer_load_dwordx4 v205, s[44:47], s55 offen offset:3072 lds
    v_mfma_f32_16x16x32_bf16 v[60:63], v[220:223], a[208:211], v[60:63]
    s_waitcnt lgkmcnt(4)
    v_mfma_f32_16x16x32_bf16 v[64:67], v[208:211], a[40:43], v[64:67]
    ds_read_b64_tr_b16 v[220:221], v239 offset:0
    ds_read_b64_tr_b16 v[222:223], v239 offset:1024
    v_mfma_f32_16x16x32_bf16 v[68:71], v[208:211], a[96:99], v[68:71]
    s_add_u32 m0, s32, 135168
    v_add_u32 v239, 0xffff8000, v239
    v_mfma_f32_16x16x32_bf16 v[72:75], v[208:211], a[152:155], v[72:75]
    buffer_load_dwordx4 v204, s[44:47], s56 offen offset:0 lds
    v_mfma_f32_16x16x32_bf16 v[76:79], v[208:211], a[208:211], v[76:79]
    s_waitcnt lgkmcnt(4)
    v_mfma_f32_16x16x32_bf16 v[80:83], v[212:215], a[40:43], v[80:83]
    s_waitcnt vmcnt(13)
    ds_read_b64_tr_b16 v[208:209], v232 offset:0
    ds_read_b64_tr_b16 v[210:211], v232 offset:1024
    v_mfma_f32_16x16x32_bf16 v[84:87], v[212:215], a[96:99], v[84:87]
    v_add_u32 v232, 0x10000, v232
    v_mfma_f32_16x16x32_bf16 v[88:91], v[212:215], a[152:155], v[88:91]
    buffer_load_dwordx4 v204, s[44:47], s57 offen offset:1024 lds
    v_mfma_f32_16x16x32_bf16 v[92:95], v[212:215], a[208:211], v[92:95]
    s_waitcnt lgkmcnt(4)
    v_mfma_f32_16x16x32_bf16 v[96:99], v[216:219], a[40:43], v[96:99]
    ds_read_b64_tr_b16 v[212:213], v233 offset:0
    ds_read_b64_tr_b16 v[214:215], v233 offset:1024
    v_mfma_f32_16x16x32_bf16 v[100:103], v[216:219], a[96:99], v[100:103]
    v_add_u32 v233, 0x10000, v233
    v_mfma_f32_16x16x32_bf16 v[104:107], v[216:219], a[152:155], v[104:107]
    buffer_load_dwordx4 v205, s[44:47], s58 offen offset:2048 lds
    v_mfma_f32_16x16x32_bf16 v[108:111], v[216:219], a[208:211], v[108:111]
    s_waitcnt lgkmcnt(4)
    v_mfma_f32_16x16x32_bf16 v[112:115], v[220:223], a[40:43], v[112:115]
    ds_read_b64_tr_b16 v[216:217], v234 offset:0
    ds_read_b64_tr_b16 v[218:219], v234 offset:1024
    v_mfma_f32_16x16x32_bf16 v[116:119], v[220:223], a[96:99], v[116:119]
    v_add_u32 v234, 0x10000, v234
    v_mfma_f32_16x16x32_bf16 v[120:123], v[220:223], a[152:155], v[120:123]
    buffer_load_dwordx4 v205, s[44:47], s59 offen offset:3072 lds
    v_mfma_f32_16x16x32_bf16 v[124:127], v[220:223], a[208:211], v[124:127]
    s_waitcnt lgkmcnt(4)
    v_add_u32 v204, 0x40000, v204
    v_add_u32 v205, 0x40000, v205
    v_mfma_f32_16x16x32_bf16 v[0:3], v[208:211], a[44:47], v[0:3]
    ds_read_b64_tr_b16 v[220:221], v235 offset:0
    ds_read_b64_tr_b16 v[222:223], v235 offset:1024
    v_mfma_f32_16x16x32_bf16 v[4:7], v[208:211], a[100:103], v[4:7]
    v_add_u32 v235, 0x10000, v235
    v_mfma_f32_16x16x32_bf16 v[8:11], v[208:211], a[156:159], v[8:11]
    v_mfma_f32_16x16x32_bf16 v[12:15], v[208:211], a[212:215], v[12:15]
    s_waitcnt lgkmcnt(4)
    v_mfma_f32_16x16x32_bf16 v[16:19], v[212:215], a[44:47], v[16:19]
    ds_read_b64_tr_b16 v[208:209], v236 offset:0
    ds_read_b64_tr_b16 v[210:211], v236 offset:1024
    v_mfma_f32_16x16x32_bf16 v[20:23], v[212:215], a[100:103], v[20:23]
    v_add_u32 v236, 0x10000, v236
    v_mfma_f32_16x16x32_bf16 v[24:27], v[212:215], a[156:159], v[24:27]
    v_mfma_f32_16x16x32_bf16 v[28:31], v[212:215], a[212:215], v[28:31]
    s_waitcnt lgkmcnt(4)
    v_mfma_f32_16x16x32_bf16 v[32:35], v[216:219], a[44:47], v[32:35]
    ds_read_b64_tr_b16 v[212:213], v237 offset:0
    ds_read_b64_tr_b16 v[214:215], v237 offset:1024
    v_mfma_f32_16x16x32_bf16 v[36:39], v[216:219], a[100:103], v[36:39]
    v_add_u32 v237, 0x10000, v237
    v_mfma_f32_16x16x32_bf16 v[40:43], v[216:219], a[156:159], v[40:43]
    v_mfma_f32_16x16x32_bf16 v[44:47], v[216:219], a[212:215], v[44:47]
    s_waitcnt lgkmcnt(4)
    v_mfma_f32_16x16x32_bf16 v[48:51], v[220:223], a[44:47], v[48:51]
    ds_read_b64_tr_b16 v[216:217], v238 offset:0
    ds_read_b64_tr_b16 v[218:219], v238 offset:1024
    v_mfma_f32_16x16x32_bf16 v[52:55], v[220:223], a[100:103], v[52:55]
    v_add_u32 v238, 0x10000, v238
    v_mfma_f32_16x16x32_bf16 v[56:59], v[220:223], a[156:159], v[56:59]
    v_mfma_f32_16x16x32_bf16 v[60:63], v[220:223], a[212:215], v[60:63]
    s_waitcnt lgkmcnt(4)
    v_mfma_f32_16x16x32_bf16 v[64:67], v[208:211], a[44:47], v[64:67]
    ds_read_b64_tr_b16 v[220:221], v239 offset:0
    ds_read_b64_tr_b16 v[222:223], v239 offset:1024
    v_mfma_f32_16x16x32_bf16 v[68:71], v[208:211], a[100:103], v[68:71]
    v_add_u32 v239, 0x10000, v239
    v_mfma_f32_16x16x32_bf16 v[72:75], v[208:211], a[156:159], v[72:75]
    v_mfma_f32_16x16x32_bf16 v[76:79], v[208:211], a[212:215], v[76:79]
    s_waitcnt lgkmcnt(4)
    v_mfma_f32_16x16x32_bf16 v[80:83], v[212:215], a[44:47], v[80:83]
    s_waitcnt vmcnt(8)
    ds_read_b64_tr_b16 v[208:209], v232 offset:0
    ds_read_b64_tr_b16 v[210:211], v232 offset:1024
    v_mfma_f32_16x16x32_bf16 v[84:87], v[212:215], a[100:103], v[84:87]
    v_add_u32 v232, 0x8000, v232
    v_mfma_f32_16x16x32_bf16 v[88:91], v[212:215], a[156:159], v[88:91]
    v_mfma_f32_16x16x32_bf16 v[92:95], v[212:215], a[212:215], v[92:95]
    s_waitcnt lgkmcnt(4)
    v_mfma_f32_16x16x32_bf16 v[96:99], v[216:219], a[44:47], v[96:99]
    ds_read_b64_tr_b16 v[212:213], v233 offset:0
    ds_read_b64_tr_b16 v[214:215], v233 offset:1024
    v_mfma_f32_16x16x32_bf16 v[100:103], v[216:219], a[100:103], v[100:103]
    v_add_u32 v233, 0x8000, v233
    v_mfma_f32_16x16x32_bf16 v[104:107], v[216:219], a[156:159], v[104:107]
    v_mfma_f32_16x16x32_bf16 v[108:111], v[216:219], a[212:215], v[108:111]
    s_waitcnt lgkmcnt(4)
    v_mfma_f32_16x16x32_bf16 v[112:115], v[220:223], a[44:47], v[112:115]
    ds_read_b64_tr_b16 v[216:217], v234 offset:0
    ds_read_b64_tr_b16 v[218:219], v234 offset:1024
    v_mfma_f32_16x16x32_bf16 v[116:119], v[220:223], a[100:103], v[116:119]
    v_add_u32 v234, 0x8000, v234
    v_mfma_f32_16x16x32_bf16 v[120:123], v[220:223], a[156:159], v[120:123]
    v_mfma_f32_16x16x32_bf16 v[124:127], v[220:223], a[212:215], v[124:127]
    s_waitcnt lgkmcnt(4)
    s_barrier
    v_mfma_f32_16x16x32_bf16 v[0:3], v[208:211], a[48:51], v[0:3]
    ds_read_b64_tr_b16 v[220:221], v235 offset:0
    ds_read_b64_tr_b16 v[222:223], v235 offset:1024
    v_mfma_f32_16x16x32_bf16 v[4:7], v[208:211], a[104:107], v[4:7]
    s_mov_b32 m0, s28
    v_add_u32 v235, 0x8000, v235
    v_mfma_f32_16x16x32_bf16 v[8:11], v[208:211], a[160:163], v[8:11]
    buffer_load_dwordx4 v226, s[8:11], s35 offen offset:0  lds
    v_mfma_f32_16x16x32_bf16 v[12:15], v[208:211], a[216:219], v[12:15]
    s_waitcnt lgkmcnt(4)
    v_mfma_f32_16x16x32_bf16 v[16:19], v[212:215], a[48:51], v[16:19]
    ds_read_b64_tr_b16 v[208:209], v236 offset:0
    ds_read_b64_tr_b16 v[210:211], v236 offset:1024
    v_mfma_f32_16x16x32_bf16 v[20:23], v[212:215], a[104:107], v[20:23]
    v_add_u32 v236, 0x8000, v236
    v_mfma_f32_16x16x32_bf16 v[24:27], v[212:215], a[160:163], v[24:27]
    buffer_load_dwordx4 v226, s[8:11], 64 offen offset:1056  lds
    v_mfma_f32_16x16x32_bf16 v[28:31], v[212:215], a[216:219], v[28:31]
    s_waitcnt lgkmcnt(4)
    v_mfma_f32_16x16x32_bf16 v[32:35], v[216:219], a[48:51], v[32:35]
    ds_read_b64_tr_b16 v[212:213], v237 offset:0
    ds_read_b64_tr_b16 v[214:215], v237 offset:1024
    v_mfma_f32_16x16x32_bf16 v[36:39], v[216:219], a[104:107], v[36:39]
    v_add_u32 v237, 0x8000, v237
    v_mfma_f32_16x16x32_bf16 v[40:43], v[216:219], a[160:163], v[40:43]
    buffer_load_dwordx4 v226, s[8:11], 32 offen offset:2112  lds
    v_mfma_f32_16x16x32_bf16 v[44:47], v[216:219], a[216:219], v[44:47]
    s_waitcnt lgkmcnt(4)
    v_mfma_f32_16x16x32_bf16 v[48:51], v[220:223], a[48:51], v[48:51]
    ds_read_b64_tr_b16 v[216:217], v238 offset:0
    ds_read_b64_tr_b16 v[218:219], v238 offset:1024
    v_mfma_f32_16x16x32_bf16 v[52:55], v[220:223], a[104:107], v[52:55]
    v_add_u32 v238, 0x8000, v238
    v_mfma_f32_16x16x32_bf16 v[56:59], v[220:223], a[160:163], v[56:59]
    buffer_load_dwordx4 v226, s[8:11], 0 offen offset:3168  lds
    v_mfma_f32_16x16x32_bf16 v[60:63], v[220:223], a[216:219], v[60:63]
    s_waitcnt lgkmcnt(4)
    v_mfma_f32_16x16x32_bf16 v[64:67], v[208:211], a[48:51], v[64:67]
    ds_read_b64_tr_b16 v[220:221], v239 offset:0
    ds_read_b64_tr_b16 v[222:223], v239 offset:1024
    v_mfma_f32_16x16x32_bf16 v[68:71], v[208:211], a[104:107], v[68:71]
    s_add_u32 m0, s28, 4224
    v_add_u32 v239, 0x8000, v239
    v_mfma_f32_16x16x32_bf16 v[72:75], v[208:211], a[160:163], v[72:75]
    buffer_load_dwordx4 v226, s[12:15], s35 offen offset:0  lds
    v_mfma_f32_16x16x32_bf16 v[76:79], v[208:211], a[216:219], v[76:79]
    s_waitcnt lgkmcnt(4)
    v_mfma_f32_16x16x32_bf16 v[80:83], v[212:215], a[48:51], v[80:83]
    s_waitcnt vmcnt(5)
    ds_read_b64_tr_b16 v[208:209], v232 offset:0
    ds_read_b64_tr_b16 v[210:211], v232 offset:1024
    v_mfma_f32_16x16x32_bf16 v[84:87], v[212:215], a[104:107], v[84:87]
    v_mfma_f32_16x16x32_bf16 v[88:91], v[212:215], a[160:163], v[88:91]
    buffer_load_dwordx4 v226, s[12:15], 64 offen offset:1056  lds
    v_mfma_f32_16x16x32_bf16 v[92:95], v[212:215], a[216:219], v[92:95]
    s_waitcnt lgkmcnt(4)
    v_mfma_f32_16x16x32_bf16 v[96:99], v[216:219], a[48:51], v[96:99]
    ds_read_b64_tr_b16 v[212:213], v233 offset:0
    ds_read_b64_tr_b16 v[214:215], v233 offset:1024
    v_mfma_f32_16x16x32_bf16 v[100:103], v[216:219], a[104:107], v[100:103]
    v_mfma_f32_16x16x32_bf16 v[104:107], v[216:219], a[160:163], v[104:107]
    buffer_load_dwordx4 v226, s[12:15], 32 offen offset:2112  lds
    v_mfma_f32_16x16x32_bf16 v[108:111], v[216:219], a[216:219], v[108:111]
    s_waitcnt lgkmcnt(4)
    v_mfma_f32_16x16x32_bf16 v[112:115], v[220:223], a[48:51], v[112:115]
    ds_read_b64_tr_b16 v[216:217], v234 offset:0
    ds_read_b64_tr_b16 v[218:219], v234 offset:1024
    v_mfma_f32_16x16x32_bf16 v[116:119], v[220:223], a[104:107], v[116:119]
    v_mfma_f32_16x16x32_bf16 v[120:123], v[220:223], a[160:163], v[120:123]
    buffer_load_dwordx4 v226, s[12:15], 0 offen offset:3168  lds
    v_mfma_f32_16x16x32_bf16 v[124:127], v[220:223], a[216:219], v[124:127]
    s_waitcnt lgkmcnt(4)
    v_add_u32 v226, 0x8000, v226
    v_mfma_f32_16x16x32_bf16 v[0:3], v[208:211], a[52:55], v[0:3]
    ds_read_b64_tr_b16 v[220:221], v235 offset:0
    ds_read_b64_tr_b16 v[222:223], v235 offset:1024
    v_mfma_f32_16x16x32_bf16 v[4:7], v[208:211], a[108:111], v[4:7]
    s_add_u32 m0, s28, 33792
    v_mfma_f32_16x16x32_bf16 v[8:11], v[208:211], a[164:167], v[8:11]
    buffer_load_dwordx4 v226, s[8:11], s35 offen offset:0  lds
    v_mfma_f32_16x16x32_bf16 v[12:15], v[208:211], a[220:223], v[12:15]
    s_waitcnt lgkmcnt(4)
    v_mfma_f32_16x16x32_bf16 v[16:19], v[212:215], a[52:55], v[16:19]
    ds_read_b64_tr_b16 v[208:209], v236 offset:0
    ds_read_b64_tr_b16 v[210:211], v236 offset:1024
    v_mfma_f32_16x16x32_bf16 v[20:23], v[212:215], a[108:111], v[20:23]
    v_mfma_f32_16x16x32_bf16 v[24:27], v[212:215], a[164:167], v[24:27]
    buffer_load_dwordx4 v226, s[8:11], 64 offen offset:1056  lds
    v_mfma_f32_16x16x32_bf16 v[28:31], v[212:215], a[220:223], v[28:31]
    s_waitcnt lgkmcnt(4)
    v_cvt_pk_bf16_f32 v128, v0, v1
    v_cvt_pk_bf16_f32 v129, v2, v3
    v_mfma_f32_16x16x32_bf16 v[32:35], v[216:219], a[52:55], v[32:35]
    ds_read_b64_tr_b16 v[212:213], v237 offset:0
    ds_read_b64_tr_b16 v[214:215], v237 offset:1024
    v_mfma_f32_16x16x32_bf16 v[36:39], v[216:219], a[108:111], v[36:39]
    v_cvt_pk_bf16_f32 v130, v4, v5
    v_cvt_pk_bf16_f32 v131, v6, v7
    v_mfma_f32_16x16x32_bf16 v[40:43], v[216:219], a[164:167], v[40:43]
    buffer_load_dwordx4 v226, s[8:11], 32 offen offset:2112  lds
    v_mfma_f32_16x16x32_bf16 v[44:47], v[216:219], a[220:223], v[44:47]
    s_waitcnt lgkmcnt(4)
    v_cvt_pk_bf16_f32 v132, v8, v9
    v_cvt_pk_bf16_f32 v133, v10, v11
    v_mfma_f32_16x16x32_bf16 v[48:51], v[220:223], a[52:55], v[48:51]
    ds_read_b64_tr_b16 v[216:217], v238 offset:0
    ds_read_b64_tr_b16 v[218:219], v238 offset:1024
    v_mfma_f32_16x16x32_bf16 v[52:55], v[220:223], a[108:111], v[52:55]
    v_cvt_pk_bf16_f32 v136, v16, v17
    v_cvt_pk_bf16_f32 v137, v18, v19
    v_mfma_f32_16x16x32_bf16 v[56:59], v[220:223], a[164:167], v[56:59]
    buffer_load_dwordx4 v226, s[8:11], 0 offen offset:3168  lds
    v_mfma_f32_16x16x32_bf16 v[60:63], v[220:223], a[220:223], v[60:63]
    s_waitcnt lgkmcnt(4)
    v_cvt_pk_bf16_f32 v140, v24, v25
    v_cvt_pk_bf16_f32 v141, v26, v27
    v_mfma_f32_16x16x32_bf16 v[64:67], v[208:211], a[52:55], v[64:67]
    ds_read_b64_tr_b16 v[220:221], v239 offset:0
    ds_read_b64_tr_b16 v[222:223], v239 offset:1024
    v_mfma_f32_16x16x32_bf16 v[68:71], v[208:211], a[108:111], v[68:71]
    s_add_u32 m0, s28, 38016
    v_cvt_pk_bf16_f32 v144, v32, v33
    v_cvt_pk_bf16_f32 v145, v34, v35
    v_mfma_f32_16x16x32_bf16 v[72:75], v[208:211], a[164:167], v[72:75]
    buffer_load_dwordx4 v226, s[12:15], s35 offen offset:0  lds
    v_mfma_f32_16x16x32_bf16 v[76:79], v[208:211], a[220:223], v[76:79]
    s_waitcnt lgkmcnt(4)
    v_cvt_pk_bf16_f32 v148, v40, v41
    v_cvt_pk_bf16_f32 v149, v42, v43
    v_mfma_f32_16x16x32_bf16 v[80:83], v[212:215], a[52:55], v[80:83]
    v_cvt_pk_bf16_f32 v150, v44, v45
    v_cvt_pk_bf16_f32 v151, v46, v47
    v_mfma_f32_16x16x32_bf16 v[84:87], v[212:215], a[108:111], v[84:87]
    v_cvt_pk_bf16_f32 v152, v48, v49
    v_cvt_pk_bf16_f32 v153, v50, v51
    v_mfma_f32_16x16x32_bf16 v[88:91], v[212:215], a[164:167], v[88:91]
    buffer_load_dwordx4 v226, s[12:15], 64 offen offset:1056  lds
    v_mfma_f32_16x16x32_bf16 v[92:95], v[212:215], a[220:223], v[92:95]
    s_waitcnt lgkmcnt(2)
    v_cvt_pk_bf16_f32 v156, v56, v57
    v_cvt_pk_bf16_f32 v157, v58, v59
    v_mfma_f32_16x16x32_bf16 v[96:99], v[216:219], a[52:55], v[96:99]
    v_cvt_pk_bf16_f32 v158, v60, v61
    v_cvt_pk_bf16_f32 v159, v62, v63
    v_mfma_f32_16x16x32_bf16 v[100:103], v[216:219], a[108:111], v[100:103]
    v_cvt_pk_bf16_f32 v160, v64, v65
    v_cvt_pk_bf16_f32 v161, v66, v67
    v_mfma_f32_16x16x32_bf16 v[104:107], v[216:219], a[164:167], v[104:107]
    buffer_load_dwordx4 v226, s[12:15], 32 offen offset:2112  lds
    v_mfma_f32_16x16x32_bf16 v[108:111], v[216:219], a[220:223], v[108:111]
    s_waitcnt lgkmcnt(0)
    v_cvt_pk_bf16_f32 v164, v72, v73
    v_cvt_pk_bf16_f32 v165, v74, v75
    v_mfma_f32_16x16x32_bf16 v[112:115], v[220:223], a[52:55], v[112:115]
    v_cvt_pk_bf16_f32 v166, v76, v77
    v_cvt_pk_bf16_f32 v167, v78, v79
    v_mfma_f32_16x16x32_bf16 v[116:119], v[220:223], a[108:111], v[116:119]
    v_cvt_pk_bf16_f32 v168, v80, v81
    v_cvt_pk_bf16_f32 v169, v82, v83
    v_mfma_f32_16x16x32_bf16 v[120:123], v[220:223], a[164:167], v[120:123]
    buffer_load_dwordx4 v226, s[12:15], 0 offen offset:3168  lds
    v_mfma_f32_16x16x32_bf16 v[124:127], v[220:223], a[220:223], v[124:127]
    v_add_u32 v226, 0x8000, v226
    s_nop 7
    v_cvt_pk_bf16_f32 v134, v12, v13
    v_cvt_pk_bf16_f32 v135, v14, v15
    v_cvt_pk_bf16_f32 v138, v20, v21
    v_cvt_pk_bf16_f32 v139, v22, v23
    v_cvt_pk_bf16_f32 v142, v28, v29
    v_cvt_pk_bf16_f32 v143, v30, v31
    v_cvt_pk_bf16_f32 v146, v36, v37
    v_cvt_pk_bf16_f32 v147, v38, v39
    v_cvt_pk_bf16_f32 v154, v52, v53
    v_cvt_pk_bf16_f32 v155, v54, v55
    v_cvt_pk_bf16_f32 v162, v68, v69
    v_cvt_pk_bf16_f32 v163, v70, v71
    v_cvt_pk_bf16_f32 v170, v84, v85
    v_cvt_pk_bf16_f32 v171, v86, v87
    v_cvt_pk_bf16_f32 v172, v88, v89
    v_cvt_pk_bf16_f32 v173, v90, v91
    v_cvt_pk_bf16_f32 v174, v92, v93
    v_cvt_pk_bf16_f32 v175, v94, v95
    v_cvt_pk_bf16_f32 v176, v96, v97
    v_cvt_pk_bf16_f32 v177, v98, v99
    v_cvt_pk_bf16_f32 v178, v100, v101
    v_cvt_pk_bf16_f32 v179, v102, v103
    v_cvt_pk_bf16_f32 v180, v104, v105
    v_cvt_pk_bf16_f32 v181, v106, v107
    v_cvt_pk_bf16_f32 v182, v108, v109
    v_cvt_pk_bf16_f32 v183, v110, v111
    v_cvt_pk_bf16_f32 v184, v112, v113
    v_cvt_pk_bf16_f32 v185, v114, v115
    v_cvt_pk_bf16_f32 v186, v116, v117
    v_cvt_pk_bf16_f32 v187, v118, v119
    v_cvt_pk_bf16_f32 v188, v120, v121
    v_cvt_pk_bf16_f32 v189, v122, v123
    v_cvt_pk_bf16_f32 v190, v124, v125
    v_cvt_pk_bf16_f32 v191, v126, v127
    v_and_b32 v200, 15, v252
    v_lshrrev_b32 v201, 4, v252
    v_mul_u32_u24 v202, 1040, v200
    v_lshl_add_u32 v202, v201, 3, v202
    s_lshl_b32 s60, s34, 8
    s_add_u32 s60, s60, 67584
    v_add_u32 v202, s60, v202
    s_mov_b32 s61, 0x3db8aa3b
    s_barrier
    ds_write_b64 v202, v[128:129] offset:0
    ds_write_b64 v202, v[130:131] offset:16640
    ds_write_b64 v202, v[132:133] offset:33280
    ds_write_b64 v202, v[134:135] offset:49920
    ds_write_b64 v202, v[136:137] offset:32
    ds_write_b64 v202, v[138:139] offset:16672
    ds_write_b64 v202, v[140:141] offset:33312
    ds_write_b64 v202, v[142:143] offset:49952
    ds_write_b64 v202, v[144:145] offset:64
    ds_write_b64 v202, v[146:147] offset:16704
    ds_write_b64 v202, v[148:149] offset:33344
    ds_write_b64 v202, v[150:151] offset:49984
    ds_write_b64 v202, v[152:153] offset:96
    ds_write_b64 v202, v[154:155] offset:16736
    ds_write_b64 v202, v[156:157] offset:33376
    ds_write_b64 v202, v[158:159] offset:50016
    ds_write_b64 v202, v[160:161] offset:128
    ds_write_b64 v202, v[162:163] offset:16768
    ds_write_b64 v202, v[164:165] offset:33408
    ds_write_b64 v202, v[166:167] offset:50048
    ds_write_b64 v202, v[168:169] offset:160
    ds_write_b64 v202, v[170:171] offset:16800
    ds_write_b64 v202, v[172:173] offset:33440
    ds_write_b64 v202, v[174:175] offset:50080
    ds_write_b64 v202, v[176:177] offset:192
    ds_write_b64 v202, v[178:179] offset:16832
    ds_write_b64 v202, v[180:181] offset:33472
    ds_write_b64 v202, v[182:183] offset:50112
    ds_write_b64 v202, v[184:185] offset:224
    ds_write_b64 v202, v[186:187] offset:16864
    ds_write_b64 v202, v[188:189] offset:33504
    ds_write_b64 v202, v[190:191] offset:50144
    s_waitcnt lgkmcnt(0)
    s_barrier
    s_mul_i32 s60, s39, 33280
    s_add_u32 s60, s60, 67584
    v_mul_u32_u24 v202, 1040, v200
    v_lshl_add_u32 v202, v201, 4, v202
    v_add_u32 v202, s60, v202
    ds_read_b128 v[0:3], v202 offset:0
    ds_read_b128 v[4:7], v202 offset:64
    ds_read_b128 v[8:11], v202 offset:128
    ds_read_b128 v[12:15], v202 offset:192
    ds_read_b128 v[16:19], v202 offset:256
    ds_read_b128 v[20:23], v202 offset:320
    ds_read_b128 v[24:27], v202 offset:384
    ds_read_b128 v[28:31], v202 offset:448
    ds_read_b128 v[32:35], v202 offset:16640
    ds_read_b128 v[36:39], v202 offset:16704
    ds_read_b128 v[40:43], v202 offset:16768
    ds_read_b128 v[44:47], v202 offset:16832
    ds_read_b128 v[48:51], v202 offset:16896
    ds_read_b128 v[52:55], v202 offset:16960
    ds_read_b128 v[56:59], v202 offset:17024
    ds_read_b128 v[60:63], v202 offset:17088
    ds_read_b128 v[64:67], v202 offset:512
    ds_read_b128 v[68:71], v202 offset:576
    ds_read_b128 v[72:75], v202 offset:640
    ds_read_b128 v[76:79], v202 offset:704
    ds_read_b128 v[80:83], v202 offset:768
    ds_read_b128 v[84:87], v202 offset:832
    ds_read_b128 v[88:91], v202 offset:896
    ds_read_b128 v[92:95], v202 offset:960
    ds_read_b128 v[96:99], v202 offset:17152
    ds_read_b128 v[100:103], v202 offset:17216
    ds_read_b128 v[104:107], v202 offset:17280
    ds_read_b128 v[108:111], v202 offset:17344
    ds_read_b128 v[112:115], v202 offset:17408
    ds_read_b128 v[116:119], v202 offset:17472
    ds_read_b128 v[120:123], v202 offset:17536
    ds_read_b128 v[124:127], v202 offset:17600
    s_waitcnt vmcnt(0)
    s_waitcnt lgkmcnt(0)
    s_barrier
    v_add_u32 v226, 0xffff0000, v226
    ds_read_b128 v[208:211], v224 offset:0
    ds_read_b128 v[212:215], v224 offset:64
    s_waitcnt lgkmcnt(1)
    v_mfma_f32_16x16x32_bf16 v[128:131], v[208:211], v[0:3], 0
    s_waitcnt lgkmcnt(0)
    ds_read_b128 v[216:219], v224 offset:128
    v_mfma_f32_16x16x32_bf16 v[128:131], v[212:215], v[4:7], v[128:131]
    ds_read_b128 v[220:223], v224 offset:192
    v_mfma_f32_16x16x32_bf16 v[132:135], v[208:211], v[32:35], 0
    s_add_u32 m0, s28, 67584
    v_mfma_f32_16x16x32_bf16 v[132:135], v[212:215], v[36:39], v[132:135]
    buffer_load_dwordx4 v226, s[16:19], s35 offen offset:0  lds
    v_mfma_f32_16x16x32_bf16 v[136:139], v[208:211], v[64:67], 0
    v_mfma_f32_16x16x32_bf16 v[136:139], v[212:215], v[68:71], v[136:139]
    v_mfma_f32_16x16x32_bf16 v[140:143], v[208:211], v[96:99], 0
    v_mfma_f32_16x16x32_bf16 v[140:143], v[212:215], v[100:103], v[140:143]
    s_waitcnt lgkmcnt(1)
    buffer_load_dwordx4 v226, s[16:19], 64 offen offset:1056  lds
    v_mfma_f32_16x16x32_bf16 v[128:131], v[216:219], v[8:11], v[128:131]
    s_waitcnt lgkmcnt(0)
    ds_read_b128 v[208:211], v224 offset:256
    v_mfma_f32_16x16x32_bf16 v[128:131], v[220:223], v[12:15], v[128:131]
    ds_read_b128 v[212:215], v224 offset:320
    v_mfma_f32_16x16x32_bf16 v[132:135], v[216:219], v[40:43], v[132:135]
    v_mfma_f32_16x16x32_bf16 v[132:135], v[220:223], v[44:47], v[132:135]
    buffer_load_dwordx4 v226, s[16:19], 32 offen offset:2112  lds
    v_mfma_f32_16x16x32_bf16 v[136:139], v[216:219], v[72:75], v[136:139]
    v_mfma_f32_16x16x32_bf16 v[136:139], v[220:223], v[76:79], v[136:139]
    v_mfma_f32_16x16x32_bf16 v[140:143], v[216:219], v[104:107], v[140:143]
    v_mfma_f32_16x16x32_bf16 v[140:143], v[220:223], v[108:111], v[140:143]
    s_waitcnt lgkmcnt(1)
    buffer_load_dwordx4 v226, s[16:19], 0 offen offset:3168  lds
    v_mfma_f32_16x16x32_bf16 v[128:131], v[208:211], v[16:19], v[128:131]
    s_waitcnt lgkmcnt(0)
    ds_read_b128 v[216:219], v224 offset:384
    v_mfma_f32_16x16x32_bf16 v[128:131], v[212:215], v[20:23], v[128:131]
    ds_read_b128 v[220:223], v224 offset:448
    v_mfma_f32_16x16x32_bf16 v[132:135], v[208:211], v[48:51], v[132:135]
    s_add_u32 m0, s28, 71808
    v_mfma_f32_16x16x32_bf16 v[132:135], v[212:215], v[52:55], v[132:135]
    buffer_load_dwordx4 v226, s[20:23], s35 offen offset:0  lds
    v_mfma_f32_16x16x32_bf16 v[136:139], v[208:211], v[80:83], v[136:139]
    v_mfma_f32_16x16x32_bf16 v[136:139], v[212:215], v[84:87], v[136:139]
    v_mfma_f32_16x16x32_bf16 v[140:143], v[208:211], v[112:115], v[140:143]
    v_mfma_f32_16x16x32_bf16 v[140:143], v[212:215], v[116:119], v[140:143]
    s_waitcnt lgkmcnt(1)
    buffer_load_dwordx4 v226, s[20:23], 64 offen offset:1056  lds
    v_mfma_f32_16x16x32_bf16 v[128:131], v[216:219], v[24:27], v[128:131]
    s_waitcnt lgkmcnt(0)
    ds_read_b128 v[208:211], v224 offset:8448
    v_mfma_f32_16x16x32_bf16 v[128:131], v[220:223], v[28:31], v[128:131]
    ds_read_b128 v[212:215], v224 offset:8512
    v_mfma_f32_16x16x32_bf16 v[132:135], v[216:219], v[56:59], v[132:135]
    v_mfma_f32_16x16x32_bf16 v[132:135], v[220:223], v[60:63], v[132:135]
    buffer_load_dwordx4 v226, s[20:23], 32 offen offset:2112  lds
    v_mfma_f32_16x16x32_bf16 v[136:139], v[216:219], v[88:91], v[136:139]
    v_mfma_f32_16x16x32_bf16 v[136:139], v[220:223], v[92:95], v[136:139]
    v_mfma_f32_16x16x32_bf16 v[140:143], v[216:219], v[120:123], v[140:143]
    v_mfma_f32_16x16x32_bf16 v[140:143], v[220:223], v[124:127], v[140:143]
    s_waitcnt lgkmcnt(1)
    buffer_load_dwordx4 v226, s[20:23], 0 offen offset:3168  lds
    v_mfma_f32_16x16x32_bf16 v[144:147], v[208:211], v[0:3], 0
    s_waitcnt lgkmcnt(0)
    ds_read_b128 v[216:219], v224 offset:8576
    v_add_u32 v226, 0x8000, v226
    v_mfma_f32_16x16x32_bf16 v[144:147], v[212:215], v[4:7], v[144:147]
    ds_read_b128 v[220:223], v224 offset:8640
    v_mfma_f32_16x16x32_bf16 v[148:151], v[208:211], v[32:35], 0
    v_mfma_f32_16x16x32_bf16 v[148:151], v[212:215], v[36:39], v[148:151]
    v_mfma_f32_16x16x32_bf16 v[152:155], v[208:211], v[64:67], 0
    v_max3_f32 v244, v128, v129, v130
    v_max3_f32 v245, v132, v133, v134
    v_mfma_f32_16x16x32_bf16 v[152:155], v[212:215], v[68:71], v[152:155]
    v_max3_f32 v246, v136, v137, v138
    v_max3_f32 v247, v140, v141, v142
    v_mfma_f32_16x16x32_bf16 v[156:159], v[208:211], v[96:99], 0
    v_max_f32 v244, v244, v131
    v_max_f32 v245, v245, v135
    v_mfma_f32_16x16x32_bf16 v[156:159], v[212:215], v[100:103], v[156:159]
    s_waitcnt lgkmcnt(1)
    v_max_f32 v246, v246, v139
    v_max_f32 v247, v247, v143
    v_mfma_f32_16x16x32_bf16 v[144:147], v[216:219], v[8:11], v[144:147]
    s_waitcnt lgkmcnt(0)
    s_add_u32 s8, s8, 0x8000
    s_addc_u32 s9, s9, 0
    s_sub_u32 s10, s10, 0x8000
    ds_read_b128 v[208:211], v224 offset:8704
    v_mov_b32 v248, v244
    v_mfma_f32_16x16x32_bf16 v[144:147], v[220:223], v[12:15], v[144:147]
    ds_read_b128 v[212:215], v224 offset:8768
    v_mov_b32 v249, v245
    v_mfma_f32_16x16x32_bf16 v[148:151], v[216:219], v[40:43], v[148:151]
    v_mov_b32 v250, v246
    v_mov_b32 v251, v247
    v_mfma_f32_16x16x32_bf16 v[148:151], v[220:223], v[44:47], v[148:151]
    v_permlane16_swap_b32 v244, v248
    v_permlane16_swap_b32 v245, v249
    v_mfma_f32_16x16x32_bf16 v[152:155], v[216:219], v[72:75], v[152:155]
    s_add_u32 s12, s12, 0x8000
    s_addc_u32 s13, s13, 0
    s_sub_u32 s14, s14, 0x8000
    v_permlane16_swap_b32 v246, v250
    v_permlane16_swap_b32 v247, v251
    v_mfma_f32_16x16x32_bf16 v[152:155], v[220:223], v[76:79], v[152:155]
    v_max_f32 v244, v244, v248
    v_max_f32 v245, v245, v249
    v_mfma_f32_16x16x32_bf16 v[156:159], v[216:219], v[104:107], v[156:159]
    v_max_f32 v246, v246, v250
    v_max_f32 v247, v247, v251
    v_mfma_f32_16x16x32_bf16 v[156:159], v[220:223], v[108:111], v[156:159]
    s_waitcnt lgkmcnt(1)
    v_mov_b32 v248, v244
    v_mov_b32 v249, v245
    v_mfma_f32_16x16x32_bf16 v[144:147], v[208:211], v[16:19], v[144:147]
    s_waitcnt lgkmcnt(0)
    ds_read_b128 v[216:219], v224 offset:8832
    v_mov_b32 v250, v246
    v_mfma_f32_16x16x32_bf16 v[144:147], v[212:215], v[20:23], v[144:147]
    ds_read_b128 v[220:223], v224 offset:8896
    v_mov_b32 v251, v247
    v_mfma_f32_16x16x32_bf16 v[148:151], v[208:211], v[48:51], v[148:151]
    v_permlane32_swap_b32 v244, v248
    v_permlane32_swap_b32 v245, v249
    v_mfma_f32_16x16x32_bf16 v[148:151], v[212:215], v[52:55], v[148:151]
    v_permlane32_swap_b32 v246, v250
    v_permlane32_swap_b32 v247, v251
    v_mfma_f32_16x16x32_bf16 v[152:155], v[208:211], v[80:83], v[152:155]
    v_max_f32 v244, v244, v248
    v_max_f32 v245, v245, v249
    v_mfma_f32_16x16x32_bf16 v[152:155], v[212:215], v[84:87], v[152:155]
    v_max_f32 v246, v246, v250
    v_max_f32 v247, v247, v251
    v_mfma_f32_16x16x32_bf16 v[156:159], v[208:211], v[112:115], v[156:159]
    v_sub_f32 v192, 0, v244
    v_sub_f32 v196, 0, v245
    v_mfma_f32_16x16x32_bf16 v[156:159], v[212:215], v[116:119], v[156:159]
    s_waitcnt lgkmcnt(1)
    v_sub_f32 v200, 0, v246
    v_sub_f32 v204, 0, v247
    v_mfma_f32_16x16x32_bf16 v[144:147], v[216:219], v[24:27], v[144:147]
    s_waitcnt lgkmcnt(0)
    v_mov_b32 v236, 0
    v_mov_b32 v237, 0
    v_mfma_f32_16x16x32_bf16 v[144:147], v[220:223], v[28:31], v[144:147]
    v_mov_b32 v238, 0
    v_mov_b32 v239, 0
    v_mfma_f32_16x16x32_bf16 v[148:151], v[216:219], v[56:59], v[148:151]
    v_add_f32 v128, v128, v192
    v_add_f32 v129, v129, v192
    v_mfma_f32_16x16x32_bf16 v[148:151], v[220:223], v[60:63], v[148:151]
    v_add_f32 v130, v130, v192
    v_add_f32 v131, v131, v192
    v_mfma_f32_16x16x32_bf16 v[152:155], v[216:219], v[88:91], v[152:155]
    v_add_f32 v132, v132, v196
    v_add_f32 v133, v133, v196
    v_mfma_f32_16x16x32_bf16 v[152:155], v[220:223], v[92:95], v[152:155]
    v_add_f32 v134, v134, v196
    v_add_f32 v135, v135, v196
    v_mfma_f32_16x16x32_bf16 v[156:159], v[216:219], v[120:123], v[156:159]
    v_add_f32 v136, v136, v200
    v_add_f32 v137, v137, v200
    v_mfma_f32_16x16x32_bf16 v[156:159], v[220:223], v[124:127], v[156:159]
    v_add_f32 v138, v138, v200
    v_add_f32 v139, v139, v200
    v_add_f32 v140, v140, v204
    v_add_f32 v141, v141, v204
    v_add_f32 v142, v142, v204
    v_add_f32 v143, v143, v204
    v_mov_b32 v193, v192
    v_mov_b32 v194, v192
    v_mov_b32 v195, v192
    v_mov_b32 v197, v196
    v_mov_b32 v198, v196
    v_mov_b32 v199, v196
    v_mov_b32 v201, v200
    v_mov_b32 v202, v200
    v_mov_b32 v203, v200
    v_mov_b32 v205, v204
    v_mov_b32 v206, v204
    v_mov_b32 v207, v204
    v_exp_f32 v244, v128
    v_exp_f32 v245, v129
    v_exp_f32 v246, v130
    v_exp_f32 v247, v131
    v_add_f32 v228, v236, v244
    v_add_f32 v228, v228, v245
    v_cvt_pk_bf16_f32 v160, v244, v245
    v_exp_f32 v248, v132
    v_exp_f32 v249, v133
    v_add_f32 v228, v228, v246
    v_add_f32 v228, v228, v247
    v_cvt_pk_bf16_f32 v161, v246, v247
    v_exp_f32 v250, v134
    v_exp_f32 v251, v135
    v_add_f32 v229, v237, v248
    v_add_f32 v229, v229, v249
    v_cvt_pk_bf16_f32 v164, v248, v249
    v_exp_f32 v244, v136
    v_exp_f32 v245, v137
    v_add_f32 v229, v229, v250
    v_add_f32 v229, v229, v251
    v_cvt_pk_bf16_f32 v165, v250, v251
    v_exp_f32 v246, v138
    v_exp_f32 v247, v139
    v_add_f32 v230, v238, v244
    v_add_f32 v230, v230, v245
    v_cvt_pk_bf16_f32 v168, v244, v245
    v_exp_f32 v248, v140
    v_exp_f32 v249, v141
    v_add_f32 v230, v230, v246
    v_add_f32 v230, v230, v247
    v_cvt_pk_bf16_f32 v169, v246, v247
    v_exp_f32 v250, v142
    v_exp_f32 v251, v143
    v_add_f32 v231, v239, v248
    v_add_f32 v231, v231, v249
    v_cvt_pk_bf16_f32 v172, v248, v249
    v_add_f32 v231, v231, v250
    v_add_f32 v231, v231, v251
    v_cvt_pk_bf16_f32 v173, v250, v251
    s_nop 7
    v_add_f32 v144, v144, v192
    v_add_f32 v145, v145, v192
    v_add_f32 v146, v146, v192
    v_add_f32 v147, v147, v192
    v_add_f32 v148, v148, v196
    v_add_f32 v149, v149, v196
    v_add_f32 v150, v150, v196
    v_add_f32 v151, v151, v196
    v_add_f32 v152, v152, v200
    v_add_f32 v153, v153, v200
    v_add_f32 v154, v154, v200
    v_add_f32 v155, v155, v200
    v_add_f32 v156, v156, v204
    v_add_f32 v157, v157, v204
    v_add_f32 v158, v158, v204
    v_add_f32 v159, v159, v204
    v_exp_f32 v244, v144
    v_exp_f32 v245, v145
    v_exp_f32 v246, v146
    v_exp_f32 v247, v147
    v_add_f32 v228, v228, v244
    v_add_f32 v228, v228, v245
    v_cvt_pk_bf16_f32 v162, v244, v245
    v_exp_f32 v248, v148
    v_exp_f32 v249, v149
    v_add_f32 v228, v228, v246
    v_add_f32 v228, v228, v247
    v_cvt_pk_bf16_f32 v163, v246, v247
    v_exp_f32 v250, v150
    v_exp_f32 v251, v151
    v_add_f32 v229, v229, v248
    v_add_f32 v229, v229, v249
    v_cvt_pk_bf16_f32 v166, v248, v249
    v_exp_f32 v244, v152
    v_exp_f32 v245, v153
    v_add_f32 v229, v229, v250
    v_add_f32 v229, v229, v251
    v_cvt_pk_bf16_f32 v167, v250, v251
    v_exp_f32 v246, v154
    v_exp_f32 v247, v155
    v_add_f32 v230, v230, v244
    v_add_f32 v230, v230, v245
    v_cvt_pk_bf16_f32 v170, v244, v245
    v_exp_f32 v248, v156
    v_exp_f32 v249, v157
    v_add_f32 v230, v230, v246
    v_add_f32 v230, v230, v247
    v_cvt_pk_bf16_f32 v171, v246, v247
    v_exp_f32 v250, v158
    v_exp_f32 v251, v159
    v_add_f32 v231, v231, v248
    v_add_f32 v231, v231, v249
    v_cvt_pk_bf16_f32 v174, v248, v249
    v_add_f32 v231, v231, v250
    v_add_f32 v231, v231, v251
    v_cvt_pk_bf16_f32 v175, v250, v251
    v_max3_f32 v244, v228, v229, v230
    v_max_f32 v244, v244, v231
    v_cmp_lt_f32 vcc, s29, v244
    s_nop 1
    s_cbranch_vccnz L_rare_p
L_back_p:
    s_waitcnt vmcnt(0) lgkmcnt(0)
    s_barrier
    ds_read_b128 v[208:211], v224 offset:33792
    ds_read_b128 v[212:215], v224 offset:33856
    s_waitcnt lgkmcnt(0)
    v_mfma_f32_16x16x32_bf16 v[128:131], v[208:211], v[0:3], v[192:195]
    ds_read_b128 v[216:219], v224 offset:33920
    v_mfma_f32_16x16x32_bf16 v[128:131], v[212:215], v[4:7], v[128:131]
    ds_read_b128 v[220:223], v224 offset:33984
    v_mfma_f32_16x16x32_bf16 v[132:135], v[208:211], v[32:35], v[196:199]
    s_mov_b32 m0, s28
    v_mfma_f32_16x16x32_bf16 v[132:135], v[212:215], v[36:39], v[132:135]
    buffer_load_dwordx4 v226, s[8:11], s35 offen offset:0  lds
    v_mfma_f32_16x16x32_bf16 v[136:139], v[208:211], v[64:67], v[200:203]
    v_mfma_f32_16x16x32_bf16 v[136:139], v[212:215], v[68:71], v[136:139]
    v_mfma_f32_16x16x32_bf16 v[140:143], v[208:211], v[96:99], v[204:207]
    v_mfma_f32_16x16x32_bf16 v[140:143], v[212:215], v[100:103], v[140:143]
    s_waitcnt lgkmcnt(1)
    buffer_load_dwordx4 v226, s[8:11], 64 offen offset:1056  lds
    v_mfma_f32_16x16x32_bf16 v[128:131], v[216:219], v[8:11], v[128:131]
    s_waitcnt lgkmcnt(0)
    ds_read_b128 v[208:211], v224 offset:34048
    v_mfma_f32_16x16x32_bf16 v[128:131], v[220:223], v[12:15], v[128:131]
    ds_read_b128 v[212:215], v224 offset:34112
    v_mfma_f32_16x16x32_bf16 v[132:135], v[216:219], v[40:43], v[132:135]
    v_mfma_f32_16x16x32_bf16 v[132:135], v[220:223], v[44:47], v[132:135]
    buffer_load_dwordx4 v226, s[8:11], 32 offen offset:2112  lds
    v_mfma_f32_16x16x32_bf16 v[136:139], v[216:219], v[72:75], v[136:139]
    v_mfma_f32_16x16x32_bf16 v[136:139], v[220:223], v[76:79], v[136:139]
    v_mfma_f32_16x16x32_bf16 v[140:143], v[216:219], v[104:107], v[140:143]
    v_mfma_f32_16x16x32_bf16 v[140:143], v[220:223], v[108:111], v[140:143]
    s_waitcnt lgkmcnt(1)
    buffer_load_dwordx4 v226, s[8:11], 0 offen offset:3168  lds
    v_mfma_f32_16x16x32_bf16 v[128:131], v[208:211], v[16:19], v[128:131]
    s_waitcnt lgkmcnt(0)
    ds_read_b128 v[216:219], v224 offset:34176
    v_mfma_f32_16x16x32_bf16 v[128:131], v[212:215], v[20:23], v[128:131]
    ds_read_b128 v[220:223], v224 offset:34240
    v_mfma_f32_16x16x32_bf16 v[132:135], v[208:211], v[48:51], v[132:135]
    s_add_u32 m0, s28, 4224
    v_mfma_f32_16x16x32_bf16 v[132:135], v[212:215], v[52:55], v[132:135]
    buffer_load_dwordx4 v226, s[12:15], s35 offen offset:0  lds
    v_mfma_f32_16x16x32_bf16 v[136:139], v[208:211], v[80:83], v[136:139]
    v_mfma_f32_16x16x32_bf16 v[136:139], v[212:215], v[84:87], v[136:139]
    v_mfma_f32_16x16x32_bf16 v[140:143], v[208:211], v[112:115], v[140:143]
    v_mfma_f32_16x16x32_bf16 v[140:143], v[212:215], v[116:119], v[140:143]
    s_waitcnt lgkmcnt(1)
    buffer_load_dwordx4 v226, s[12:15], 64 offen offset:1056  lds
    v_mfma_f32_16x16x32_bf16 v[128:131], v[216:219], v[24:27], v[128:131]
    s_waitcnt lgkmcnt(0)
    ds_read_b128 v[208:211], v224 offset:42240
    v_mfma_f32_16x16x32_bf16 v[128:131], v[220:223], v[28:31], v[128:131]
    ds_read_b128 v[212:215], v224 offset:42304
    v_mfma_f32_16x16x32_bf16 v[132:135], v[216:219], v[56:59], v[132:135]
    v_mfma_f32_16x16x32_bf16 v[132:135], v[220:223], v[60:63], v[132:135]
    buffer_load_dwordx4 v226, s[12:15], 32 offen offset:2112  lds
    v_mfma_f32_16x16x32_bf16 v[136:139], v[216:219], v[88:91], v[136:139]
    v_mfma_f32_16x16x32_bf16 v[136:139], v[220:223], v[92:95], v[136:139]
    v_mfma_f32_16x16x32_bf16 v[140:143], v[216:219], v[120:123], v[140:143]
    v_mfma_f32_16x16x32_bf16 v[140:143], v[220:223], v[124:127], v[140:143]
    s_waitcnt lgkmcnt(1)
    buffer_load_dwordx4 v226, s[12:15], 0 offen offset:3168  lds
    v_mfma_f32_16x16x32_bf16 v[144:147], v[208:211], v[0:3], v[192:195]
    s_waitcnt lgkmcnt(0)
    ds_read_b128 v[216:219], v224 offset:42368
    v_mfma_f32_16x16x32_bf16 v[144:147], v[212:215], v[4:7], v[144:147]
    ds_read_b128 v[220:223], v224 offset:42432
    v_mfma_f32_16x16x32_bf16 v[148:151], v[208:211], v[32:35], v[196:199]
    s_add_u32 m0, s28, 101376
    v_mfma_f32_16x16x32_bf16 v[148:151], v[212:215], v[36:39], v[148:151]
    buffer_load_dwordx4 v226, s[16:19], s35 offen offset:0  lds
    v_mfma_f32_16x16x32_bf16 v[152:155], v[208:211], v[64:67], v[200:203]
    v_exp_f32 v244, v128
    v_mfma_f32_16x16x32_bf16 v[152:155], v[212:215], v[68:71], v[152:155]
    v_exp_f32 v245, v129
    v_mfma_f32_16x16x32_bf16 v[156:159], v[208:211], v[96:99], v[204:207]
    v_exp_f32 v246, v130
    v_mfma_f32_16x16x32_bf16 v[156:159], v[212:215], v[100:103], v[156:159]
    s_waitcnt lgkmcnt(1)
    buffer_load_dwordx4 v226, s[16:19], 64 offen offset:1056  lds
    v_mfma_f32_16x16x32_bf16 v[144:147], v[216:219], v[8:11], v[144:147]
    s_waitcnt lgkmcnt(0)
    ds_read_b128 v[208:211], v224 offset:42496
    v_mfma_f32_16x16x32_bf16 v[144:147], v[220:223], v[12:15], v[144:147]
    ds_read_b128 v[212:215], v224 offset:42560
    v_mfma_f32_16x16x32_bf16 v[148:151], v[216:219], v[40:43], v[148:151]
    v_exp_f32 v247, v131
    v_mfma_f32_16x16x32_bf16 v[148:151], v[220:223], v[44:47], v[148:151]
    buffer_load_dwordx4 v226, s[16:19], 32 offen offset:2112  lds
    v_add_f32 v236, v228, v244
    v_mfma_f32_16x16x32_bf16 v[152:155], v[216:219], v[72:75], v[152:155]
    v_add_f32 v236, v236, v245
    v_cvt_pk_bf16_f32 v176, v244, v245
    v_mfma_f32_16x16x32_bf16 v[152:155], v[220:223], v[76:79], v[152:155]
    v_exp_f32 v248, v132
    v_mfma_f32_16x16x32_bf16 v[156:159], v[216:219], v[104:107], v[156:159]
    v_exp_f32 v249, v133
    v_mfma_f32_16x16x32_bf16 v[156:159], v[220:223], v[108:111], v[156:159]
    s_waitcnt lgkmcnt(1)
    buffer_load_dwordx4 v226, s[16:19], 0 offen offset:3168  lds
    v_add_f32 v236, v236, v246
    v_mfma_f32_16x16x32_bf16 v[144:147], v[208:211], v[16:19], v[144:147]
    s_waitcnt lgkmcnt(0)
    ds_read_b128 v[216:219], v224 offset:42624
    v_add_f32 v236, v236, v247
    v_mfma_f32_16x16x32_bf16 v[144:147], v[212:215], v[20:23], v[144:147]
    ds_read_b128 v[220:223], v224 offset:42688
    v_cvt_pk_bf16_f32 v177, v246, v247
    v_mfma_f32_16x16x32_bf16 v[148:151], v[208:211], v[48:51], v[148:151]
    s_add_u32 m0, s28, 105600
    v_exp_f32 v250, v134
    v_mfma_f32_16x16x32_bf16 v[148:151], v[212:215], v[52:55], v[148:151]
    buffer_load_dwordx4 v226, s[20:23], s35 offen offset:0  lds
    v_mfma_f32_16x16x32_bf16 v[152:155], v[208:211], v[80:83], v[152:155]
    v_exp_f32 v251, v135
    v_mfma_f32_16x16x32_bf16 v[152:155], v[212:215], v[84:87], v[152:155]
    v_add_f32 v237, v229, v248
    v_add_f32 v237, v237, v249
    v_mfma_f32_16x16x32_bf16 v[156:159], v[208:211], v[112:115], v[156:159]
    v_cvt_pk_bf16_f32 v180, v248, v249
    v_mfma_f32_16x16x32_bf16 v[156:159], v[212:215], v[116:119], v[156:159]
    s_waitcnt lgkmcnt(1)
    buffer_load_dwordx4 v226, s[20:23], 64 offen offset:1056  lds
    v_mfma_f32_16x16x32_bf16 v[144:147], v[216:219], v[24:27], v[144:147]
    s_waitcnt lgkmcnt(0)
    v_exp_f32 v244, v136
    v_mfma_f32_16x16x32_bf16 v[144:147], v[220:223], v[28:31], v[144:147]
    ds_read_b64_tr_b16 v[208:209], v225 offset:0
    ds_read_b64_tr_b16 v[210:211], v225 offset:8448
    v_mfma_f32_16x16x32_bf16 v[148:151], v[216:219], v[56:59], v[148:151]
    v_exp_f32 v245, v137
    v_mfma_f32_16x16x32_bf16 v[148:151], v[220:223], v[60:63], v[148:151]
    ds_read_b64_tr_b16 v[212:213], v225 offset:32
    ds_read_b64_tr_b16 v[214:215], v225 offset:8480
    v_mfma_f32_16x16x32_bf16 v[152:155], v[216:219], v[88:91], v[152:155]
    buffer_load_dwordx4 v226, s[20:23], 32 offen offset:2112  lds
    v_add_f32 v237, v237, v250
    v_mfma_f32_16x16x32_bf16 v[152:155], v[220:223], v[92:95], v[152:155]
    v_add_f32 v237, v237, v251
    v_cvt_pk_bf16_f32 v181, v250, v251
    v_mfma_f32_16x16x32_bf16 v[156:159], v[216:219], v[120:123], v[156:159]
    v_exp_f32 v246, v138
    v_mfma_f32_16x16x32_bf16 v[156:159], v[220:223], v[124:127], v[156:159]
    s_waitcnt lgkmcnt(2)
    buffer_load_dwordx4 v226, s[20:23], 0 offen offset:3168  lds
    v_mfma_f32_16x16x32_bf16 a[0:3], v[208:211], v[160:163], 0
    ds_read_b64_tr_b16 v[216:217], v225 offset:64
    ds_read_b64_tr_b16 v[218:219], v225 offset:8512
    v_add_u32 v226, 0x8000, v226
    v_mfma_f32_16x16x32_bf16 a[4:7], v[208:211], v[164:167], 0
    v_exp_f32 v247, v139
    v_mfma_f32_16x16x32_bf16 a[8:11], v[208:211], v[168:171], 0
    ds_read_b64_tr_b16 v[220:221], v225 offset:96
    ds_read_b64_tr_b16 v[222:223], v225 offset:8544
    v_mfma_f32_16x16x32_bf16 a[12:15], v[208:211], v[172:175], 0
    s_waitcnt lgkmcnt(4)
    buffer_load_dword v253, v227, s[92:95], 0 offen
    v_add_f32 v238, v230, v244
    v_mfma_f32_16x16x32_bf16 a[16:19], v[212:215], v[160:163], 0
    ds_read_b64_tr_b16 v[208:209], v225 offset:128
    ds_read_b64_tr_b16 v[210:211], v225 offset:8576
    v_add_u32 v227, 0x8000, v227
    v_mfma_f32_16x16x32_bf16 a[20:23], v[212:215], v[164:167], 0
    v_add_f32 v238, v238, v245
    v_cvt_pk_bf16_f32 v184, v244, v245
    v_mfma_f32_16x16x32_bf16 a[24:27], v[212:215], v[168:171], 0
    v_exp_f32 v248, v140
    v_mfma_f32_16x16x32_bf16 a[28:31], v[212:215], v[172:175], 0
    s_waitcnt lgkmcnt(4)
    v_exp_f32 v249, v141
    v_mfma_f32_16x16x32_bf16 a[32:35], v[216:219], v[160:163], 0
    ds_read_b64_tr_b16 v[212:213], v225 offset:160
    ds_read_b64_tr_b16 v[214:215], v225 offset:8608
    v_mfma_f32_16x16x32_bf16 a[36:39], v[216:219], v[164:167], 0
    v_add_f32 v238, v238, v246
    v_add_f32 v238, v238, v247
    v_mfma_f32_16x16x32_bf16 a[40:43], v[216:219], v[168:171], 0
    v_cvt_pk_bf16_f32 v185, v246, v247
    v_mfma_f32_16x16x32_bf16 a[44:47], v[216:219], v[172:175], 0
    s_waitcnt lgkmcnt(4)
    v_exp_f32 v250, v142
    v_mfma_f32_16x16x32_bf16 a[48:51], v[220:223], v[160:163], 0
    ds_read_b64_tr_b16 v[216:217], v225 offset:192
    ds_read_b64_tr_b16 v[218:219], v225 offset:8640
    v_mfma_f32_16x16x32_bf16 a[52:55], v[220:223], v[164:167], 0
    v_exp_f32 v251, v143
    v_mfma_f32_16x16x32_bf16 a[56:59], v[220:223], v[168:171], 0
    v_add_f32 v239, v231, v248
    v_add_f32 v239, v239, v249
    v_mfma_f32_16x16x32_bf16 a[60:63], v[220:223], v[172:175], 0
    s_waitcnt lgkmcnt(4)
    v_cvt_pk_bf16_f32 v188, v248, v249
    v_add_f32 v239, v239, v250
    v_mfma_f32_16x16x32_bf16 a[64:67], v[208:211], v[160:163], 0
    ds_read_b64_tr_b16 v[220:221], v225 offset:224
    ds_read_b64_tr_b16 v[222:223], v225 offset:8672
    v_mfma_f32_16x16x32_bf16 a[68:71], v[208:211], v[164:167], 0
    v_add_f32 v239, v239, v251
    v_cvt_pk_bf16_f32 v189, v250, v251
    v_mfma_f32_16x16x32_bf16 a[72:75], v[208:211], v[168:171], 0
    v_exp_f32 v244, v144
    v_mfma_f32_16x16x32_bf16 a[76:79], v[208:211], v[172:175], 0
    s_waitcnt lgkmcnt(4)
    v_exp_f32 v245, v145
    v_mfma_f32_16x16x32_bf16 a[80:83], v[212:215], v[160:163], 0
    ds_read_b64_tr_b16 v[208:209], v225 offset:256
    ds_read_b64_tr_b16 v[210:211], v225 offset:8704
    v_mfma_f32_16x16x32_bf16 a[84:87], v[212:215], v[164:167], 0
    v_exp_f32 v246, v146
    v_mfma_f32_16x16x32_bf16 a[88:91], v[212:215], v[168:171], 0
    v_exp_f32 v247, v147
    v_mfma_f32_16x16x32_bf16 a[92:95], v[212:215], v[172:175], 0
    s_waitcnt lgkmcnt(4)
    v_add_f32 v236, v236, v244
    v_add_f32 v236, v236, v245
    v_mfma_f32_16x16x32_bf16 a[96:99], v[216:219], v[160:163], 0
    ds_read_b64_tr_b16 v[212:213], v225 offset:288
    ds_read_b64_tr_b16 v[214:215], v225 offset:8736
    v_mfma_f32_16x16x32_bf16 a[100:103], v[216:219], v[164:167], 0
    v_cvt_pk_bf16_f32 v178, v244, v245
    v_mfma_f32_16x16x32_bf16 a[104:107], v[216:219], v[168:171], 0
    v_exp_f32 v248, v148
    v_mfma_f32_16x16x32_bf16 a[108:111], v[216:219], v[172:175], 0
    s_waitcnt lgkmcnt(4)
    v_exp_f32 v249, v149
    v_mfma_f32_16x16x32_bf16 a[112:115], v[220:223], v[160:163], 0
    ds_read_b64_tr_b16 v[216:217], v225 offset:320
    ds_read_b64_tr_b16 v[218:219], v225 offset:8768
    v_mfma_f32_16x16x32_bf16 a[116:119], v[220:223], v[164:167], 0
    v_add_f32 v236, v236, v246
    v_add_f32 v236, v236, v247
    v_mfma_f32_16x16x32_bf16 a[120:123], v[220:223], v[168:171], 0
    v_cvt_pk_bf16_f32 v179, v246, v247
    v_mfma_f32_16x16x32_bf16 a[124:127], v[220:223], v[172:175], 0
    s_waitcnt lgkmcnt(4)
    v_exp_f32 v250, v150
    v_mfma_f32_16x16x32_bf16 a[128:131], v[208:211], v[160:163], 0
    ds_read_b64_tr_b16 v[220:221], v225 offset:352
    ds_read_b64_tr_b16 v[222:223], v225 offset:8800
    v_mfma_f32_16x16x32_bf16 a[132:135], v[208:211], v[164:167], 0
    v_exp_f32 v251, v151
    v_mfma_f32_16x16x32_bf16 a[136:139], v[208:211], v[168:171], 0
    v_add_f32 v237, v237, v248
    v_add_f32 v237, v237, v249
    v_mfma_f32_16x16x32_bf16 a[140:143], v[208:211], v[172:175], 0
    s_waitcnt lgkmcnt(4)
    v_cvt_pk_bf16_f32 v182, v248, v249
    v_mfma_f32_16x16x32_bf16 a[144:147], v[212:215], v[160:163], 0
    ds_read_b64_tr_b16 v[208:209], v225 offset:384
    ds_read_b64_tr_b16 v[210:211], v225 offset:8832
    v_mfma_f32_16x16x32_bf16 a[148:151], v[212:215], v[164:167], 0
    v_exp_f32 v244, v152
    v_mfma_f32_16x16x32_bf16 a[152:155], v[212:215], v[168:171], 0
    v_exp_f32 v245, v153
    v_mfma_f32_16x16x32_bf16 a[156:159], v[212:215], v[172:175], 0
    s_waitcnt lgkmcnt(4)
    v_add_f32 v237, v237, v250
    v_add_f32 v237, v237, v251
    v_mfma_f32_16x16x32_bf16 a[160:163], v[216:219], v[160:163], 0
    ds_read_b64_tr_b16 v[212:213], v225 offset:416
    ds_read_b64_tr_b16 v[214:215], v225 offset:8864
    v_mfma_f32_16x16x32_bf16 a[164:167], v[216:219], v[164:167], 0
    v_cvt_pk_bf16_f32 v183, v250, v251
    v_mfma_f32_16x16x32_bf16 a[168:171], v[216:219], v[168:171], 0
    v_exp_f32 v246, v154
    v_mfma_f32_16x16x32_bf16 a[172:175], v[216:219], v[172:175], 0
    s_waitcnt lgkmcnt(4)
    v_exp_f32 v247, v155
    v_mfma_f32_16x16x32_bf16 a[176:179], v[220:223], v[160:163], 0
    ds_read_b64_tr_b16 v[216:217], v225 offset:448
    ds_read_b64_tr_b16 v[218:219], v225 offset:8896
    v_mfma_f32_16x16x32_bf16 a[180:183], v[220:223], v[164:167], 0
    v_add_f32 v238, v238, v244
    v_add_f32 v238, v238, v245
    v_mfma_f32_16x16x32_bf16 a[184:187], v[220:223], v[168:171], 0
    v_cvt_pk_bf16_f32 v186, v244, v245
    v_mfma_f32_16x16x32_bf16 a[188:191], v[220:223], v[172:175], 0
    s_waitcnt lgkmcnt(4)
    v_exp_f32 v248, v156
    v_mfma_f32_16x16x32_bf16 a[192:195], v[208:211], v[160:163], 0
    ds_read_b64_tr_b16 v[220:221], v225 offset:480
    ds_read_b64_tr_b16 v[222:223], v225 offset:8928
    v_mfma_f32_16x16x32_bf16 a[196:199], v[208:211], v[164:167], 0
    v_exp_f32 v249, v157
    v_mfma_f32_16x16x32_bf16 a[200:203], v[208:211], v[168:171], 0
    v_add_f32 v238, v238, v246
    v_add_f32 v238, v238, v247
    v_mfma_f32_16x16x32_bf16 a[204:207], v[208:211], v[172:175], 0
    s_waitcnt lgkmcnt(4)
    v_cvt_pk_bf16_f32 v187, v246, v247
    v_mfma_f32_16x16x32_bf16 a[208:211], v[212:215], v[160:163], 0
    v_exp_f32 v250, v158
    v_mfma_f32_16x16x32_bf16 a[212:215], v[212:215], v[164:167], 0
    v_exp_f32 v251, v159
    v_mfma_f32_16x16x32_bf16 a[216:219], v[212:215], v[168:171], 0
    s_waitcnt vmcnt(1) lgkmcnt(0)
    s_barrier
    ds_read_b128 v[208:211], v224 offset:0
    v_mfma_f32_16x16x32_bf16 a[220:223], v[212:215], v[172:175], 0
    v_add_f32 v239, v239, v248
    v_add_f32 v239, v239, v249
    v_mfma_f32_16x16x32_bf16 a[224:227], v[216:219], v[160:163], 0
    ds_read_b128 v[212:215], v224 offset:64
    v_cvt_pk_bf16_f32 v190, v248, v249
    v_mfma_f32_16x16x32_bf16 a[228:231], v[216:219], v[164:167], 0
    v_add_f32 v239, v239, v250
    v_add_f32 v239, v239, v251
    v_mfma_f32_16x16x32_bf16 a[232:235], v[216:219], v[168:171], 0
    v_cvt_pk_bf16_f32 v191, v250, v251
    v_max3_f32 v244, v236, v237, v238
    v_mfma_f32_16x16x32_bf16 a[236:239], v[216:219], v[172:175], 0
    v_max_f32 v244, v244, v239
    v_cmp_lt_f32 vcc, s29, v244
    v_mfma_f32_16x16x32_bf16 a[240:243], v[220:223], v[160:163], 0
    v_mfma_f32_16x16x32_bf16 a[244:247], v[220:223], v[164:167], 0
    v_mfma_f32_16x16x32_bf16 a[248:251], v[220:223], v[168:171], 0
    v_mfma_f32_16x16x32_bf16 a[252:255], v[220:223], v[172:175], 0
    s_cbranch_vccnz L_rare_f
L_back_f:
    s_mov_b32 s33, 14
.p2align 6
L_loop:
    s_waitcnt lgkmcnt(1)
    v_mfma_f32_16x16x32_bf16 v[128:131], v[208:211], v[0:3], v[192:195]
    s_waitcnt lgkmcnt(0)
    ds_read_b128 v[216:219], v224 offset:128
    v_mfma_f32_16x16x32_bf16 v[128:131], v[212:215], v[4:7], v[128:131]
    ds_read_b128 v[220:223], v224 offset:192
    v_mfma_f32_16x16x32_bf16 v[132:135], v[208:211], v[32:35], v[196:199]
    s_add_u32 m0, s28, 33792
    v_mfma_f32_16x16x32_bf16 v[132:135], v[212:215], v[36:39], v[132:135]
    buffer_load_dwordx4 v226, s[8:11], s35 offen offset:0  lds
    v_mfma_f32_16x16x32_bf16 v[136:139], v[208:211], v[64:67], v[200:203]
    v_mfma_f32_16x16x32_bf16 v[136:139], v[212:215], v[68:71], v[136:139]
    v_mfma_f32_16x16x32_bf16 v[140:143], v[208:211], v[96:99], v[204:207]
    v_mfma_f32_16x16x32_bf16 v[140:143], v[212:215], v[100:103], v[140:143]
    s_waitcnt lgkmcnt(1)
    buffer_load_dwordx4 v226, s[8:11], 64 offen offset:1056  lds
    v_mfma_f32_16x16x32_bf16 v[128:131], v[216:219], v[8:11], v[128:131]
    s_waitcnt lgkmcnt(0)
    ds_read_b128 v[208:211], v224 offset:256
    v_mfma_f32_16x16x32_bf16 v[128:131], v[220:223], v[12:15], v[128:131]
    ds_read_b128 v[212:215], v224 offset:320
    v_mfma_f32_16x16x32_bf16 v[132:135], v[216:219], v[40:43], v[132:135]
    v_mfma_f32_16x16x32_bf16 v[132:135], v[220:223], v[44:47], v[132:135]
    buffer_load_dwordx4 v226, s[8:11], 32 offen offset:2112  lds
    v_mfma_f32_16x16x32_bf16 v[136:139], v[216:219], v[72:75], v[136:139]
    v_mfma_f32_16x16x32_bf16 v[136:139], v[220:223], v[76:79], v[136:139]
    v_mfma_f32_16x16x32_bf16 v[140:143], v[216:219], v[104:107], v[140:143]
    v_mfma_f32_16x16x32_bf16 v[140:143], v[220:223], v[108:111], v[140:143]
    s_waitcnt lgkmcnt(1)
    buffer_load_dwordx4 v226, s[8:11], 0 offen offset:3168  lds
    v_mfma_f32_16x16x32_bf16 v[128:131], v[208:211], v[16:19], v[128:131]
    s_waitcnt lgkmcnt(0)
    ds_read_b128 v[216:219], v224 offset:384
    v_mfma_f32_16x16x32_bf16 v[128:131], v[212:215], v[20:23], v[128:131]
    ds_read_b128 v[220:223], v224 offset:448
    v_mfma_f32_16x16x32_bf16 v[132:135], v[208:211], v[48:51], v[132:135]
    s_add_u32 m0, s28, 38016
    v_mfma_f32_16x16x32_bf16 v[132:135], v[212:215], v[52:55], v[132:135]
    buffer_load_dwordx4 v226, s[12:15], s35 offen offset:0  lds
    v_mfma_f32_16x16x32_bf16 v[136:139], v[208:211], v[80:83], v[136:139]
    v_mfma_f32_16x16x32_bf16 v[136:139], v[212:215], v[84:87], v[136:139]
    v_mfma_f32_16x16x32_bf16 v[140:143], v[208:211], v[112:115], v[140:143]
    v_mfma_f32_16x16x32_bf16 v[140:143], v[212:215], v[116:119], v[140:143]
    s_waitcnt lgkmcnt(1)
    buffer_load_dwordx4 v226, s[12:15], 64 offen offset:1056  lds
    v_mfma_f32_16x16x32_bf16 v[128:131], v[216:219], v[24:27], v[128:131]
    s_waitcnt lgkmcnt(0)
    ds_read_b128 v[208:211], v224 offset:8448
    v_mfma_f32_16x16x32_bf16 v[128:131], v[220:223], v[28:31], v[128:131]
    ds_read_b128 v[212:215], v224 offset:8512
    v_mfma_f32_16x16x32_bf16 v[132:135], v[216:219], v[56:59], v[132:135]
    v_mfma_f32_16x16x32_bf16 v[132:135], v[220:223], v[60:63], v[132:135]
    buffer_load_dwordx4 v226, s[12:15], 32 offen offset:2112  lds
    v_mfma_f32_16x16x32_bf16 v[136:139], v[216:219], v[88:91], v[136:139]
    v_mfma_f32_16x16x32_bf16 v[136:139], v[220:223], v[92:95], v[136:139]
    v_mfma_f32_16x16x32_bf16 v[140:143], v[216:219], v[120:123], v[140:143]
    v_mfma_f32_16x16x32_bf16 v[140:143], v[220:223], v[124:127], v[140:143]
    s_waitcnt lgkmcnt(1)
    buffer_load_dwordx4 v226, s[12:15], 0 offen offset:3168  lds
    v_mfma_f32_16x16x32_bf16 v[144:147], v[208:211], v[0:3], v[192:195]
    s_waitcnt lgkmcnt(0)
    ds_read_b128 v[216:219], v224 offset:8576
    v_mfma_f32_16x16x32_bf16 v[144:147], v[212:215], v[4:7], v[144:147]
    ds_read_b128 v[220:223], v224 offset:8640
    v_mfma_f32_16x16x32_bf16 v[148:151], v[208:211], v[32:35], v[196:199]
    s_add_u32 m0, s28, 67584
    v_mfma_f32_16x16x32_bf16 v[148:151], v[212:215], v[36:39], v[148:151]
    buffer_load_dwordx4 v226, s[16:19], s35 offen offset:0  lds
    v_mfma_f32_16x16x32_bf16 v[152:155], v[208:211], v[64:67], v[200:203]
    v_exp_f32 v244, v128
    v_mfma_f32_16x16x32_bf16 v[152:155], v[212:215], v[68:71], v[152:155]
    v_exp_f32 v245, v129
    v_mfma_f32_16x16x32_bf16 v[156:159], v[208:211], v[96:99], v[204:207]
    v_exp_f32 v246, v130
    v_mfma_f32_16x16x32_bf16 v[156:159], v[212:215], v[100:103], v[156:159]
    s_waitcnt lgkmcnt(1)
    buffer_load_dwordx4 v226, s[16:19], 64 offen offset:1056  lds
    v_mfma_f32_16x16x32_bf16 v[144:147], v[216:219], v[8:11], v[144:147]
    s_waitcnt lgkmcnt(0)
    ds_read_b128 v[208:211], v224 offset:8704
    v_mfma_f32_16x16x32_bf16 v[144:147], v[220:223], v[12:15], v[144:147]
    ds_read_b128 v[212:215], v224 offset:8768
    v_mfma_f32_16x16x32_bf16 v[148:151], v[216:219], v[40:43], v[148:151]
    v_exp_f32 v247, v131
    v_mfma_f32_16x16x32_bf16 v[148:151], v[220:223], v[44:47], v[148:151]
    buffer_load_dwordx4 v226, s[16:19], 32 offen offset:2112  lds
    v_add_f32 v228, v236, v244
    v_mfma_f32_16x16x32_bf16 v[152:155], v[216:219], v[72:75], v[152:155]
    v_add_f32 v228, v228, v245
    v_cvt_pk_bf16_f32 v160, v244, v245
    v_mfma_f32_16x16x32_bf16 v[152:155], v[220:223], v[76:79], v[152:155]
    v_exp_f32 v248, v132
    v_mfma_f32_16x16x32_bf16 v[156:159], v[216:219], v[104:107], v[156:159]
    v_exp_f32 v249, v133
    v_mfma_f32_16x16x32_bf16 v[156:159], v[220:223], v[108:111], v[156:159]
    s_waitcnt lgkmcnt(1)
    buffer_load_dwordx4 v226, s[16:19], 0 offen offset:3168  lds
    v_add_f32 v228, v228, v246
    v_mfma_f32_16x16x32_bf16 v[144:147], v[208:211], v[16:19], v[144:147]
    s_waitcnt lgkmcnt(0)
    ds_read_b128 v[216:219], v224 offset:8832
    v_add_f32 v228, v228, v247
    v_mfma_f32_16x16x32_bf16 v[144:147], v[212:215], v[20:23], v[144:147]
    ds_read_b128 v[220:223], v224 offset:8896
    v_cvt_pk_bf16_f32 v161, v246, v247
    v_mfma_f32_16x16x32_bf16 v[148:151], v[208:211], v[48:51], v[148:151]
    s_add_u32 m0, s28, 71808
    v_exp_f32 v250, v134
    v_mfma_f32_16x16x32_bf16 v[148:151], v[212:215], v[52:55], v[148:151]
    buffer_load_dwordx4 v226, s[20:23], s35 offen offset:0  lds
    v_mfma_f32_16x16x32_bf16 v[152:155], v[208:211], v[80:83], v[152:155]
    v_exp_f32 v251, v135
    v_mfma_f32_16x16x32_bf16 v[152:155], v[212:215], v[84:87], v[152:155]
    v_add_f32 v229, v237, v248
    v_add_f32 v229, v229, v249
    v_mfma_f32_16x16x32_bf16 v[156:159], v[208:211], v[112:115], v[156:159]
    v_cvt_pk_bf16_f32 v164, v248, v249
    v_mfma_f32_16x16x32_bf16 v[156:159], v[212:215], v[116:119], v[156:159]
    s_waitcnt lgkmcnt(1)
    buffer_load_dwordx4 v226, s[20:23], 64 offen offset:1056  lds
    v_mfma_f32_16x16x32_bf16 v[144:147], v[216:219], v[24:27], v[144:147]
    s_waitcnt lgkmcnt(0)
    v_exp_f32 v244, v136
    v_mfma_f32_16x16x32_bf16 v[144:147], v[220:223], v[28:31], v[144:147]
    ds_read_b64_tr_b16 v[208:209], v225 offset:33792
    ds_read_b64_tr_b16 v[210:211], v225 offset:42240
    v_mfma_f32_16x16x32_bf16 v[148:151], v[216:219], v[56:59], v[148:151]
    v_exp_f32 v245, v137
    v_mfma_f32_16x16x32_bf16 v[148:151], v[220:223], v[60:63], v[148:151]
    ds_read_b64_tr_b16 v[212:213], v225 offset:33824
    ds_read_b64_tr_b16 v[214:215], v225 offset:42272
    v_mfma_f32_16x16x32_bf16 v[152:155], v[216:219], v[88:91], v[152:155]
    buffer_load_dwordx4 v226, s[20:23], 32 offen offset:2112  lds
    v_add_f32 v229, v229, v250
    v_mfma_f32_16x16x32_bf16 v[152:155], v[220:223], v[92:95], v[152:155]
    v_add_f32 v229, v229, v251
    v_cvt_pk_bf16_f32 v165, v250, v251
    v_mfma_f32_16x16x32_bf16 v[156:159], v[216:219], v[120:123], v[156:159]
    v_exp_f32 v246, v138
    v_mfma_f32_16x16x32_bf16 v[156:159], v[220:223], v[124:127], v[156:159]
    s_waitcnt lgkmcnt(2)
    buffer_load_dwordx4 v226, s[20:23], 0 offen offset:3168  lds
    v_mfma_f32_16x16x32_bf16 a[0:3], v[208:211], v[176:179], a[0:3]
    ds_read_b64_tr_b16 v[216:217], v225 offset:33856
    ds_read_b64_tr_b16 v[218:219], v225 offset:42304
    v_add_u32 v226, 0x8000, v226
    v_mfma_f32_16x16x32_bf16 a[4:7], v[208:211], v[180:183], a[4:7]
    v_exp_f32 v247, v139
    v_mfma_f32_16x16x32_bf16 a[8:11], v[208:211], v[184:187], a[8:11]
    ds_read_b64_tr_b16 v[220:221], v225 offset:33888
    ds_read_b64_tr_b16 v[222:223], v225 offset:42336
    v_mfma_f32_16x16x32_bf16 a[12:15], v[208:211], v[188:191], a[12:15]
    s_waitcnt lgkmcnt(4)
    buffer_load_dword v254, v227, s[92:95], 0 offen
    v_add_f32 v230, v238, v244
    v_mfma_f32_16x16x32_bf16 a[16:19], v[212:215], v[176:179], a[16:19]
    ds_read_b64_tr_b16 v[208:209], v225 offset:33920
    ds_read_b64_tr_b16 v[210:211], v225 offset:42368
    v_add_u32 v227, 0x8000, v227
    v_mfma_f32_16x16x32_bf16 a[20:23], v[212:215], v[180:183], a[20:23]
    v_add_f32 v230, v230, v245
    v_cvt_pk_bf16_f32 v168, v244, v245
    v_mfma_f32_16x16x32_bf16 a[24:27], v[212:215], v[184:187], a[24:27]
    v_exp_f32 v248, v140
    v_mfma_f32_16x16x32_bf16 a[28:31], v[212:215], v[188:191], a[28:31]
    s_waitcnt lgkmcnt(4)
    v_exp_f32 v249, v141
    v_mfma_f32_16x16x32_bf16 a[32:35], v[216:219], v[176:179], a[32:35]
    ds_read_b64_tr_b16 v[212:213], v225 offset:33952
    ds_read_b64_tr_b16 v[214:215], v225 offset:42400
    v_mfma_f32_16x16x32_bf16 a[36:39], v[216:219], v[180:183], a[36:39]
    v_add_f32 v230, v230, v246
    v_add_f32 v230, v230, v247
    v_mfma_f32_16x16x32_bf16 a[40:43], v[216:219], v[184:187], a[40:43]
    v_cvt_pk_bf16_f32 v169, v246, v247
    v_mfma_f32_16x16x32_bf16 a[44:47], v[216:219], v[188:191], a[44:47]
    s_waitcnt lgkmcnt(4)
    v_exp_f32 v250, v142
    v_mfma_f32_16x16x32_bf16 a[48:51], v[220:223], v[176:179], a[48:51]
    ds_read_b64_tr_b16 v[216:217], v225 offset:33984
    ds_read_b64_tr_b16 v[218:219], v225 offset:42432
    v_mfma_f32_16x16x32_bf16 a[52:55], v[220:223], v[180:183], a[52:55]
    v_exp_f32 v251, v143
    v_mfma_f32_16x16x32_bf16 a[56:59], v[220:223], v[184:187], a[56:59]
    v_add_f32 v231, v239, v248
    v_add_f32 v231, v231, v249
    v_mfma_f32_16x16x32_bf16 a[60:63], v[220:223], v[188:191], a[60:63]
    s_waitcnt lgkmcnt(4)
    v_cvt_pk_bf16_f32 v172, v248, v249
    v_add_f32 v231, v231, v250
    v_mfma_f32_16x16x32_bf16 a[64:67], v[208:211], v[176:179], a[64:67]
    ds_read_b64_tr_b16 v[220:221], v225 offset:34016
    ds_read_b64_tr_b16 v[222:223], v225 offset:42464
    v_mfma_f32_16x16x32_bf16 a[68:71], v[208:211], v[180:183], a[68:71]
    v_add_f32 v231, v231, v251
    v_cvt_pk_bf16_f32 v173, v250, v251
    v_mfma_f32_16x16x32_bf16 a[72:75], v[208:211], v[184:187], a[72:75]
    v_exp_f32 v244, v144
    v_mfma_f32_16x16x32_bf16 a[76:79], v[208:211], v[188:191], a[76:79]
    s_waitcnt lgkmcnt(4)
    v_exp_f32 v245, v145
    v_mfma_f32_16x16x32_bf16 a[80:83], v[212:215], v[176:179], a[80:83]
    ds_read_b64_tr_b16 v[208:209], v225 offset:34048
    ds_read_b64_tr_b16 v[210:211], v225 offset:42496
    v_mfma_f32_16x16x32_bf16 a[84:87], v[212:215], v[180:183], a[84:87]
    v_exp_f32 v246, v146
    v_mfma_f32_16x16x32_bf16 a[88:91], v[212:215], v[184:187], a[88:91]
    v_exp_f32 v247, v147
    v_mfma_f32_16x16x32_bf16 a[92:95], v[212:215], v[188:191], a[92:95]
    s_waitcnt lgkmcnt(4)
    v_add_f32 v228, v228, v244
    v_add_f32 v228, v228, v245
    v_mfma_f32_16x16x32_bf16 a[96:99], v[216:219], v[176:179], a[96:99]
    ds_read_b64_tr_b16 v[212:213], v225 offset:34080
    ds_read_b64_tr_b16 v[214:215], v225 offset:42528
    v_mfma_f32_16x16x32_bf16 a[100:103], v[216:219], v[180:183], a[100:103]
    v_cvt_pk_bf16_f32 v162, v244, v245
    v_mfma_f32_16x16x32_bf16 a[104:107], v[216:219], v[184:187], a[104:107]
    v_exp_f32 v248, v148
    v_mfma_f32_16x16x32_bf16 a[108:111], v[216:219], v[188:191], a[108:111]
    s_waitcnt lgkmcnt(4)
    v_exp_f32 v249, v149
    v_mfma_f32_16x16x32_bf16 a[112:115], v[220:223], v[176:179], a[112:115]
    ds_read_b64_tr_b16 v[216:217], v225 offset:34112
    ds_read_b64_tr_b16 v[218:219], v225 offset:42560
    v_mfma_f32_16x16x32_bf16 a[116:119], v[220:223], v[180:183], a[116:119]
    v_add_f32 v228, v228, v246
    v_add_f32 v228, v228, v247
    v_mfma_f32_16x16x32_bf16 a[120:123], v[220:223], v[184:187], a[120:123]
    v_cvt_pk_bf16_f32 v163, v246, v247
    v_mfma_f32_16x16x32_bf16 a[124:127], v[220:223], v[188:191], a[124:127]
    s_waitcnt lgkmcnt(4)
    v_exp_f32 v250, v150
    v_mfma_f32_16x16x32_bf16 a[128:131], v[208:211], v[176:179], a[128:131]
    ds_read_b64_tr_b16 v[220:221], v225 offset:34144
    ds_read_b64_tr_b16 v[222:223], v225 offset:42592
    v_mfma_f32_16x16x32_bf16 a[132:135], v[208:211], v[180:183], a[132:135]
    v_exp_f32 v251, v151
    v_mfma_f32_16x16x32_bf16 a[136:139], v[208:211], v[184:187], a[136:139]
    v_add_f32 v229, v229, v248
    v_add_f32 v229, v229, v249
    v_mfma_f32_16x16x32_bf16 a[140:143], v[208:211], v[188:191], a[140:143]
    s_waitcnt lgkmcnt(4)
    v_cvt_pk_bf16_f32 v166, v248, v249
    v_mfma_f32_16x16x32_bf16 a[144:147], v[212:215], v[176:179], a[144:147]
    ds_read_b64_tr_b16 v[208:209], v225 offset:34176
    ds_read_b64_tr_b16 v[210:211], v225 offset:42624
    v_mfma_f32_16x16x32_bf16 a[148:151], v[212:215], v[180:183], a[148:151]
    v_exp_f32 v244, v152
    v_mfma_f32_16x16x32_bf16 a[152:155], v[212:215], v[184:187], a[152:155]
    v_exp_f32 v245, v153
    v_mfma_f32_16x16x32_bf16 a[156:159], v[212:215], v[188:191], a[156:159]
    s_waitcnt lgkmcnt(4)
    v_add_f32 v229, v229, v250
    v_add_f32 v229, v229, v251
    v_mfma_f32_16x16x32_bf16 a[160:163], v[216:219], v[176:179], a[160:163]
    ds_read_b64_tr_b16 v[212:213], v225 offset:34208
    ds_read_b64_tr_b16 v[214:215], v225 offset:42656
    v_mfma_f32_16x16x32_bf16 a[164:167], v[216:219], v[180:183], a[164:167]
    v_cvt_pk_bf16_f32 v167, v250, v251
    v_mfma_f32_16x16x32_bf16 a[168:171], v[216:219], v[184:187], a[168:171]
    v_exp_f32 v246, v154
    v_mfma_f32_16x16x32_bf16 a[172:175], v[216:219], v[188:191], a[172:175]
    s_waitcnt lgkmcnt(4)
    v_exp_f32 v247, v155
    v_mfma_f32_16x16x32_bf16 a[176:179], v[220:223], v[176:179], a[176:179]
    ds_read_b64_tr_b16 v[216:217], v225 offset:34240
    ds_read_b64_tr_b16 v[218:219], v225 offset:42688
    v_mfma_f32_16x16x32_bf16 a[180:183], v[220:223], v[180:183], a[180:183]
    v_add_f32 v230, v230, v244
    v_add_f32 v230, v230, v245
    v_mfma_f32_16x16x32_bf16 a[184:187], v[220:223], v[184:187], a[184:187]
    v_cvt_pk_bf16_f32 v170, v244, v245
    v_mfma_f32_16x16x32_bf16 a[188:191], v[220:223], v[188:191], a[188:191]
    s_waitcnt lgkmcnt(4)
    v_exp_f32 v248, v156
    v_mfma_f32_16x16x32_bf16 a[192:195], v[208:211], v[176:179], a[192:195]
    ds_read_b64_tr_b16 v[220:221], v225 offset:34272
    ds_read_b64_tr_b16 v[222:223], v225 offset:42720
    v_mfma_f32_16x16x32_bf16 a[196:199], v[208:211], v[180:183], a[196:199]
    v_exp_f32 v249, v157
    v_mfma_f32_16x16x32_bf16 a[200:203], v[208:211], v[184:187], a[200:203]
    v_add_f32 v230, v230, v246
    v_add_f32 v230, v230, v247
    v_mfma_f32_16x16x32_bf16 a[204:207], v[208:211], v[188:191], a[204:207]
    s_waitcnt lgkmcnt(4)
    v_cvt_pk_bf16_f32 v171, v246, v247
    v_mfma_f32_16x16x32_bf16 a[208:211], v[212:215], v[176:179], a[208:211]
    v_exp_f32 v250, v158
    v_mfma_f32_16x16x32_bf16 a[212:215], v[212:215], v[180:183], a[212:215]
    v_exp_f32 v251, v159
    v_mfma_f32_16x16x32_bf16 a[216:219], v[212:215], v[184:187], a[216:219]
    s_waitcnt vmcnt(1) lgkmcnt(0)
    s_barrier
    ds_read_b128 v[208:211], v224 offset:33792
    v_mfma_f32_16x16x32_bf16 a[220:223], v[212:215], v[188:191], a[220:223]
    v_add_f32 v231, v231, v248
    v_add_f32 v231, v231, v249
    v_mfma_f32_16x16x32_bf16 a[224:227], v[216:219], v[176:179], a[224:227]
    ds_read_b128 v[212:215], v224 offset:33856
    v_cvt_pk_bf16_f32 v174, v248, v249
    v_mfma_f32_16x16x32_bf16 a[228:231], v[216:219], v[180:183], a[228:231]
    v_add_f32 v231, v231, v250
    v_add_f32 v231, v231, v251
    v_mfma_f32_16x16x32_bf16 a[232:235], v[216:219], v[184:187], a[232:235]
    v_cvt_pk_bf16_f32 v175, v250, v251
    v_max3_f32 v244, v228, v229, v230
    v_mfma_f32_16x16x32_bf16 a[236:239], v[216:219], v[188:191], a[236:239]
    v_max_f32 v244, v244, v231
    v_cmp_lt_f32 vcc, s29, v244
    v_mfma_f32_16x16x32_bf16 a[240:243], v[220:223], v[176:179], a[240:243]
    v_mfma_f32_16x16x32_bf16 a[244:247], v[220:223], v[180:183], a[244:247]
    v_mfma_f32_16x16x32_bf16 a[248:251], v[220:223], v[184:187], a[248:251]
    v_mfma_f32_16x16x32_bf16 a[252:255], v[220:223], v[188:191], a[252:255]
    s_cbranch_vccnz L_rare_a
L_back_a:
    s_waitcnt lgkmcnt(1)
    v_mfma_f32_16x16x32_bf16 v[128:131], v[208:211], v[0:3], v[192:195]
    s_waitcnt lgkmcnt(0)
    ds_read_b128 v[216:219], v224 offset:33920
    v_mfma_f32_16x16x32_bf16 v[128:131], v[212:215], v[4:7], v[128:131]
    ds_read_b128 v[220:223], v224 offset:33984
    v_mfma_f32_16x16x32_bf16 v[132:135], v[208:211], v[32:35], v[196:199]
    s_mov_b32 m0, s28
    v_mfma_f32_16x16x32_bf16 v[132:135], v[212:215], v[36:39], v[132:135]
    buffer_load_dwordx4 v226, s[8:11], s35 offen offset:0  lds
    v_mfma_f32_16x16x32_bf16 v[136:139], v[208:211], v[64:67], v[200:203]
    v_mfma_f32_16x16x32_bf16 v[136:139], v[212:215], v[68:71], v[136:139]
    v_mfma_f32_16x16x32_bf16 v[140:143], v[208:211], v[96:99], v[204:207]
    v_mfma_f32_16x16x32_bf16 v[140:143], v[212:215], v[100:103], v[140:143]
    s_waitcnt lgkmcnt(1)
    buffer_load_dwordx4 v226, s[8:11], 64 offen offset:1056  lds
    v_mfma_f32_16x16x32_bf16 v[128:131], v[216:219], v[8:11], v[128:131]
    s_waitcnt lgkmcnt(0)
    ds_read_b128 v[208:211], v224 offset:34048
    v_mfma_f32_16x16x32_bf16 v[128:131], v[220:223], v[12:15], v[128:131]
    ds_read_b128 v[212:215], v224 offset:34112
    v_mfma_f32_16x16x32_bf16 v[132:135], v[216:219], v[40:43], v[132:135]
    v_mfma_f32_16x16x32_bf16 v[132:135], v[220:223], v[44:47], v[132:135]
    buffer_load_dwordx4 v226, s[8:11], 32 offen offset:2112  lds
    v_mfma_f32_16x16x32_bf16 v[136:139], v[216:219], v[72:75], v[136:139]
    v_mfma_f32_16x16x32_bf16 v[136:139], v[220:223], v[76:79], v[136:139]
    v_mfma_f32_16x16x32_bf16 v[140:143], v[216:219], v[104:107], v[140:143]
    v_mfma_f32_16x16x32_bf16 v[140:143], v[220:223], v[108:111], v[140:143]
    s_waitcnt lgkmcnt(1)
    buffer_load_dwordx4 v226, s[8:11], 0 offen offset:3168  lds
    v_mfma_f32_16x16x32_bf16 v[128:131], v[208:211], v[16:19], v[128:131]
    s_waitcnt lgkmcnt(0)
    ds_read_b128 v[216:219], v224 offset:34176
    v_mfma_f32_16x16x32_bf16 v[128:131], v[212:215], v[20:23], v[128:131]
    ds_read_b128 v[220:223], v224 offset:34240
    v_mfma_f32_16x16x32_bf16 v[132:135], v[208:211], v[48:51], v[132:135]
    s_add_u32 m0, s28, 4224
    v_mfma_f32_16x16x32_bf16 v[132:135], v[212:215], v[52:55], v[132:135]
    buffer_load_dwordx4 v226, s[12:15], s35 offen offset:0  lds
    v_mfma_f32_16x16x32_bf16 v[136:139], v[208:211], v[80:83], v[136:139]
    v_mfma_f32_16x16x32_bf16 v[136:139], v[212:215], v[84:87], v[136:139]
    v_mfma_f32_16x16x32_bf16 v[140:143], v[208:211], v[112:115], v[140:143]
    v_mfma_f32_16x16x32_bf16 v[140:143], v[212:215], v[116:119], v[140:143]
    s_waitcnt lgkmcnt(1)
    buffer_load_dwordx4 v226, s[12:15], 64 offen offset:1056  lds
    v_mfma_f32_16x16x32_bf16 v[128:131], v[216:219], v[24:27], v[128:131]
    s_waitcnt lgkmcnt(0)
    ds_read_b128 v[208:211], v224 offset:42240
    v_mfma_f32_16x16x32_bf16 v[128:131], v[220:223], v[28:31], v[128:131]
    ds_read_b128 v[212:215], v224 offset:42304
    v_mfma_f32_16x16x32_bf16 v[132:135], v[216:219], v[56:59], v[132:135]
    v_mfma_f32_16x16x32_bf16 v[132:135], v[220:223], v[60:63], v[132:135]
    buffer_load_dwordx4 v226, s[12:15], 32 offen offset:2112  lds
    v_mfma_f32_16x16x32_bf16 v[136:139], v[216:219], v[88:91], v[136:139]
    v_mfma_f32_16x16x32_bf16 v[136:139], v[220:223], v[92:95], v[136:139]
    v_mfma_f32_16x16x32_bf16 v[140:143], v[216:219], v[120:123], v[140:143]
    v_mfma_f32_16x16x32_bf16 v[140:143], v[220:223], v[124:127], v[140:143]
    s_waitcnt lgkmcnt(1)
    buffer_load_dwordx4 v226, s[12:15], 0 offen offset:3168  lds
    v_mfma_f32_16x16x32_bf16 v[144:147], v[208:211], v[0:3], v[192:195]
    s_waitcnt lgkmcnt(0)
    ds_read_b128 v[216:219], v224 offset:42368
    v_mfma_f32_16x16x32_bf16 v[144:147], v[212:215], v[4:7], v[144:147]
    ds_read_b128 v[220:223], v224 offset:42432
    v_mfma_f32_16x16x32_bf16 v[148:151], v[208:211], v[32:35], v[196:199]
    s_add_u32 m0, s28, 101376
    v_mfma_f32_16x16x32_bf16 v[148:151], v[212:215], v[36:39], v[148:151]
    buffer_load_dwordx4 v226, s[16:19], s35 offen offset:0  lds
    v_mfma_f32_16x16x32_bf16 v[152:155], v[208:211], v[64:67], v[200:203]
    v_exp_f32 v244, v128
    v_mfma_f32_16x16x32_bf16 v[152:155], v[212:215], v[68:71], v[152:155]
    v_exp_f32 v245, v129
    v_mfma_f32_16x16x32_bf16 v[156:159], v[208:211], v[96:99], v[204:207]
    v_exp_f32 v246, v130
    v_mfma_f32_16x16x32_bf16 v[156:159], v[212:215], v[100:103], v[156:159]
    s_waitcnt lgkmcnt(1)
    buffer_load_dwordx4 v226, s[16:19], 64 offen offset:1056  lds
    v_mfma_f32_16x16x32_bf16 v[144:147], v[216:219], v[8:11], v[144:147]
    s_waitcnt lgkmcnt(0)
    ds_read_b128 v[208:211], v224 offset:42496
    v_mfma_f32_16x16x32_bf16 v[144:147], v[220:223], v[12:15], v[144:147]
    ds_read_b128 v[212:215], v224 offset:42560
    v_mfma_f32_16x16x32_bf16 v[148:151], v[216:219], v[40:43], v[148:151]
    v_exp_f32 v247, v131
    v_mfma_f32_16x16x32_bf16 v[148:151], v[220:223], v[44:47], v[148:151]
    buffer_load_dwordx4 v226, s[16:19], 32 offen offset:2112  lds
    v_add_f32 v236, v228, v244
    v_mfma_f32_16x16x32_bf16 v[152:155], v[216:219], v[72:75], v[152:155]
    v_add_f32 v236, v236, v245
    v_cvt_pk_bf16_f32 v176, v244, v245
    v_mfma_f32_16x16x32_bf16 v[152:155], v[220:223], v[76:79], v[152:155]
    v_exp_f32 v248, v132
    v_mfma_f32_16x16x32_bf16 v[156:159], v[216:219], v[104:107], v[156:159]
    v_exp_f32 v249, v133
    v_mfma_f32_16x16x32_bf16 v[156:159], v[220:223], v[108:111], v[156:159]
    s_waitcnt lgkmcnt(1)
    buffer_load_dwordx4 v226, s[16:19], 0 offen offset:3168  lds
    v_add_f32 v236, v236, v246
    v_mfma_f32_16x16x32_bf16 v[144:147], v[208:211], v[16:19], v[144:147]
    s_waitcnt lgkmcnt(0)
    ds_read_b128 v[216:219], v224 offset:42624
    v_add_f32 v236, v236, v247
    v_mfma_f32_16x16x32_bf16 v[144:147], v[212:215], v[20:23], v[144:147]
    ds_read_b128 v[220:223], v224 offset:42688
    v_cvt_pk_bf16_f32 v177, v246, v247
    v_mfma_f32_16x16x32_bf16 v[148:151], v[208:211], v[48:51], v[148:151]
    s_add_u32 m0, s28, 105600
    v_exp_f32 v250, v134
    v_mfma_f32_16x16x32_bf16 v[148:151], v[212:215], v[52:55], v[148:151]
    buffer_load_dwordx4 v226, s[20:23], s35 offen offset:0  lds
    v_mfma_f32_16x16x32_bf16 v[152:155], v[208:211], v[80:83], v[152:155]
    v_exp_f32 v251, v135
    v_mfma_f32_16x16x32_bf16 v[152:155], v[212:215], v[84:87], v[152:155]
    v_add_f32 v237, v229, v248
    v_add_f32 v237, v237, v249
    v_mfma_f32_16x16x32_bf16 v[156:159], v[208:211], v[112:115], v[156:159]
    v_cvt_pk_bf16_f32 v180, v248, v249
    v_mfma_f32_16x16x32_bf16 v[156:159], v[212:215], v[116:119], v[156:159]
    s_waitcnt lgkmcnt(1)
    buffer_load_dwordx4 v226, s[20:23], 64 offen offset:1056  lds
    v_mfma_f32_16x16x32_bf16 v[144:147], v[216:219], v[24:27], v[144:147]
    s_waitcnt lgkmcnt(0)
    v_exp_f32 v244, v136
    v_mfma_f32_16x16x32_bf16 v[144:147], v[220:223], v[28:31], v[144:147]
    ds_read_b64_tr_b16 v[208:209], v225 offset:0
    ds_read_b64_tr_b16 v[210:211], v225 offset:8448
    v_mfma_f32_16x16x32_bf16 v[148:151], v[216:219], v[56:59], v[148:151]
    v_exp_f32 v245, v137
    v_mfma_f32_16x16x32_bf16 v[148:151], v[220:223], v[60:63], v[148:151]
    ds_read_b64_tr_b16 v[212:213], v225 offset:32
    ds_read_b64_tr_b16 v[214:215], v225 offset:8480
    v_mfma_f32_16x16x32_bf16 v[152:155], v[216:219], v[88:91], v[152:155]
    buffer_load_dwordx4 v226, s[20:23], 32 offen offset:2112  lds
    v_add_f32 v237, v237, v250
    v_mfma_f32_16x16x32_bf16 v[152:155], v[220:223], v[92:95], v[152:155]
    v_add_f32 v237, v237, v251
    v_cvt_pk_bf16_f32 v181, v250, v251
    v_mfma_f32_16x16x32_bf16 v[156:159], v[216:219], v[120:123], v[156:159]
    v_exp_f32 v246, v138
    v_mfma_f32_16x16x32_bf16 v[156:159], v[220:223], v[124:127], v[156:159]
    s_waitcnt lgkmcnt(2)
    buffer_load_dwordx4 v226, s[20:23], 0 offen offset:3168  lds
    v_mfma_f32_16x16x32_bf16 a[0:3], v[208:211], v[160:163], a[0:3]
    ds_read_b64_tr_b16 v[216:217], v225 offset:64
    ds_read_b64_tr_b16 v[218:219], v225 offset:8512
    v_add_u32 v226, 0x8000, v226
    v_mfma_f32_16x16x32_bf16 a[4:7], v[208:211], v[164:167], a[4:7]
    v_exp_f32 v247, v139
    v_mfma_f32_16x16x32_bf16 a[8:11], v[208:211], v[168:171], a[8:11]
    ds_read_b64_tr_b16 v[220:221], v225 offset:96
    ds_read_b64_tr_b16 v[222:223], v225 offset:8544
    v_mfma_f32_16x16x32_bf16 a[12:15], v[208:211], v[172:175], a[12:15]
    s_waitcnt lgkmcnt(4)
    buffer_load_dword v253, v227, s[92:95], 0 offen
    v_add_f32 v238, v230, v244
    v_mfma_f32_16x16x32_bf16 a[16:19], v[212:215], v[160:163], a[16:19]
    ds_read_b64_tr_b16 v[208:209], v225 offset:128
    ds_read_b64_tr_b16 v[210:211], v225 offset:8576
    v_add_u32 v227, 0x8000, v227
    v_mfma_f32_16x16x32_bf16 a[20:23], v[212:215], v[164:167], a[20:23]
    v_add_f32 v238, v238, v245
    v_cvt_pk_bf16_f32 v184, v244, v245
    v_mfma_f32_16x16x32_bf16 a[24:27], v[212:215], v[168:171], a[24:27]
    v_exp_f32 v248, v140
    v_mfma_f32_16x16x32_bf16 a[28:31], v[212:215], v[172:175], a[28:31]
    s_waitcnt lgkmcnt(4)
    v_exp_f32 v249, v141
    v_mfma_f32_16x16x32_bf16 a[32:35], v[216:219], v[160:163], a[32:35]
    ds_read_b64_tr_b16 v[212:213], v225 offset:160
    ds_read_b64_tr_b16 v[214:215], v225 offset:8608
    v_mfma_f32_16x16x32_bf16 a[36:39], v[216:219], v[164:167], a[36:39]
    v_add_f32 v238, v238, v246
    v_add_f32 v238, v238, v247
    v_mfma_f32_16x16x32_bf16 a[40:43], v[216:219], v[168:171], a[40:43]
    v_cvt_pk_bf16_f32 v185, v246, v247
    v_mfma_f32_16x16x32_bf16 a[44:47], v[216:219], v[172:175], a[44:47]
    s_waitcnt lgkmcnt(4)
    v_exp_f32 v250, v142
    v_mfma_f32_16x16x32_bf16 a[48:51], v[220:223], v[160:163], a[48:51]
    ds_read_b64_tr_b16 v[216:217], v225 offset:192
    ds_read_b64_tr_b16 v[218:219], v225 offset:8640
    v_mfma_f32_16x16x32_bf16 a[52:55], v[220:223], v[164:167], a[52:55]
    v_exp_f32 v251, v143
    v_mfma_f32_16x16x32_bf16 a[56:59], v[220:223], v[168:171], a[56:59]
    v_add_f32 v239, v231, v248
    v_add_f32 v239, v239, v249
    v_mfma_f32_16x16x32_bf16 a[60:63], v[220:223], v[172:175], a[60:63]
    s_waitcnt lgkmcnt(4)
    v_cvt_pk_bf16_f32 v188, v248, v249
    v_add_f32 v239, v239, v250
    v_mfma_f32_16x16x32_bf16 a[64:67], v[208:211], v[160:163], a[64:67]
    ds_read_b64_tr_b16 v[220:221], v225 offset:224
    ds_read_b64_tr_b16 v[222:223], v225 offset:8672
    v_mfma_f32_16x16x32_bf16 a[68:71], v[208:211], v[164:167], a[68:71]
    v_add_f32 v239, v239, v251
    v_cvt_pk_bf16_f32 v189, v250, v251
    v_mfma_f32_16x16x32_bf16 a[72:75], v[208:211], v[168:171], a[72:75]
    v_exp_f32 v244, v144
    v_mfma_f32_16x16x32_bf16 a[76:79], v[208:211], v[172:175], a[76:79]
    s_waitcnt lgkmcnt(4)
    v_exp_f32 v245, v145
    v_mfma_f32_16x16x32_bf16 a[80:83], v[212:215], v[160:163], a[80:83]
    ds_read_b64_tr_b16 v[208:209], v225 offset:256
    ds_read_b64_tr_b16 v[210:211], v225 offset:8704
    v_mfma_f32_16x16x32_bf16 a[84:87], v[212:215], v[164:167], a[84:87]
    v_exp_f32 v246, v146
    v_mfma_f32_16x16x32_bf16 a[88:91], v[212:215], v[168:171], a[88:91]
    v_exp_f32 v247, v147
    v_mfma_f32_16x16x32_bf16 a[92:95], v[212:215], v[172:175], a[92:95]
    s_waitcnt lgkmcnt(4)
    v_add_f32 v236, v236, v244
    v_add_f32 v236, v236, v245
    v_mfma_f32_16x16x32_bf16 a[96:99], v[216:219], v[160:163], a[96:99]
    ds_read_b64_tr_b16 v[212:213], v225 offset:288
    ds_read_b64_tr_b16 v[214:215], v225 offset:8736
    v_mfma_f32_16x16x32_bf16 a[100:103], v[216:219], v[164:167], a[100:103]
    v_cvt_pk_bf16_f32 v178, v244, v245
    v_mfma_f32_16x16x32_bf16 a[104:107], v[216:219], v[168:171], a[104:107]
    v_exp_f32 v248, v148
    v_mfma_f32_16x16x32_bf16 a[108:111], v[216:219], v[172:175], a[108:111]
    s_waitcnt lgkmcnt(4)
    v_exp_f32 v249, v149
    v_mfma_f32_16x16x32_bf16 a[112:115], v[220:223], v[160:163], a[112:115]
    ds_read_b64_tr_b16 v[216:217], v225 offset:320
    ds_read_b64_tr_b16 v[218:219], v225 offset:8768
    v_mfma_f32_16x16x32_bf16 a[116:119], v[220:223], v[164:167], a[116:119]
    v_add_f32 v236, v236, v246
    v_add_f32 v236, v236, v247
    v_mfma_f32_16x16x32_bf16 a[120:123], v[220:223], v[168:171], a[120:123]
    v_cvt_pk_bf16_f32 v179, v246, v247
    v_mfma_f32_16x16x32_bf16 a[124:127], v[220:223], v[172:175], a[124:127]
    s_waitcnt lgkmcnt(4)
    v_exp_f32 v250, v150
    v_mfma_f32_16x16x32_bf16 a[128:131], v[208:211], v[160:163], a[128:131]
    ds_read_b64_tr_b16 v[220:221], v225 offset:352
    ds_read_b64_tr_b16 v[222:223], v225 offset:8800
    v_mfma_f32_16x16x32_bf16 a[132:135], v[208:211], v[164:167], a[132:135]
    v_exp_f32 v251, v151
    v_mfma_f32_16x16x32_bf16 a[136:139], v[208:211], v[168:171], a[136:139]
    v_add_f32 v237, v237, v248
    v_add_f32 v237, v237, v249
    v_mfma_f32_16x16x32_bf16 a[140:143], v[208:211], v[172:175], a[140:143]
    s_waitcnt lgkmcnt(4)
    v_cvt_pk_bf16_f32 v182, v248, v249
    v_mfma_f32_16x16x32_bf16 a[144:147], v[212:215], v[160:163], a[144:147]
    ds_read_b64_tr_b16 v[208:209], v225 offset:384
    ds_read_b64_tr_b16 v[210:211], v225 offset:8832
    v_mfma_f32_16x16x32_bf16 a[148:151], v[212:215], v[164:167], a[148:151]
    v_exp_f32 v244, v152
    v_mfma_f32_16x16x32_bf16 a[152:155], v[212:215], v[168:171], a[152:155]
    v_exp_f32 v245, v153
    v_mfma_f32_16x16x32_bf16 a[156:159], v[212:215], v[172:175], a[156:159]
    s_waitcnt lgkmcnt(4)
    v_add_f32 v237, v237, v250
    v_add_f32 v237, v237, v251
    v_mfma_f32_16x16x32_bf16 a[160:163], v[216:219], v[160:163], a[160:163]
    ds_read_b64_tr_b16 v[212:213], v225 offset:416
    ds_read_b64_tr_b16 v[214:215], v225 offset:8864
    v_mfma_f32_16x16x32_bf16 a[164:167], v[216:219], v[164:167], a[164:167]
    v_cvt_pk_bf16_f32 v183, v250, v251
    v_mfma_f32_16x16x32_bf16 a[168:171], v[216:219], v[168:171], a[168:171]
    v_exp_f32 v246, v154
    v_mfma_f32_16x16x32_bf16 a[172:175], v[216:219], v[172:175], a[172:175]
    s_waitcnt lgkmcnt(4)
    v_exp_f32 v247, v155
    v_mfma_f32_16x16x32_bf16 a[176:179], v[220:223], v[160:163], a[176:179]
    ds_read_b64_tr_b16 v[216:217], v225 offset:448
    ds_read_b64_tr_b16 v[218:219], v225 offset:8896
    v_mfma_f32_16x16x32_bf16 a[180:183], v[220:223], v[164:167], a[180:183]
    v_add_f32 v238, v238, v244
    v_add_f32 v238, v238, v245
    v_mfma_f32_16x16x32_bf16 a[184:187], v[220:223], v[168:171], a[184:187]
    v_cvt_pk_bf16_f32 v186, v244, v245
    v_mfma_f32_16x16x32_bf16 a[188:191], v[220:223], v[172:175], a[188:191]
    s_waitcnt lgkmcnt(4)
    v_exp_f32 v248, v156
    v_mfma_f32_16x16x32_bf16 a[192:195], v[208:211], v[160:163], a[192:195]
    ds_read_b64_tr_b16 v[220:221], v225 offset:480
    ds_read_b64_tr_b16 v[222:223], v225 offset:8928
    v_mfma_f32_16x16x32_bf16 a[196:199], v[208:211], v[164:167], a[196:199]
    v_exp_f32 v249, v157
    v_mfma_f32_16x16x32_bf16 a[200:203], v[208:211], v[168:171], a[200:203]
    v_add_f32 v238, v238, v246
    v_add_f32 v238, v238, v247
    v_mfma_f32_16x16x32_bf16 a[204:207], v[208:211], v[172:175], a[204:207]
    s_waitcnt lgkmcnt(4)
    v_cvt_pk_bf16_f32 v187, v246, v247
    v_mfma_f32_16x16x32_bf16 a[208:211], v[212:215], v[160:163], a[208:211]
    v_exp_f32 v250, v158
    v_mfma_f32_16x16x32_bf16 a[212:215], v[212:215], v[164:167], a[212:215]
    v_exp_f32 v251, v159
    v_mfma_f32_16x16x32_bf16 a[216:219], v[212:215], v[168:171], a[216:219]
    s_waitcnt vmcnt(1) lgkmcnt(0)
    s_barrier
    ds_read_b128 v[208:211], v224 offset:0
    v_mfma_f32_16x16x32_bf16 a[220:223], v[212:215], v[172:175], a[220:223]
    v_add_f32 v239, v239, v248
    v_add_f32 v239, v239, v249
    v_mfma_f32_16x16x32_bf16 a[224:227], v[216:219], v[160:163], a[224:227]
    ds_read_b128 v[212:215], v224 offset:64
    v_cvt_pk_bf16_f32 v190, v248, v249
    v_mfma_f32_16x16x32_bf16 a[228:231], v[216:219], v[164:167], a[228:231]
    v_add_f32 v239, v239, v250
    v_add_f32 v239, v239, v251
    v_mfma_f32_16x16x32_bf16 a[232:235], v[216:219], v[168:171], a[232:235]
    v_cvt_pk_bf16_f32 v191, v250, v251
    v_max3_f32 v244, v236, v237, v238
    v_mfma_f32_16x16x32_bf16 a[236:239], v[216:219], v[172:175], a[236:239]
    v_max_f32 v244, v244, v239
    v_cmp_lt_f32 vcc, s29, v244
    v_mfma_f32_16x16x32_bf16 a[240:243], v[220:223], v[160:163], a[240:243]
    v_mfma_f32_16x16x32_bf16 a[244:247], v[220:223], v[164:167], a[244:247]
    v_mfma_f32_16x16x32_bf16 a[248:251], v[220:223], v[168:171], a[248:251]
    v_mfma_f32_16x16x32_bf16 a[252:255], v[220:223], v[172:175], a[252:255]
    s_cbranch_vccnz L_rare_b
L_back_b:
    s_sub_u32 s33, s33, 1
    s_cmp_lg_u32 s33, 0
    s_cbranch_scc1 L_loop
    s_waitcnt lgkmcnt(1)
    v_mfma_f32_16x16x32_bf16 v[128:131], v[208:211], v[0:3], v[192:195]
    s_waitcnt lgkmcnt(0)
    ds_read_b128 v[216:219], v224 offset:128
    v_mfma_f32_16x16x32_bf16 v[128:131], v[212:215], v[4:7], v[128:131]
    ds_read_b128 v[220:223], v224 offset:192
    v_mfma_f32_16x16x32_bf16 v[132:135], v[208:211], v[32:35], v[196:199]
    s_add_u32 m0, s28, 33792
    v_mfma_f32_16x16x32_bf16 v[132:135], v[212:215], v[36:39], v[132:135]
    buffer_load_dwordx4 v226, s[8:11], s35 offen offset:0  lds
    v_mfma_f32_16x16x32_bf16 v[136:139], v[208:211], v[64:67], v[200:203]
    v_mfma_f32_16x16x32_bf16 v[136:139], v[212:215], v[68:71], v[136:139]
    v_mfma_f32_16x16x32_bf16 v[140:143], v[208:211], v[96:99], v[204:207]
    v_mfma_f32_16x16x32_bf16 v[140:143], v[212:215], v[100:103], v[140:143]
    s_waitcnt lgkmcnt(1)
    buffer_load_dwordx4 v226, s[8:11], 64 offen offset:1056  lds
    v_mfma_f32_16x16x32_bf16 v[128:131], v[216:219], v[8:11], v[128:131]
    s_waitcnt lgkmcnt(0)
    ds_read_b128 v[208:211], v224 offset:256
    v_mfma_f32_16x16x32_bf16 v[128:131], v[220:223], v[12:15], v[128:131]
    ds_read_b128 v[212:215], v224 offset:320
    v_mfma_f32_16x16x32_bf16 v[132:135], v[216:219], v[40:43], v[132:135]
    v_mfma_f32_16x16x32_bf16 v[132:135], v[220:223], v[44:47], v[132:135]
    buffer_load_dwordx4 v226, s[8:11], 32 offen offset:2112  lds
    v_mfma_f32_16x16x32_bf16 v[136:139], v[216:219], v[72:75], v[136:139]
    v_mfma_f32_16x16x32_bf16 v[136:139], v[220:223], v[76:79], v[136:139]
    v_mfma_f32_16x16x32_bf16 v[140:143], v[216:219], v[104:107], v[140:143]
    v_mfma_f32_16x16x32_bf16 v[140:143], v[220:223], v[108:111], v[140:143]
    s_waitcnt lgkmcnt(1)
    buffer_load_dwordx4 v226, s[8:11], 0 offen offset:3168  lds
    v_mfma_f32_16x16x32_bf16 v[128:131], v[208:211], v[16:19], v[128:131]
    s_waitcnt lgkmcnt(0)
    ds_read_b128 v[216:219], v224 offset:384
    v_mfma_f32_16x16x32_bf16 v[128:131], v[212:215], v[20:23], v[128:131]
    ds_read_b128 v[220:223], v224 offset:448
    v_mfma_f32_16x16x32_bf16 v[132:135], v[208:211], v[48:51], v[132:135]
    s_add_u32 m0, s28, 38016
    v_mfma_f32_16x16x32_bf16 v[132:135], v[212:215], v[52:55], v[132:135]
    buffer_load_dwordx4 v226, s[12:15], s35 offen offset:0  lds
    v_mfma_f32_16x16x32_bf16 v[136:139], v[208:211], v[80:83], v[136:139]
    v_mfma_f32_16x16x32_bf16 v[136:139], v[212:215], v[84:87], v[136:139]
    v_mfma_f32_16x16x32_bf16 v[140:143], v[208:211], v[112:115], v[140:143]
    v_mfma_f32_16x16x32_bf16 v[140:143], v[212:215], v[116:119], v[140:143]
    s_waitcnt lgkmcnt(1)
    buffer_load_dwordx4 v226, s[12:15], 64 offen offset:1056  lds
    v_mfma_f32_16x16x32_bf16 v[128:131], v[216:219], v[24:27], v[128:131]
    s_waitcnt lgkmcnt(0)
    ds_read_b128 v[208:211], v224 offset:8448
    v_mfma_f32_16x16x32_bf16 v[128:131], v[220:223], v[28:31], v[128:131]
    ds_read_b128 v[212:215], v224 offset:8512
    v_mfma_f32_16x16x32_bf16 v[132:135], v[216:219], v[56:59], v[132:135]
    v_mfma_f32_16x16x32_bf16 v[132:135], v[220:223], v[60:63], v[132:135]
    buffer_load_dwordx4 v226, s[12:15], 32 offen offset:2112  lds
    v_mfma_f32_16x16x32_bf16 v[136:139], v[216:219], v[88:91], v[136:139]
    v_mfma_f32_16x16x32_bf16 v[136:139], v[220:223], v[92:95], v[136:139]
    v_mfma_f32_16x16x32_bf16 v[140:143], v[216:219], v[120:123], v[140:143]
    v_mfma_f32_16x16x32_bf16 v[140:143], v[220:223], v[124:127], v[140:143]
    s_waitcnt lgkmcnt(1)
    buffer_load_dwordx4 v226, s[12:15], 0 offen offset:3168  lds
    v_mfma_f32_16x16x32_bf16 v[144:147], v[208:211], v[0:3], v[192:195]
    s_waitcnt lgkmcnt(0)
    ds_read_b128 v[216:219], v224 offset:8576
    v_mfma_f32_16x16x32_bf16 v[144:147], v[212:215], v[4:7], v[144:147]
    ds_read_b128 v[220:223], v224 offset:8640
    v_mfma_f32_16x16x32_bf16 v[148:151], v[208:211], v[32:35], v[196:199]
    s_add_u32 m0, s28, 67584
    v_mfma_f32_16x16x32_bf16 v[148:151], v[212:215], v[36:39], v[148:151]
    buffer_load_dwordx4 v226, s[16:19], s35 offen offset:0  lds
    v_mfma_f32_16x16x32_bf16 v[152:155], v[208:211], v[64:67], v[200:203]
    v_exp_f32 v244, v128
    v_mfma_f32_16x16x32_bf16 v[152:155], v[212:215], v[68:71], v[152:155]
    v_exp_f32 v245, v129
    v_mfma_f32_16x16x32_bf16 v[156:159], v[208:211], v[96:99], v[204:207]
    v_exp_f32 v246, v130
    v_mfma_f32_16x16x32_bf16 v[156:159], v[212:215], v[100:103], v[156:159]
    s_waitcnt lgkmcnt(1)
    buffer_load_dwordx4 v226, s[16:19], 64 offen offset:1056  lds
    v_mfma_f32_16x16x32_bf16 v[144:147], v[216:219], v[8:11], v[144:147]
    s_waitcnt lgkmcnt(0)
    ds_read_b128 v[208:211], v224 offset:8704
    v_mfma_f32_16x16x32_bf16 v[144:147], v[220:223], v[12:15], v[144:147]
    ds_read_b128 v[212:215], v224 offset:8768
    v_mfma_f32_16x16x32_bf16 v[148:151], v[216:219], v[40:43], v[148:151]
    v_exp_f32 v247, v131
    v_mfma_f32_16x16x32_bf16 v[148:151], v[220:223], v[44:47], v[148:151]
    buffer_load_dwordx4 v226, s[16:19], 32 offen offset:2112  lds
    v_add_f32 v228, v236, v244
    v_mfma_f32_16x16x32_bf16 v[152:155], v[216:219], v[72:75], v[152:155]
    v_add_f32 v228, v228, v245
    v_cvt_pk_bf16_f32 v160, v244, v245
    v_mfma_f32_16x16x32_bf16 v[152:155], v[220:223], v[76:79], v[152:155]
    v_exp_f32 v248, v132
    v_mfma_f32_16x16x32_bf16 v[156:159], v[216:219], v[104:107], v[156:159]
    v_exp_f32 v249, v133
    v_mfma_f32_16x16x32_bf16 v[156:159], v[220:223], v[108:111], v[156:159]
    s_waitcnt lgkmcnt(1)
    buffer_load_dwordx4 v226, s[16:19], 0 offen offset:3168  lds
    v_add_f32 v228, v228, v246
    v_mfma_f32_16x16x32_bf16 v[144:147], v[208:211], v[16:19], v[144:147]
    s_waitcnt lgkmcnt(0)
    ds_read_b128 v[216:219], v224 offset:8832
    v_add_f32 v228, v228, v247
    v_mfma_f32_16x16x32_bf16 v[144:147], v[212:215], v[20:23], v[144:147]
    ds_read_b128 v[220:223], v224 offset:8896
    v_cvt_pk_bf16_f32 v161, v246, v247
    v_mfma_f32_16x16x32_bf16 v[148:151], v[208:211], v[48:51], v[148:151]
    s_add_u32 m0, s28, 71808
    v_exp_f32 v250, v134
    v_mfma_f32_16x16x32_bf16 v[148:151], v[212:215], v[52:55], v[148:151]
    buffer_load_dwordx4 v226, s[20:23], s35 offen offset:0  lds
    v_mfma_f32_16x16x32_bf16 v[152:155], v[208:211], v[80:83], v[152:155]
    v_exp_f32 v251, v135
    v_mfma_f32_16x16x32_bf16 v[152:155], v[212:215], v[84:87], v[152:155]
    v_add_f32 v229, v237, v248
    v_add_f32 v229, v229, v249
    v_mfma_f32_16x16x32_bf16 v[156:159], v[208:211], v[112:115], v[156:159]
    v_cvt_pk_bf16_f32 v164, v248, v249
    v_mfma_f32_16x16x32_bf16 v[156:159], v[212:215], v[116:119], v[156:159]
    s_waitcnt lgkmcnt(1)
    buffer_load_dwordx4 v226, s[20:23], 64 offen offset:1056  lds
    v_mfma_f32_16x16x32_bf16 v[144:147], v[216:219], v[24:27], v[144:147]
    s_waitcnt lgkmcnt(0)
    v_exp_f32 v244, v136
    v_mfma_f32_16x16x32_bf16 v[144:147], v[220:223], v[28:31], v[144:147]
    ds_read_b64_tr_b16 v[208:209], v225 offset:33792
    ds_read_b64_tr_b16 v[210:211], v225 offset:42240
    v_mfma_f32_16x16x32_bf16 v[148:151], v[216:219], v[56:59], v[148:151]
    v_exp_f32 v245, v137
    v_mfma_f32_16x16x32_bf16 v[148:151], v[220:223], v[60:63], v[148:151]
    ds_read_b64_tr_b16 v[212:213], v225 offset:33824
    ds_read_b64_tr_b16 v[214:215], v225 offset:42272
    v_mfma_f32_16x16x32_bf16 v[152:155], v[216:219], v[88:91], v[152:155]
    buffer_load_dwordx4 v226, s[20:23], 32 offen offset:2112  lds
    v_add_f32 v229, v229, v250
    v_mfma_f32_16x16x32_bf16 v[152:155], v[220:223], v[92:95], v[152:155]
    v_add_f32 v229, v229, v251
    v_cvt_pk_bf16_f32 v165, v250, v251
    v_mfma_f32_16x16x32_bf16 v[156:159], v[216:219], v[120:123], v[156:159]
    v_exp_f32 v246, v138
    v_mfma_f32_16x16x32_bf16 v[156:159], v[220:223], v[124:127], v[156:159]
    s_waitcnt lgkmcnt(2)
    buffer_load_dwordx4 v226, s[20:23], 0 offen offset:3168  lds
    v_mfma_f32_16x16x32_bf16 a[0:3], v[208:211], v[176:179], a[0:3]
    ds_read_b64_tr_b16 v[216:217], v225 offset:33856
    ds_read_b64_tr_b16 v[218:219], v225 offset:42304
    v_add_u32 v226, 0x8000, v226
    v_mfma_f32_16x16x32_bf16 a[4:7], v[208:211], v[180:183], a[4:7]
    v_exp_f32 v247, v139
    v_mfma_f32_16x16x32_bf16 a[8:11], v[208:211], v[184:187], a[8:11]
    ds_read_b64_tr_b16 v[220:221], v225 offset:33888
    ds_read_b64_tr_b16 v[222:223], v225 offset:42336
    v_mfma_f32_16x16x32_bf16 a[12:15], v[208:211], v[188:191], a[12:15]
    s_waitcnt lgkmcnt(4)
    buffer_load_dword v254, v227, s[92:95], 0 offen
    v_add_f32 v230, v238, v244
    v_mfma_f32_16x16x32_bf16 a[16:19], v[212:215], v[176:179], a[16:19]
    ds_read_b64_tr_b16 v[208:209], v225 offset:33920
    ds_read_b64_tr_b16 v[210:211], v225 offset:42368
    v_add_u32 v227, 0x8000, v227
    v_mfma_f32_16x16x32_bf16 a[20:23], v[212:215], v[180:183], a[20:23]
    v_add_f32 v230, v230, v245
    v_cvt_pk_bf16_f32 v168, v244, v245
    v_mfma_f32_16x16x32_bf16 a[24:27], v[212:215], v[184:187], a[24:27]
    v_exp_f32 v248, v140
    v_mfma_f32_16x16x32_bf16 a[28:31], v[212:215], v[188:191], a[28:31]
    s_waitcnt lgkmcnt(4)
    buffer_load_dword v255, v242, s[48:51], 0 offen
    v_mfma_f32_16x16x32_bf16 a[32:35], v[216:219], v[176:179], a[32:35]
    ds_read_b64_tr_b16 v[212:213], v225 offset:33952
    ds_read_b64_tr_b16 v[214:215], v225 offset:42400
    v_mfma_f32_16x16x32_bf16 a[36:39], v[216:219], v[180:183], a[36:39]
    v_exp_f32 v249, v141
    v_mfma_f32_16x16x32_bf16 a[40:43], v[216:219], v[184:187], a[40:43]
    v_add_f32 v230, v230, v246
    v_add_f32 v230, v230, v247
    v_mfma_f32_16x16x32_bf16 a[44:47], v[216:219], v[188:191], a[44:47]
    s_waitcnt lgkmcnt(4)
    v_cvt_pk_bf16_f32 v169, v246, v247
    v_mfma_f32_16x16x32_bf16 a[48:51], v[220:223], v[176:179], a[48:51]
    ds_read_b64_tr_b16 v[216:217], v225 offset:33984
    ds_read_b64_tr_b16 v[218:219], v225 offset:42432
    v_mfma_f32_16x16x32_bf16 a[52:55], v[220:223], v[180:183], a[52:55]
    v_exp_f32 v250, v142
    v_mfma_f32_16x16x32_bf16 a[56:59], v[220:223], v[184:187], a[56:59]
    v_exp_f32 v251, v143
    v_mfma_f32_16x16x32_bf16 a[60:63], v[220:223], v[188:191], a[60:63]
    s_waitcnt lgkmcnt(4)
    v_add_f32 v231, v239, v248
    v_add_f32 v231, v231, v249
    v_mfma_f32_16x16x32_bf16 a[64:67], v[208:211], v[176:179], a[64:67]
    ds_read_b64_tr_b16 v[220:221], v225 offset:34016
    ds_read_b64_tr_b16 v[222:223], v225 offset:42464
    v_mfma_f32_16x16x32_bf16 a[68:71], v[208:211], v[180:183], a[68:71]
    v_cvt_pk_bf16_f32 v172, v248, v249
    v_add_f32 v231, v231, v250
    v_mfma_f32_16x16x32_bf16 a[72:75], v[208:211], v[184:187], a[72:75]
    v_add_f32 v231, v231, v251
    v_cvt_pk_bf16_f32 v173, v250, v251
    v_mfma_f32_16x16x32_bf16 a[76:79], v[208:211], v[188:191], a[76:79]
    s_waitcnt lgkmcnt(4)
    v_exp_f32 v244, v144
    v_mfma_f32_16x16x32_bf16 a[80:83], v[212:215], v[176:179], a[80:83]
    ds_read_b64_tr_b16 v[208:209], v225 offset:34048
    ds_read_b64_tr_b16 v[210:211], v225 offset:42496
    v_mfma_f32_16x16x32_bf16 a[84:87], v[212:215], v[180:183], a[84:87]
    v_exp_f32 v245, v145
    v_mfma_f32_16x16x32_bf16 a[88:91], v[212:215], v[184:187], a[88:91]
    v_exp_f32 v246, v146
    v_mfma_f32_16x16x32_bf16 a[92:95], v[212:215], v[188:191], a[92:95]
    s_waitcnt lgkmcnt(4)
    v_exp_f32 v247, v147
    v_mfma_f32_16x16x32_bf16 a[96:99], v[216:219], v[176:179], a[96:99]
    ds_read_b64_tr_b16 v[212:213], v225 offset:34080
    ds_read_b64_tr_b16 v[214:215], v225 offset:42528
    v_mfma_f32_16x16x32_bf16 a[100:103], v[216:219], v[180:183], a[100:103]
    v_add_f32 v228, v228, v244
    v_add_f32 v228, v228, v245
    v_mfma_f32_16x16x32_bf16 a[104:107], v[216:219], v[184:187], a[104:107]
    v_cvt_pk_bf16_f32 v162, v244, v245
    v_mfma_f32_16x16x32_bf16 a[108:111], v[216:219], v[188:191], a[108:111]
    s_waitcnt lgkmcnt(4)
    v_exp_f32 v248, v148
    v_mfma_f32_16x16x32_bf16 a[112:115], v[220:223], v[176:179], a[112:115]
    ds_read_b64_tr_b16 v[216:217], v225 offset:34112
    ds_read_b64_tr_b16 v[218:219], v225 offset:42560
    v_mfma_f32_16x16x32_bf16 a[116:119], v[220:223], v[180:183], a[116:119]
    v_exp_f32 v249, v149
    v_mfma_f32_16x16x32_bf16 a[120:123], v[220:223], v[184:187], a[120:123]
    v_add_f32 v228, v228, v246
    v_add_f32 v228, v228, v247
    v_mfma_f32_16x16x32_bf16 a[124:127], v[220:223], v[188:191], a[124:127]
    s_waitcnt lgkmcnt(4)
    v_cvt_pk_bf16_f32 v163, v246, v247
    v_mfma_f32_16x16x32_bf16 a[128:131], v[208:211], v[176:179], a[128:131]
    ds_read_b64_tr_b16 v[220:221], v225 offset:34144
    ds_read_b64_tr_b16 v[222:223], v225 offset:42592
    v_mfma_f32_16x16x32_bf16 a[132:135], v[208:211], v[180:183], a[132:135]
    v_exp_f32 v250, v150
    v_mfma_f32_16x16x32_bf16 a[136:139], v[208:211], v[184:187], a[136:139]
    v_exp_f32 v251, v151
    v_mfma_f32_16x16x32_bf16 a[140:143], v[208:211], v[188:191], a[140:143]
    s_waitcnt lgkmcnt(4)
    v_add_f32 v229, v229, v248
    v_add_f32 v229, v229, v249
    v_mfma_f32_16x16x32_bf16 a[144:147], v[212:215], v[176:179], a[144:147]
    ds_read_b64_tr_b16 v[208:209], v225 offset:34176
    ds_read_b64_tr_b16 v[210:211], v225 offset:42624
    v_mfma_f32_16x16x32_bf16 a[148:151], v[212:215], v[180:183], a[148:151]
    v_cvt_pk_bf16_f32 v166, v248, v249
    v_mfma_f32_16x16x32_bf16 a[152:155], v[212:215], v[184:187], a[152:155]
    v_exp_f32 v244, v152
    v_mfma_f32_16x16x32_bf16 a[156:159], v[212:215], v[188:191], a[156:159]
    s_waitcnt lgkmcnt(4)
    v_exp_f32 v245, v153
    v_mfma_f32_16x16x32_bf16 a[160:163], v[216:219], v[176:179], a[160:163]
    ds_read_b64_tr_b16 v[212:213], v225 offset:34208
    ds_read_b64_tr_b16 v[214:215], v225 offset:42656
    v_mfma_f32_16x16x32_bf16 a[164:167], v[216:219], v[180:183], a[164:167]
    v_add_f32 v229, v229, v250
    v_add_f32 v229, v229, v251
    v_mfma_f32_16x16x32_bf16 a[168:171], v[216:219], v[184:187], a[168:171]
    v_cvt_pk_bf16_f32 v167, v250, v251
    v_mfma_f32_16x16x32_bf16 a[172:175], v[216:219], v[188:191], a[172:175]
    s_waitcnt lgkmcnt(4)
    v_exp_f32 v246, v154
    v_mfma_f32_16x16x32_bf16 a[176:179], v[220:223], v[176:179], a[176:179]
    ds_read_b64_tr_b16 v[216:217], v225 offset:34240
    ds_read_b64_tr_b16 v[218:219], v225 offset:42688
    v_mfma_f32_16x16x32_bf16 a[180:183], v[220:223], v[180:183], a[180:183]
    v_exp_f32 v247, v155
    v_mfma_f32_16x16x32_bf16 a[184:187], v[220:223], v[184:187], a[184:187]
    v_add_f32 v230, v230, v244
    v_add_f32 v230, v230, v245
    v_mfma_f32_16x16x32_bf16 a[188:191], v[220:223], v[188:191], a[188:191]
    s_waitcnt lgkmcnt(4)
    v_cvt_pk_bf16_f32 v170, v244, v245
    v_mfma_f32_16x16x32_bf16 a[192:195], v[208:211], v[176:179], a[192:195]
    ds_read_b64_tr_b16 v[220:221], v225 offset:34272
    ds_read_b64_tr_b16 v[222:223], v225 offset:42720
    v_mfma_f32_16x16x32_bf16 a[196:199], v[208:211], v[180:183], a[196:199]
    v_exp_f32 v248, v156
    v_mfma_f32_16x16x32_bf16 a[200:203], v[208:211], v[184:187], a[200:203]
    v_exp_f32 v249, v157
    v_mfma_f32_16x16x32_bf16 a[204:207], v[208:211], v[188:191], a[204:207]
    s_waitcnt lgkmcnt(4)
    v_add_f32 v230, v230, v246
    v_add_f32 v230, v230, v247
    v_mfma_f32_16x16x32_bf16 a[208:211], v[212:215], v[176:179], a[208:211]
    v_cvt_pk_bf16_f32 v171, v246, v247
    v_mfma_f32_16x16x32_bf16 a[212:215], v[212:215], v[180:183], a[212:215]
    v_exp_f32 v250, v158
    v_mfma_f32_16x16x32_bf16 a[216:219], v[212:215], v[184:187], a[216:219]
    s_waitcnt vmcnt(2) lgkmcnt(0)
    s_barrier
    ds_read_b128 v[208:211], v224 offset:33792
    v_mfma_f32_16x16x32_bf16 a[220:223], v[212:215], v[188:191], a[220:223]
    v_exp_f32 v251, v159
    v_mfma_f32_16x16x32_bf16 a[224:227], v[216:219], v[176:179], a[224:227]
    ds_read_b128 v[212:215], v224 offset:33856
    v_add_f32 v231, v231, v248
    v_mfma_f32_16x16x32_bf16 a[228:231], v[216:219], v[180:183], a[228:231]
    v_add_f32 v231, v231, v249
    v_cvt_pk_bf16_f32 v174, v248, v249
    v_mfma_f32_16x16x32_bf16 a[232:235], v[216:219], v[184:187], a[232:235]
    v_add_f32 v231, v231, v250
    v_add_f32 v231, v231, v251
    v_mfma_f32_16x16x32_bf16 a[236:239], v[216:219], v[188:191], a[236:239]
    v_cvt_pk_bf16_f32 v175, v250, v251
    v_max3_f32 v244, v228, v229, v230
    v_mfma_f32_16x16x32_bf16 a[240:243], v[220:223], v[176:179], a[240:243]
    v_max_f32 v244, v244, v231
    v_cmp_lt_f32 vcc, s29, v244
    v_mfma_f32_16x16x32_bf16 a[244:247], v[220:223], v[180:183], a[244:247]
    v_mfma_f32_16x16x32_bf16 a[248:251], v[220:223], v[184:187], a[248:251]
    v_mfma_f32_16x16x32_bf16 a[252:255], v[220:223], v[188:191], a[252:255]
    s_cbranch_vccnz L_rare_c
L_back_c:
    s_waitcnt lgkmcnt(1)
    v_mfma_f32_16x16x32_bf16 v[128:131], v[208:211], v[0:3], v[192:195]
    s_waitcnt lgkmcnt(0)
    ds_read_b128 v[216:219], v224 offset:33920
    v_mfma_f32_16x16x32_bf16 v[128:131], v[212:215], v[4:7], v[128:131]
    ds_read_b128 v[220:223], v224 offset:33984
    v_mfma_f32_16x16x32_bf16 v[132:135], v[208:211], v[32:35], v[196:199]
    s_add_u32 m0, s28, 101376
    v_mfma_f32_16x16x32_bf16 v[132:135], v[212:215], v[36:39], v[132:135]
    buffer_load_dwordx4 v226, s[16:19], s35 offen offset:0  lds
    v_mfma_f32_16x16x32_bf16 v[136:139], v[208:211], v[64:67], v[200:203]
    v_mfma_f32_16x16x32_bf16 v[136:139], v[212:215], v[68:71], v[136:139]
    v_mfma_f32_16x16x32_bf16 v[140:143], v[208:211], v[96:99], v[204:207]
    v_mfma_f32_16x16x32_bf16 v[140:143], v[212:215], v[100:103], v[140:143]
    s_waitcnt lgkmcnt(1)
    buffer_load_dwordx4 v226, s[16:19], 64 offen offset:1056  lds
    v_mfma_f32_16x16x32_bf16 v[128:131], v[216:219], v[8:11], v[128:131]
    s_waitcnt lgkmcnt(0)
    ds_read_b128 v[208:211], v224 offset:34048
    v_mfma_f32_16x16x32_bf16 v[128:131], v[220:223], v[12:15], v[128:131]
    ds_read_b128 v[212:215], v224 offset:34112
    v_mfma_f32_16x16x32_bf16 v[132:135], v[216:219], v[40:43], v[132:135]
    v_mfma_f32_16x16x32_bf16 v[132:135], v[220:223], v[44:47], v[132:135]
    buffer_load_dwordx4 v226, s[16:19], 32 offen offset:2112  lds
    v_mfma_f32_16x16x32_bf16 v[136:139], v[216:219], v[72:75], v[136:139]
    v_mfma_f32_16x16x32_bf16 v[136:139], v[220:223], v[76:79], v[136:139]
    v_mfma_f32_16x16x32_bf16 v[140:143], v[216:219], v[104:107], v[140:143]
    v_mfma_f32_16x16x32_bf16 v[140:143], v[220:223], v[108:111], v[140:143]
    s_waitcnt lgkmcnt(1)
    buffer_load_dwordx4 v226, s[16:19], 0 offen offset:3168  lds
    v_mfma_f32_16x16x32_bf16 v[128:131], v[208:211], v[16:19], v[128:131]
    s_waitcnt lgkmcnt(0)
    ds_read_b128 v[216:219], v224 offset:34176
    v_mfma_f32_16x16x32_bf16 v[128:131], v[212:215], v[20:23], v[128:131]
    ds_read_b128 v[220:223], v224 offset:34240
    v_mfma_f32_16x16x32_bf16 v[132:135], v[208:211], v[48:51], v[132:135]
    s_add_u32 m0, s28, 105600
    v_mfma_f32_16x16x32_bf16 v[132:135], v[212:215], v[52:55], v[132:135]
    buffer_load_dwordx4 v226, s[20:23], s35 offen offset:0  lds
    v_mfma_f32_16x16x32_bf16 v[136:139], v[208:211], v[80:83], v[136:139]
    v_mfma_f32_16x16x32_bf16 v[136:139], v[212:215], v[84:87], v[136:139]
    v_mfma_f32_16x16x32_bf16 v[140:143], v[208:211], v[112:115], v[140:143]
    v_mfma_f32_16x16x32_bf16 v[140:143], v[212:215], v[116:119], v[140:143]
    s_waitcnt lgkmcnt(1)
    buffer_load_dwordx4 v226, s[20:23], 64 offen offset:1056  lds
    v_mfma_f32_16x16x32_bf16 v[128:131], v[216:219], v[24:27], v[128:131]
    s_waitcnt lgkmcnt(0)
    ds_read_b128 v[208:211], v224 offset:42240
    v_mfma_f32_16x16x32_bf16 v[128:131], v[220:223], v[28:31], v[128:131]
    ds_read_b128 v[212:215], v224 offset:42304
    v_mfma_f32_16x16x32_bf16 v[132:135], v[216:219], v[56:59], v[132:135]
    v_mfma_f32_16x16x32_bf16 v[132:135], v[220:223], v[60:63], v[132:135]
    buffer_load_dwordx4 v226, s[20:23], 32 offen offset:2112  lds
    v_mfma_f32_16x16x32_bf16 v[136:139], v[216:219], v[88:91], v[136:139]
    v_mfma_f32_16x16x32_bf16 v[136:139], v[220:223], v[92:95], v[136:139]
    v_mfma_f32_16x16x32_bf16 v[140:143], v[216:219], v[120:123], v[140:143]
    v_mfma_f32_16x16x32_bf16 v[140:143], v[220:223], v[124:127], v[140:143]
    s_waitcnt lgkmcnt(1)
    buffer_load_dwordx4 v226, s[20:23], 0 offen offset:3168  lds
    v_mfma_f32_16x16x32_bf16 v[144:147], v[208:211], v[0:3], v[192:195]
    s_waitcnt lgkmcnt(0)
    ds_read_b128 v[216:219], v224 offset:42368
    v_add_u32 v226, 0x8000, v226
    v_mfma_f32_16x16x32_bf16 v[144:147], v[212:215], v[4:7], v[144:147]
    ds_read_b128 v[220:223], v224 offset:42432
    v_mfma_f32_16x16x32_bf16 v[148:151], v[208:211], v[32:35], v[196:199]
    v_mfma_f32_16x16x32_bf16 v[148:151], v[212:215], v[36:39], v[148:151]
    v_mfma_f32_16x16x32_bf16 v[152:155], v[208:211], v[64:67], v[200:203]
    v_exp_f32 v244, v128
    v_mfma_f32_16x16x32_bf16 v[152:155], v[212:215], v[68:71], v[152:155]
    v_exp_f32 v245, v129
    v_mfma_f32_16x16x32_bf16 v[156:159], v[208:211], v[96:99], v[204:207]
    v_exp_f32 v246, v130
    v_mfma_f32_16x16x32_bf16 v[156:159], v[212:215], v[100:103], v[156:159]
    s_waitcnt lgkmcnt(1)
    v_mfma_f32_16x16x32_bf16 v[144:147], v[216:219], v[8:11], v[144:147]
    s_waitcnt lgkmcnt(0)
    ds_read_b128 v[208:211], v224 offset:42496
    v_mfma_f32_16x16x32_bf16 v[144:147], v[220:223], v[12:15], v[144:147]
    ds_read_b128 v[212:215], v224 offset:42560
    v_mfma_f32_16x16x32_bf16 v[148:151], v[216:219], v[40:43], v[148:151]
    v_exp_f32 v247, v131
    v_mfma_f32_16x16x32_bf16 v[148:151], v[220:223], v[44:47], v[148:151]
    v_add_f32 v236, v228, v244
    v_add_f32 v236, v236, v245
    v_mfma_f32_16x16x32_bf16 v[152:155], v[216:219], v[72:75], v[152:155]
    v_cvt_pk_bf16_f32 v176, v244, v245
    v_mfma_f32_16x16x32_bf16 v[152:155], v[220:223], v[76:79], v[152:155]
    v_exp_f32 v248, v132
    v_mfma_f32_16x16x32_bf16 v[156:159], v[216:219], v[104:107], v[156:159]
    v_exp_f32 v249, v133
    v_mfma_f32_16x16x32_bf16 v[156:159], v[220:223], v[108:111], v[156:159]
    s_waitcnt lgkmcnt(1)
    v_add_f32 v236, v236, v246
    v_add_f32 v236, v236, v247
    v_mfma_f32_16x16x32_bf16 v[144:147], v[208:211], v[16:19], v[144:147]
    s_waitcnt lgkmcnt(0)
    ds_read_b128 v[216:219], v224 offset:42624
    v_cvt_pk_bf16_f32 v177, v246, v247
    v_mfma_f32_16x16x32_bf16 v[144:147], v[212:215], v[20:23], v[144:147]
    ds_read_b128 v[220:223], v224 offset:42688
    v_mfma_f32_16x16x32_bf16 v[148:151], v[208:211], v[48:51], v[148:151]
    v_exp_f32 v250, v134
    v_mfma_f32_16x16x32_bf16 v[148:151], v[212:215], v[52:55], v[148:151]
    v_exp_f32 v251, v135
    v_mfma_f32_16x16x32_bf16 v[152:155], v[208:211], v[80:83], v[152:155]
    v_add_f32 v237, v229, v248
    v_mfma_f32_16x16x32_bf16 v[152:155], v[212:215], v[84:87], v[152:155]
    v_add_f32 v237, v237, v249
    v_cvt_pk_bf16_f32 v180, v248, v249
    v_mfma_f32_16x16x32_bf16 v[156:159], v[208:211], v[112:115], v[156:159]
    v_exp_f32 v244, v136
    v_mfma_f32_16x16x32_bf16 v[156:159], v[212:215], v[116:119], v[156:159]
    s_waitcnt lgkmcnt(1)
    v_mfma_f32_16x16x32_bf16 v[144:147], v[216:219], v[24:27], v[144:147]
    s_waitcnt lgkmcnt(0)
    v_exp_f32 v245, v137
    v_mfma_f32_16x16x32_bf16 v[144:147], v[220:223], v[28:31], v[144:147]
    ds_read_b64_tr_b16 v[208:209], v225 offset:0
    ds_read_b64_tr_b16 v[210:211], v225 offset:8448
    v_mfma_f32_16x16x32_bf16 v[148:151], v[216:219], v[56:59], v[148:151]
    v_add_f32 v237, v237, v250
    v_add_f32 v237, v237, v251
    v_mfma_f32_16x16x32_bf16 v[148:151], v[220:223], v[60:63], v[148:151]
    ds_read_b64_tr_b16 v[212:213], v225 offset:32
    ds_read_b64_tr_b16 v[214:215], v225 offset:8480
    v_mfma_f32_16x16x32_bf16 v[152:155], v[216:219], v[88:91], v[152:155]
    v_cvt_pk_bf16_f32 v181, v250, v251
    v_mfma_f32_16x16x32_bf16 v[152:155], v[220:223], v[92:95], v[152:155]
    v_exp_f32 v246, v138
    v_mfma_f32_16x16x32_bf16 v[156:159], v[216:219], v[120:123], v[156:159]
    v_exp_f32 v247, v139
    v_mfma_f32_16x16x32_bf16 v[156:159], v[220:223], v[124:127], v[156:159]
    s_waitcnt lgkmcnt(2)
    v_add_f32 v238, v230, v244
    v_add_f32 v238, v238, v245
    v_mfma_f32_16x16x32_bf16 a[0:3], v[208:211], v[160:163], a[0:3]
    ds_read_b64_tr_b16 v[216:217], v225 offset:64
    ds_read_b64_tr_b16 v[218:219], v225 offset:8512
    v_mfma_f32_16x16x32_bf16 a[4:7], v[208:211], v[164:167], a[4:7]
    v_cvt_pk_bf16_f32 v184, v244, v245
    v_mfma_f32_16x16x32_bf16 a[8:11], v[208:211], v[168:171], a[8:11]
    ds_read_b64_tr_b16 v[220:221], v225 offset:96
    ds_read_b64_tr_b16 v[222:223], v225 offset:8544
    v_mfma_f32_16x16x32_bf16 a[12:15], v[208:211], v[172:175], a[12:15]
    s_waitcnt lgkmcnt(4)
    v_exp_f32 v248, v140
    v_mfma_f32_16x16x32_bf16 a[16:19], v[212:215], v[160:163], a[16:19]
    ds_read_b64_tr_b16 v[208:209], v225 offset:128
    ds_read_b64_tr_b16 v[210:211], v225 offset:8576
    v_mfma_f32_16x16x32_bf16 a[20:23], v[212:215], v[164:167], a[20:23]
    v_exp_f32 v249, v141
    v_mfma_f32_16x16x32_bf16 a[24:27], v[212:215], v[168:171], a[24:27]
    v_add_f32 v238, v238, v246
    v_add_f32 v238, v238, v247
    v_mfma_f32_16x16x32_bf16 a[28:31], v[212:215], v[172:175], a[28:31]
    s_waitcnt lgkmcnt(4)
    global_load_dword v255, v243, s[96:97]
    v_cvt_pk_bf16_f32 v185, v246, v247
    v_mfma_f32_16x16x32_bf16 a[32:35], v[216:219], v[160:163], a[32:35]
    ds_read_b64_tr_b16 v[212:213], v225 offset:160
    ds_read_b64_tr_b16 v[214:215], v225 offset:8608
    v_mfma_f32_16x16x32_bf16 a[36:39], v[216:219], v[164:167], a[36:39]
    v_exp_f32 v250, v142
    v_mfma_f32_16x16x32_bf16 a[40:43], v[216:219], v[168:171], a[40:43]
    v_exp_f32 v251, v143
    v_mfma_f32_16x16x32_bf16 a[44:47], v[216:219], v[172:175], a[44:47]
    s_waitcnt lgkmcnt(4)
    global_load_dword v255, v243, s[98:99]
    v_add_f32 v239, v231, v248
    v_mfma_f32_16x16x32_bf16 a[48:51], v[220:223], v[160:163], a[48:51]
    ds_read_b64_tr_b16 v[216:217], v225 offset:192
    ds_read_b64_tr_b16 v[218:219], v225 offset:8640
    v_mfma_f32_16x16x32_bf16 a[52:55], v[220:223], v[164:167], a[52:55]
    v_add_f32 v239, v239, v249
    v_cvt_pk_bf16_f32 v188, v248, v249
    v_mfma_f32_16x16x32_bf16 a[56:59], v[220:223], v[168:171], a[56:59]
    v_add_f32 v239, v239, v250
    v_add_f32 v239, v239, v251
    v_mfma_f32_16x16x32_bf16 a[60:63], v[220:223], v[172:175], a[60:63]
    s_waitcnt lgkmcnt(4)
    global_load_dword v255, v243, s[100:101]
    v_cvt_pk_bf16_f32 v189, v250, v251
    v_mfma_f32_16x16x32_bf16 a[64:67], v[208:211], v[160:163], a[64:67]
    ds_read_b64_tr_b16 v[220:221], v225 offset:224
    ds_read_b64_tr_b16 v[222:223], v225 offset:8672
    v_mfma_f32_16x16x32_bf16 a[68:71], v[208:211], v[164:167], a[68:71]
    v_exp_f32 v244, v144
    v_mfma_f32_16x16x32_bf16 a[72:75], v[208:211], v[168:171], a[72:75]
    v_exp_f32 v245, v145
    v_mfma_f32_16x16x32_bf16 a[76:79], v[208:211], v[172:175], a[76:79]
    s_waitcnt lgkmcnt(4)
    v_exp_f32 v246, v146
    v_mfma_f32_16x16x32_bf16 a[80:83], v[212:215], v[160:163], a[80:83]
    ds_read_b64_tr_b16 v[208:209], v225 offset:256
    ds_read_b64_tr_b16 v[210:211], v225 offset:8704
    v_mfma_f32_16x16x32_bf16 a[84:87], v[212:215], v[164:167], a[84:87]
    v_exp_f32 v247, v147
    v_mfma_f32_16x16x32_bf16 a[88:91], v[212:215], v[168:171], a[88:91]
    v_add_f32 v236, v236, v244
    v_add_f32 v236, v236, v245
    v_mfma_f32_16x16x32_bf16 a[92:95], v[212:215], v[172:175], a[92:95]
    s_waitcnt lgkmcnt(4)
    v_cvt_pk_bf16_f32 v178, v244, v245
    v_mfma_f32_16x16x32_bf16 a[96:99], v[216:219], v[160:163], a[96:99]
    ds_read_b64_tr_b16 v[212:213], v225 offset:288
    ds_read_b64_tr_b16 v[214:215], v225 offset:8736
    v_mfma_f32_16x16x32_bf16 a[100:103], v[216:219], v[164:167], a[100:103]
    v_exp_f32 v248, v148
    v_mfma_f32_16x16x32_bf16 a[104:107], v[216:219], v[168:171], a[104:107]
    v_exp_f32 v249, v149
    v_mfma_f32_16x16x32_bf16 a[108:111], v[216:219], v[172:175], a[108:111]
    s_waitcnt lgkmcnt(4)
    v_add_f32 v236, v236, v246
    v_add_f32 v236, v236, v247
    v_mfma_f32_16x16x32_bf16 a[112:115], v[220:223], v[160:163], a[112:115]
    ds_read_b64_tr_b16 v[216:217], v225 offset:320
    ds_read_b64_tr_b16 v[218:219], v225 offset:8768
    v_mfma_f32_16x16x32_bf16 a[116:119], v[220:223], v[164:167], a[116:119]
    v_cvt_pk_bf16_f32 v179, v246, v247
    v_mfma_f32_16x16x32_bf16 a[120:123], v[220:223], v[168:171], a[120:123]
    v_exp_f32 v250, v150
    v_mfma_f32_16x16x32_bf16 a[124:127], v[220:223], v[172:175], a[124:127]
    s_waitcnt lgkmcnt(4)
    v_exp_f32 v251, v151
    v_mfma_f32_16x16x32_bf16 a[128:131], v[208:211], v[160:163], a[128:131]
    ds_read_b64_tr_b16 v[220:221], v225 offset:352
    ds_read_b64_tr_b16 v[222:223], v225 offset:8800
    v_mfma_f32_16x16x32_bf16 a[132:135], v[208:211], v[164:167], a[132:135]
    v_add_f32 v237, v237, v248
    v_add_f32 v237, v237, v249
    v_mfma_f32_16x16x32_bf16 a[136:139], v[208:211], v[168:171], a[136:139]
    v_cvt_pk_bf16_f32 v182, v248, v249
    v_mfma_f32_16x16x32_bf16 a[140:143], v[208:211], v[172:175], a[140:143]
    s_waitcnt lgkmcnt(4)
    v_exp_f32 v244, v152
    v_mfma_f32_16x16x32_bf16 a[144:147], v[212:215], v[160:163], a[144:147]
    ds_read_b64_tr_b16 v[208:209], v225 offset:384
    ds_read_b64_tr_b16 v[210:211], v225 offset:8832
    v_mfma_f32_16x16x32_bf16 a[148:151], v[212:215], v[164:167], a[148:151]
    v_exp_f32 v245, v153
    v_mfma_f32_16x16x32_bf16 a[152:155], v[212:215], v[168:171], a[152:155]
    v_add_f32 v237, v237, v250
    v_add_f32 v237, v237, v251
    v_mfma_f32_16x16x32_bf16 a[156:159], v[212:215], v[172:175], a[156:159]
    s_waitcnt lgkmcnt(4)
    v_cvt_pk_bf16_f32 v183, v250, v251
    v_mfma_f32_16x16x32_bf16 a[160:163], v[216:219], v[160:163], a[160:163]
    ds_read_b64_tr_b16 v[212:213], v225 offset:416
    ds_read_b64_tr_b16 v[214:215], v225 offset:8864
    v_mfma_f32_16x16x32_bf16 a[164:167], v[216:219], v[164:167], a[164:167]
    v_exp_f32 v246, v154
    v_mfma_f32_16x16x32_bf16 a[168:171], v[216:219], v[168:171], a[168:171]
    v_exp_f32 v247, v155
    v_mfma_f32_16x16x32_bf16 a[172:175], v[216:219], v[172:175], a[172:175]
    s_waitcnt lgkmcnt(4)
    v_add_f32 v238, v238, v244
    v_add_f32 v238, v238, v245
    v_mfma_f32_16x16x32_bf16 a[176:179], v[220:223], v[160:163], a[176:179]
    ds_read_b64_tr_b16 v[216:217], v225 offset:448
    ds_read_b64_tr_b16 v[218:219], v225 offset:8896
    v_mfma_f32_16x16x32_bf16 a[180:183], v[220:223], v[164:167], a[180:183]
    v_cvt_pk_bf16_f32 v186, v244, v245
    v_mfma_f32_16x16x32_bf16 a[184:187], v[220:223], v[168:171], a[184:187]
    v_exp_f32 v248, v156
    v_mfma_f32_16x16x32_bf16 a[188:191], v[220:223], v[172:175], a[188:191]
    s_waitcnt lgkmcnt(4)
    v_exp_f32 v249, v157
    v_mfma_f32_16x16x32_bf16 a[192:195], v[208:211], v[160:163], a[192:195]
    ds_read_b64_tr_b16 v[220:221], v225 offset:480
    ds_read_b64_tr_b16 v[222:223], v225 offset:8928
    v_mfma_f32_16x16x32_bf16 a[196:199], v[208:211], v[164:167], a[196:199]
    v_add_f32 v238, v238, v246
    v_add_f32 v238, v238, v247
    v_mfma_f32_16x16x32_bf16 a[200:203], v[208:211], v[168:171], a[200:203]
    v_cvt_pk_bf16_f32 v187, v246, v247
    v_mfma_f32_16x16x32_bf16 a[204:207], v[208:211], v[172:175], a[204:207]
    s_waitcnt lgkmcnt(4)
    v_exp_f32 v250, v158
    v_mfma_f32_16x16x32_bf16 a[208:211], v[212:215], v[160:163], a[208:211]
    v_exp_f32 v251, v159
    v_mfma_f32_16x16x32_bf16 a[212:215], v[212:215], v[164:167], a[212:215]
    v_add_f32 v239, v239, v248
    v_add_f32 v239, v239, v249
    v_mfma_f32_16x16x32_bf16 a[216:219], v[212:215], v[168:171], a[216:219]
    v_mfma_f32_16x16x32_bf16 a[220:223], v[212:215], v[172:175], a[220:223]
    s_waitcnt lgkmcnt(2)
    v_cvt_pk_bf16_f32 v190, v248, v249
    v_add_f32 v239, v239, v250
    v_mfma_f32_16x16x32_bf16 a[224:227], v[216:219], v[160:163], a[224:227]
    v_add_f32 v239, v239, v251
    v_cvt_pk_bf16_f32 v191, v250, v251
    v_mfma_f32_16x16x32_bf16 a[228:231], v[216:219], v[164:167], a[228:231]
    v_max3_f32 v244, v236, v237, v238
    v_max_f32 v244, v244, v239
    v_mfma_f32_16x16x32_bf16 a[232:235], v[216:219], v[168:171], a[232:235]
    v_cmp_lt_f32 vcc, s29, v244
    v_mfma_f32_16x16x32_bf16 a[236:239], v[216:219], v[172:175], a[236:239]
    s_waitcnt lgkmcnt(0)
    v_mfma_f32_16x16x32_bf16 a[240:243], v[220:223], v[160:163], a[240:243]
    v_mfma_f32_16x16x32_bf16 a[244:247], v[220:223], v[164:167], a[244:247]
    v_mfma_f32_16x16x32_bf16 a[248:251], v[220:223], v[168:171], a[248:251]
    v_mfma_f32_16x16x32_bf16 a[252:255], v[220:223], v[172:175], a[252:255]
    s_cbranch_vccnz L_rare_d
L_back_d:
    s_waitcnt vmcnt(3) lgkmcnt(0)
    s_barrier
    ds_read_b64_tr_b16 v[208:209], v225 offset:33792
    ds_read_b64_tr_b16 v[210:211], v225 offset:42240
    ds_read_b64_tr_b16 v[212:213], v225 offset:33824
    ds_read_b64_tr_b16 v[214:215], v225 offset:42272
    s_waitcnt lgkmcnt(2)
    v_mfma_f32_16x16x32_bf16 a[0:3], v[208:211], v[176:179], a[0:3]
    ds_read_b64_tr_b16 v[216:217], v225 offset:33856
    ds_read_b64_tr_b16 v[218:219], v225 offset:42304
    v_mfma_f32_16x16x32_bf16 a[4:7], v[208:211], v[180:183], a[4:7]
    v_mfma_f32_16x16x32_bf16 a[8:11], v[208:211], v[184:187], a[8:11]
    ds_read_b64_tr_b16 v[220:221], v225 offset:33888
    ds_read_b64_tr_b16 v[222:223], v225 offset:42336
    v_mfma_f32_16x16x32_bf16 a[12:15], v[208:211], v[188:191], a[12:15]
    s_waitcnt lgkmcnt(4)
    v_mfma_f32_16x16x32_bf16 a[16:19], v[212:215], v[176:179], a[16:19]
    ds_read_b64_tr_b16 v[208:209], v225 offset:33920
    ds_read_b64_tr_b16 v[210:211], v225 offset:42368
    v_mfma_f32_16x16x32_bf16 a[20:23], v[212:215], v[180:183], a[20:23]
    v_mov_b32 v240, v192
    v_mov_b32 v241, v196
    v_mfma_f32_16x16x32_bf16 a[24:27], v[212:215], v[184:187], a[24:27]
    v_mov_b32 v242, v200
    v_mov_b32 v243, v204
    v_mfma_f32_16x16x32_bf16 a[28:31], v[212:215], v[188:191], a[28:31]
    s_waitcnt lgkmcnt(4)
    v_mov_b32 v244, v236
    v_mov_b32 v245, v237
    v_mfma_f32_16x16x32_bf16 a[32:35], v[216:219], v[176:179], a[32:35]
    ds_read_b64_tr_b16 v[212:213], v225 offset:33952
    ds_read_b64_tr_b16 v[214:215], v225 offset:42400
    v_mfma_f32_16x16x32_bf16 a[36:39], v[216:219], v[180:183], a[36:39]
    v_mov_b32 v246, v238
    v_mov_b32 v247, v239
    v_mfma_f32_16x16x32_bf16 a[40:43], v[216:219], v[184:187], a[40:43]
    v_mov_b32 v248, v244
    v_mov_b32 v249, v245
    v_mfma_f32_16x16x32_bf16 a[44:47], v[216:219], v[188:191], a[44:47]
    s_waitcnt lgkmcnt(4)
    v_mov_b32 v250, v246
    v_mov_b32 v251, v247
    v_mfma_f32_16x16x32_bf16 a[48:51], v[220:223], v[176:179], a[48:51]
    ds_read_b64_tr_b16 v[216:217], v225 offset:33984
    ds_read_b64_tr_b16 v[218:219], v225 offset:42432
    v_mfma_f32_16x16x32_bf16 a[52:55], v[220:223], v[180:183], a[52:55]
    v_permlane16_swap_b32 v244, v248
    v_permlane16_swap_b32 v245, v249
    v_mfma_f32_16x16x32_bf16 a[56:59], v[220:223], v[184:187], a[56:59]
    v_permlane16_swap_b32 v246, v250
    v_permlane16_swap_b32 v247, v251
    v_mfma_f32_16x16x32_bf16 a[60:63], v[220:223], v[188:191], a[60:63]
    s_waitcnt lgkmcnt(4)
    v_add_f32 v244, v244, v248
    v_add_f32 v245, v245, v249
    v_mfma_f32_16x16x32_bf16 a[64:67], v[208:211], v[176:179], a[64:67]
    ds_read_b64_tr_b16 v[220:221], v225 offset:34016
    ds_read_b64_tr_b16 v[222:223], v225 offset:42464
    v_mfma_f32_16x16x32_bf16 a[68:71], v[208:211], v[180:183], a[68:71]
    v_add_f32 v246, v246, v250
    v_add_f32 v247, v247, v251
    v_mfma_f32_16x16x32_bf16 a[72:75], v[208:211], v[184:187], a[72:75]
    v_mov_b32 v248, v244
    v_mov_b32 v249, v245
    v_mfma_f32_16x16x32_bf16 a[76:79], v[208:211], v[188:191], a[76:79]
    s_waitcnt lgkmcnt(4)
    v_mov_b32 v250, v246
    v_mov_b32 v251, v247
    v_mfma_f32_16x16x32_bf16 a[80:83], v[212:215], v[176:179], a[80:83]
    ds_read_b64_tr_b16 v[208:209], v225 offset:34048
    ds_read_b64_tr_b16 v[210:211], v225 offset:42496
    v_mfma_f32_16x16x32_bf16 a[84:87], v[212:215], v[180:183], a[84:87]
    v_permlane32_swap_b32 v244, v248
    v_permlane32_swap_b32 v245, v249
    v_mfma_f32_16x16x32_bf16 a[88:91], v[212:215], v[184:187], a[88:91]
    v_permlane32_swap_b32 v246, v250
    v_permlane32_swap_b32 v247, v251
    v_mfma_f32_16x16x32_bf16 a[92:95], v[212:215], v[188:191], a[92:95]
    s_waitcnt lgkmcnt(4)
    v_add_f32 v244, v244, v248
    v_add_f32 v245, v245, v249
    v_mfma_f32_16x16x32_bf16 a[96:99], v[216:219], v[176:179], a[96:99]
    ds_read_b64_tr_b16 v[212:213], v225 offset:34080
    ds_read_b64_tr_b16 v[214:215], v225 offset:42528
    v_mfma_f32_16x16x32_bf16 a[100:103], v[216:219], v[180:183], a[100:103]
    v_add_f32 v246, v246, v250
    v_add_f32 v247, v247, v251
    v_mfma_f32_16x16x32_bf16 a[104:107], v[216:219], v[184:187], a[104:107]
    v_and_b32 v203, 15, v252
    v_lshlrev_b32 v203, 5, v203
    v_mfma_f32_16x16x32_bf16 a[108:111], v[216:219], v[188:191], a[108:111]
    s_waitcnt lgkmcnt(4)
    s_lshl_b32 s63, s34, 9
    s_add_u32 s63, s63, 131072
    v_add_u32 v202, s63, v203
    v_lshlrev_b32 v200, 4, v252
    v_mfma_f32_16x16x32_bf16 a[112:115], v[220:223], v[176:179], a[112:115]
    s_xor_b32 s64, s34, 2
    s_lshl_b32 s65, s64, 9
    s_add_u32 s65, s65, 131072
    ds_read_b64_tr_b16 v[216:217], v225 offset:34112
    ds_read_b64_tr_b16 v[218:219], v225 offset:42560
    v_mfma_f32_16x16x32_bf16 a[116:119], v[220:223], v[180:183], a[116:119]
    s_lshl_b32 s64, s64, 15
    v_add_u32 v203, s65, v203
    v_add_u32 v201, s64, v200
    v_mfma_f32_16x16x32_bf16 a[120:123], v[220:223], v[184:187], a[120:123]
    s_lshl_b32 s66, s34, 15
    v_add_u32 v200, s66, v200
    v_mfma_f32_16x16x32_bf16 a[124:127], v[220:223], v[188:191], a[124:127]
    s_waitcnt lgkmcnt(4)
    v_mfma_f32_16x16x32_bf16 a[128:131], v[208:211], v[176:179], a[128:131]
    ds_read_b64_tr_b16 v[220:221], v225 offset:34144
    ds_read_b64_tr_b16 v[222:223], v225 offset:42592
    v_mfma_f32_16x16x32_bf16 a[132:135], v[208:211], v[180:183], a[132:135]
    v_mfma_f32_16x16x32_bf16 a[136:139], v[208:211], v[184:187], a[136:139]
    v_mfma_f32_16x16x32_bf16 a[140:143], v[208:211], v[188:191], a[140:143]
    s_waitcnt lgkmcnt(4)
    v_mfma_f32_16x16x32_bf16 a[144:147], v[212:215], v[176:179], a[144:147]
    ds_read_b64_tr_b16 v[208:209], v225 offset:34176
    ds_read_b64_tr_b16 v[210:211], v225 offset:42624
    v_mfma_f32_16x16x32_bf16 a[148:151], v[212:215], v[180:183], a[148:151]
    v_mfma_f32_16x16x32_bf16 a[152:155], v[212:215], v[184:187], a[152:155]
    v_mfma_f32_16x16x32_bf16 a[156:159], v[212:215], v[188:191], a[156:159]
    s_waitcnt lgkmcnt(4)
    v_mfma_f32_16x16x32_bf16 a[160:163], v[216:219], v[176:179], a[160:163]
    ds_read_b64_tr_b16 v[212:213], v225 offset:34208
    ds_read_b64_tr_b16 v[214:215], v225 offset:42656
    v_mfma_f32_16x16x32_bf16 a[164:167], v[216:219], v[180:183], a[164:167]
    v_mfma_f32_16x16x32_bf16 a[168:171], v[216:219], v[184:187], a[168:171]
    v_mfma_f32_16x16x32_bf16 a[172:175], v[216:219], v[188:191], a[172:175]
    s_waitcnt lgkmcnt(4)
    v_mfma_f32_16x16x32_bf16 a[176:179], v[220:223], v[176:179], a[176:179]
    ds_read_b64_tr_b16 v[216:217], v225 offset:34240
    ds_read_b64_tr_b16 v[218:219], v225 offset:42688
    v_mfma_f32_16x16x32_bf16 a[180:183], v[220:223], v[180:183], a[180:183]
    v_mfma_f32_16x16x32_bf16 a[184:187], v[220:223], v[184:187], a[184:187]
    v_mfma_f32_16x16x32_bf16 a[188:191], v[220:223], v[188:191], a[188:191]
    s_waitcnt lgkmcnt(4)
    v_mfma_f32_16x16x32_bf16 a[192:195], v[208:211], v[176:179], a[192:195]
    ds_read_b64_tr_b16 v[220:221], v225 offset:34272
    ds_read_b64_tr_b16 v[222:223], v225 offset:42720
    v_mfma_f32_16x16x32_bf16 a[196:199], v[208:211], v[180:183], a[196:199]
    v_mfma_f32_16x16x32_bf16 a[200:203], v[208:211], v[184:187], a[200:203]
    v_mfma_f32_16x16x32_bf16 a[204:207], v[208:211], v[188:191], a[204:207]
    s_waitcnt lgkmcnt(4)
    v_mfma_f32_16x16x32_bf16 a[208:211], v[212:215], v[176:179], a[208:211]
    v_mfma_f32_16x16x32_bf16 a[212:215], v[212:215], v[180:183], a[212:215]
    v_mfma_f32_16x16x32_bf16 a[216:219], v[212:215], v[184:187], a[216:219]
    v_mfma_f32_16x16x32_bf16 a[220:223], v[212:215], v[188:191], a[220:223]
    s_waitcnt lgkmcnt(2)
    v_mfma_f32_16x16x32_bf16 a[224:227], v[216:219], v[176:179], a[224:227]
    v_mfma_f32_16x16x32_bf16 a[228:231], v[216:219], v[180:183], a[228:231]
    v_mfma_f32_16x16x32_bf16 a[232:235], v[216:219], v[184:187], a[232:235]
    v_mfma_f32_16x16x32_bf16 a[236:239], v[216:219], v[188:191], a[236:239]
    s_waitcnt lgkmcnt(0)
    v_mfma_f32_16x16x32_bf16 a[240:243], v[220:223], v[176:179], a[240:243]
    v_mfma_f32_16x16x32_bf16 a[244:247], v[220:223], v[180:183], a[244:247]
    v_mfma_f32_16x16x32_bf16 a[248:251], v[220:223], v[184:187], a[248:251]
    v_mfma_f32_16x16x32_bf16 a[252:255], v[220:223], v[188:191], a[252:255]
    s_nop 7
    s_barrier
    ds_write_b128 v202, v[240:243]
    ds_write_b128 v202, v[244:247] offset:16
    s_cmp_eq_u32 s38, 0
    s_cbranch_scc0 L_comb1
    ds_write_b128 v200, a[8:11] offset:0
    v_accvgpr_read_b32 v0, a0
    v_accvgpr_read_b32 v1, a1
    v_accvgpr_read_b32 v2, a2
    v_accvgpr_read_b32 v3, a3
    s_mul_i32 s60, s34, 224
    s_mov_b32 s61, 0x124925
    v_add_u32 v192, 0, v252
    v_mul_u32_u24 v193, s61, v192
    ds_write_b128 v200, a[12:15] offset:1024
    v_accvgpr_read_b32 v4, a4
    v_accvgpr_read_b32 v5, a5
    v_accvgpr_read_b32 v6, a6
    v_accvgpr_read_b32 v7, a7
    v_lshrrev_b32 v193, 24, v193
    v_mul_u32_u24 v194, 14, v193
    v_sub_u32 v194, v192, v194
    v_mul_u32_u24 v193, 896, v193
    ds_write_b128 v200, a[24:27] offset:2048
    v_accvgpr_read_b32 v8, a16
    v_accvgpr_read_b32 v9, a17
    v_accvgpr_read_b32 v10, a18
    v_accvgpr_read_b32 v11, a19
    v_lshl_add_u32 v193, v194, 4, v193
    v_add_u32 v232, s60, v193
    v_add_u32 v192, 64, v252
    v_mul_u32_u24 v193, s61, v192
    ds_write_b128 v200, a[28:31] offset:3072
    v_accvgpr_read_b32 v12, a20
    v_accvgpr_read_b32 v13, a21
    v_accvgpr_read_b32 v14, a22
    v_accvgpr_read_b32 v15, a23
    v_lshrrev_b32 v193, 24, v193
    v_mul_u32_u24 v194, 14, v193
    v_sub_u32 v194, v192, v194
    v_mul_u32_u24 v193, 896, v193
    ds_write_b128 v200, a[40:43] offset:4096
    v_accvgpr_read_b32 v16, a32
    v_accvgpr_read_b32 v17, a33
    v_accvgpr_read_b32 v18, a34
    v_accvgpr_read_b32 v19, a35
    v_lshl_add_u32 v193, v194, 4, v193
    v_add_u32 v233, s60, v193
    v_add_u32 v192, 128, v252
    v_mul_u32_u24 v193, s61, v192
    ds_write_b128 v200, a[44:47] offset:5120
    v_accvgpr_read_b32 v20, a36
    v_accvgpr_read_b32 v21, a37
    v_accvgpr_read_b32 v22, a38
    v_accvgpr_read_b32 v23, a39
    v_lshrrev_b32 v193, 24, v193
    v_mul_u32_u24 v194, 14, v193
    v_sub_u32 v194, v192, v194
    v_mul_u32_u24 v193, 896, v193
    ds_write_b128 v200, a[56:59] offset:6144
    v_accvgpr_read_b32 v24, a48
    v_accvgpr_read_b32 v25, a49
    v_accvgpr_read_b32 v26, a50
    v_accvgpr_read_b32 v27, a51
    v_lshl_add_u32 v193, v194, 4, v193
    v_add_u32 v234, s60, v193
    v_add_u32 v192, 192, v252
    v_mul_u32_u24 v193, s61, v192
    ds_write_b128 v200, a[60:63] offset:7168
    v_accvgpr_read_b32 v28, a52
    v_accvgpr_read_b32 v29, a53
    v_accvgpr_read_b32 v30, a54
    v_accvgpr_read_b32 v31, a55
    v_lshrrev_b32 v193, 24, v193
    v_mul_u32_u24 v194, 14, v193
    v_sub_u32 v194, v192, v194
    v_mul_u32_u24 v193, 896, v193
    ds_write_b128 v200, a[72:75] offset:8192
    v_accvgpr_read_b32 v32, a64
    v_accvgpr_read_b32 v33, a65
    v_accvgpr_read_b32 v34, a66
    v_accvgpr_read_b32 v35, a67
    v_lshl_add_u32 v193, v194, 4, v193
    v_add_u32 v235, s60, v193
    v_add_u32 v192, 256, v252
    v_mul_u32_u24 v193, s61, v192
    ds_write_b128 v200, a[76:79] offset:9216
    v_accvgpr_read_b32 v36, a68
    v_accvgpr_read_b32 v37, a69
    v_accvgpr_read_b32 v38, a70
    v_accvgpr_read_b32 v39, a71
    v_lshrrev_b32 v193, 24, v193
    v_mul_u32_u24 v194, 14, v193
    v_sub_u32 v194, v192, v194
    v_mul_u32_u24 v193, 896, v193
    ds_write_b128 v200, a[88:91] offset:10240
    v_accvgpr_read_b32 v40, a80
    v_accvgpr_read_b32 v41, a81
    v_accvgpr_read_b32 v42, a82
    v_accvgpr_read_b32 v43, a83
    v_lshl_add_u32 v193, v194, 4, v193
    v_add_u32 v236, s60, v193
    v_add_u32 v192, 320, v252
    v_mul_u32_u24 v193, s61, v192
    ds_write_b128 v200, a[92:95] offset:11264
    v_accvgpr_read_b32 v44, a84
    v_accvgpr_read_b32 v45, a85
    v_accvgpr_read_b32 v46, a86
    v_accvgpr_read_b32 v47, a87
    v_lshrrev_b32 v193, 24, v193
    v_mul_u32_u24 v194, 14, v193
    v_sub_u32 v194, v192, v194
    v_mul_u32_u24 v193, 896, v193
    ds_write_b128 v200, a[104:107] offset:12288
    v_accvgpr_read_b32 v48, a96
    v_accvgpr_read_b32 v49, a97
    v_accvgpr_read_b32 v50, a98
    v_accvgpr_read_b32 v51, a99
    v_lshl_add_u32 v193, v194, 4, v193
    v_add_u32 v237, s60, v193
    v_add_u32 v192, 384, v252
    v_mul_u32_u24 v193, s61, v192
    ds_write_b128 v200, a[108:111] offset:13312
    v_accvgpr_read_b32 v52, a100
    v_accvgpr_read_b32 v53, a101
    v_accvgpr_read_b32 v54, a102
    v_accvgpr_read_b32 v55, a103
    v_lshrrev_b32 v193, 24, v193
    v_mul_u32_u24 v194, 14, v193
    v_sub_u32 v194, v192, v194
    v_mul_u32_u24 v193, 896, v193
    ds_write_b128 v200, a[120:123] offset:14336
    v_accvgpr_read_b32 v56, a112
    v_accvgpr_read_b32 v57, a113
    v_accvgpr_read_b32 v58, a114
    v_accvgpr_read_b32 v59, a115
    v_lshl_add_u32 v193, v194, 4, v193
    v_add_u32 v238, s60, v193
    s_mul_i32 s60, s34, 7168
    s_add_u32 s60, s60, 135168
    ds_write_b128 v200, a[124:127] offset:15360
    v_accvgpr_read_b32 v60, a116
    v_accvgpr_read_b32 v61, a117
    v_accvgpr_read_b32 v62, a118
    v_accvgpr_read_b32 v63, a119
    s_mul_i32 s61, s34, 32768
    s_add_u32 s61, s61, 16384
    s_add_u32 s62, s61, 7168
    s_mov_b32 s65, 0
    ds_write_b128 v200, a[136:139] offset:16384
    v_accvgpr_read_b32 v64, a128
    v_accvgpr_read_b32 v65, a129
    v_accvgpr_read_b32 v66, a130
    v_accvgpr_read_b32 v67, a131
    s_add_u32 m0, s60, 0
    s_nop 0
    buffer_load_dwordx4 v232, s[48:51], s65 offen lds
    s_add_u32 m0, s60, 1024
    ds_write_b128 v200, a[140:143] offset:17408
    v_accvgpr_read_b32 v68, a132
    v_accvgpr_read_b32 v69, a133
    v_accvgpr_read_b32 v70, a134
    v_accvgpr_read_b32 v71, a135
    s_nop 0
    buffer_load_dwordx4 v233, s[48:51], s65 offen lds
    s_add_u32 m0, s60, 2048
    s_nop 0
    ds_write_b128 v200, a[152:155] offset:18432
    v_accvgpr_read_b32 v72, a144
    v_accvgpr_read_b32 v73, a145
    v_accvgpr_read_b32 v74, a146
    v_accvgpr_read_b32 v75, a147
    buffer_load_dwordx4 v234, s[48:51], s65 offen lds
    s_add_u32 m0, s60, 3072
    s_nop 0
    buffer_load_dwordx4 v235, s[48:51], s65 offen lds
    ds_write_b128 v200, a[156:159] offset:19456
    v_accvgpr_read_b32 v76, a148
    v_accvgpr_read_b32 v77, a149
    v_accvgpr_read_b32 v78, a150
    v_accvgpr_read_b32 v79, a151
    s_add_u32 m0, s60, 4096
    s_nop 0
    buffer_load_dwordx4 v236, s[48:51], s65 offen lds
    s_add_u32 m0, s60, 5120
    ds_write_b128 v200, a[168:171] offset:20480
    v_accvgpr_read_b32 v80, a160
    v_accvgpr_read_b32 v81, a161
    v_accvgpr_read_b32 v82, a162
    v_accvgpr_read_b32 v83, a163
    s_nop 0
    buffer_load_dwordx4 v237, s[48:51], s65 offen lds
    s_add_u32 m0, s60, 6144
    s_nop 0
    ds_write_b128 v200, a[172:175] offset:21504
    v_accvgpr_read_b32 v84, a164
    v_accvgpr_read_b32 v85, a165
    v_accvgpr_read_b32 v86, a166
    v_accvgpr_read_b32 v87, a167
    buffer_load_dwordx4 v238, s[48:51], s65 offen lds
    s_mov_b32 s65, 28672
    v_lshrrev_b32 v192, 2, v252
    v_mul_u32_u24 v192, 224, v192
    ds_write_b128 v200, a[184:187] offset:22528
    v_accvgpr_read_b32 v88, a176
    v_accvgpr_read_b32 v89, a177
    v_accvgpr_read_b32 v90, a178
    v_accvgpr_read_b32 v91, a179
    v_and_b32 v193, 3, v252
    v_lshl_add_u32 v192, v193, 3, v192
    v_add_u32 v224, s60, v192
    v_add_u32 v225, s61, v192
    ds_write_b128 v200, a[188:191] offset:23552
    v_accvgpr_read_b32 v92, a180
    v_accvgpr_read_b32 v93, a181
    v_accvgpr_read_b32 v94, a182
    v_accvgpr_read_b32 v95, a183
    v_add_u32 v226, s62, v192
    v_lshlrev_b32 v192, 4, v252
    v_add_u32 v228, 0, v192
    v_add_u32 v229, 32768, v192
    ds_write_b128 v200, a[200:203] offset:24576
    v_accvgpr_read_b32 v96, a192
    v_accvgpr_read_b32 v97, a193
    v_accvgpr_read_b32 v98, a194
    v_accvgpr_read_b32 v99, a195
    v_add_u32 v230, 65536, v192
    v_add_u32 v231, 98304, v192
    ds_write_b128 v200, a[204:207] offset:25600
    v_accvgpr_read_b32 v100, a196
    v_accvgpr_read_b32 v101, a197
    v_accvgpr_read_b32 v102, a198
    v_accvgpr_read_b32 v103, a199
    ds_write_b128 v200, a[216:219] offset:26624
    v_accvgpr_read_b32 v104, a208
    v_accvgpr_read_b32 v105, a209
    v_accvgpr_read_b32 v106, a210
    v_accvgpr_read_b32 v107, a211
    ds_write_b128 v200, a[220:223] offset:27648
    v_accvgpr_read_b32 v108, a212
    v_accvgpr_read_b32 v109, a213
    v_accvgpr_read_b32 v110, a214
    v_accvgpr_read_b32 v111, a215
    ds_write_b128 v200, a[232:235] offset:28672
    v_accvgpr_read_b32 v112, a224
    v_accvgpr_read_b32 v113, a225
    v_accvgpr_read_b32 v114, a226
    v_accvgpr_read_b32 v115, a227
    ds_write_b128 v200, a[236:239] offset:29696
    v_accvgpr_read_b32 v116, a228
    v_accvgpr_read_b32 v117, a229
    v_accvgpr_read_b32 v118, a230
    v_accvgpr_read_b32 v119, a231
    ds_write_b128 v200, a[248:251] offset:30720
    v_accvgpr_read_b32 v120, a240
    v_accvgpr_read_b32 v121, a241
    v_accvgpr_read_b32 v122, a242
    v_accvgpr_read_b32 v123, a243
    ds_write_b128 v200, a[252:255] offset:31744
    v_accvgpr_read_b32 v124, a244
    v_accvgpr_read_b32 v125, a245
    v_accvgpr_read_b32 v126, a246
    v_accvgpr_read_b32 v127, a247
    s_waitcnt lgkmcnt(0)
    s_barrier
    ds_read_b128 v[204:207], v203
    ds_read_b128 v[208:211], v203 offset:16
    ds_read_b128 v[128:131], v201 offset:0
    ds_read_b128 v[132:135], v201 offset:2048
    ds_read_b128 v[136:139], v201 offset:1024
    ds_read_b128 v[140:143], v201 offset:3072
    ds_read_b128 v[144:147], v201 offset:4096
    ds_read_b128 v[148:151], v201 offset:6144
    ds_read_b128 v[152:155], v201 offset:5120
    ds_read_b128 v[156:159], v201 offset:7168
    s_waitcnt lgkmcnt(9)
    v_min_f32 v220, v240, v204
    v_sub_f32 v221, v220, v240
    v_sub_f32 v222, v220, v204
    v_exp_f32 v221, v221
    v_exp_f32 v222, v222
    s_nop 0
    v_mul_f32 v223, v221, v244
    s_waitcnt lgkmcnt(8)
    v_fmac_f32 v223, v222, v208
    v_rcp_f32 v223, v223
    s_nop 0
    v_mul_f32 v212, v221, v223
    v_mul_f32 v216, v222, v223
    v_mov_b32 v213, v212
    v_mov_b32 v217, v216
    v_min_f32 v220, v241, v205
    v_sub_f32 v221, v220, v241
    v_sub_f32 v222, v220, v205
    v_exp_f32 v221, v221
    v_exp_f32 v222, v222
    s_nop 0
    v_mul_f32 v223, v221, v245
    v_fmac_f32 v223, v222, v209
    v_rcp_f32 v223, v223
    s_nop 0
    v_mul_f32 v214, v221, v223
    v_mul_f32 v218, v222, v223
    v_mov_b32 v215, v214
    v_mov_b32 v219, v218
    s_waitcnt lgkmcnt(7)
    v_pk_mul_f32 v[128:129], v[128:129], v[216:217]
    v_pk_mul_f32 v[130:131], v[130:131], v[216:217]
    v_pk_fma_f32 v[0:1], v[0:1], v[212:213], v[128:129]
    v_pk_fma_f32 v[2:3], v[2:3], v[212:213], v[130:131]
    ds_read_b128 v[128:131], v201 offset:8192
    v_cvt_pk_bf16_f32 v160, v0, v1
    v_cvt_pk_bf16_f32 v161, v2, v3
    s_waitcnt lgkmcnt(7)
    v_pk_mul_f32 v[132:133], v[132:133], v[216:217]
    v_pk_mul_f32 v[134:135], v[134:135], v[216:217]
    v_pk_fma_f32 v[8:9], v[8:9], v[212:213], v[132:133]
    v_pk_fma_f32 v[10:11], v[10:11], v[212:213], v[134:135]
    ds_read_b128 v[132:135], v201 offset:10240
    v_cvt_pk_bf16_f32 v162, v8, v9
    v_cvt_pk_bf16_f32 v163, v10, v11
    ds_write_b128 v201, v[160:163] offset:0
    s_waitcnt lgkmcnt(8)
    v_pk_mul_f32 v[136:137], v[136:137], v[218:219]
    v_pk_mul_f32 v[138:139], v[138:139], v[218:219]
    v_pk_fma_f32 v[4:5], v[4:5], v[214:215], v[136:137]
    v_pk_fma_f32 v[6:7], v[6:7], v[214:215], v[138:139]
    ds_read_b128 v[136:139], v201 offset:9216
    v_cvt_pk_bf16_f32 v164, v4, v5
    v_cvt_pk_bf16_f32 v165, v6, v7
    s_waitcnt lgkmcnt(8)
    v_pk_mul_f32 v[140:141], v[140:141], v[218:219]
    v_pk_mul_f32 v[142:143], v[142:143], v[218:219]
    v_pk_fma_f32 v[12:13], v[12:13], v[214:215], v[140:141]
    v_pk_fma_f32 v[14:15], v[14:15], v[214:215], v[142:143]
    ds_read_b128 v[140:143], v201 offset:11264
    v_cvt_pk_bf16_f32 v166, v12, v13
    v_cvt_pk_bf16_f32 v167, v14, v15
    ds_write_b128 v201, v[164:167] offset:1024
    s_waitcnt lgkmcnt(9)
    v_pk_mul_f32 v[144:145], v[144:145], v[216:217]
    v_pk_mul_f32 v[146:147], v[146:147], v[216:217]
    v_pk_fma_f32 v[16:17], v[16:17], v[212:213], v[144:145]
    v_pk_fma_f32 v[18:19], v[18:19], v[212:213], v[146:147]
    ds_read_b128 v[144:147], v201 offset:12288
    v_cvt_pk_bf16_f32 v168, v16, v17
    v_cvt_pk_bf16_f32 v169, v18, v19
    s_waitcnt lgkmcnt(9)
    v_pk_mul_f32 v[148:149], v[148:149], v[216:217]
    v_pk_mul_f32 v[150:151], v[150:151], v[216:217]
    v_pk_fma_f32 v[24:25], v[24:25], v[212:213], v[148:149]
    v_pk_fma_f32 v[26:27], v[26:27], v[212:213], v[150:151]
    ds_read_b128 v[148:151], v201 offset:14336
    v_cvt_pk_bf16_f32 v170, v24, v25
    v_cvt_pk_bf16_f32 v171, v26, v27
    ds_write_b128 v201, v[168:171] offset:2048
    s_waitcnt lgkmcnt(10)
    v_pk_mul_f32 v[152:153], v[152:153], v[218:219]
    v_pk_mul_f32 v[154:155], v[154:155], v[218:219]
    v_pk_fma_f32 v[20:21], v[20:21], v[214:215], v[152:153]
    v_pk_fma_f32 v[22:23], v[22:23], v[214:215], v[154:155]
    ds_read_b128 v[152:155], v201 offset:13312
    v_cvt_pk_bf16_f32 v172, v20, v21
    v_cvt_pk_bf16_f32 v173, v22, v23
    s_waitcnt lgkmcnt(10)
    v_pk_mul_f32 v[156:157], v[156:157], v[218:219]
    v_pk_mul_f32 v[158:159], v[158:159], v[218:219]
    v_pk_fma_f32 v[28:29], v[28:29], v[214:215], v[156:157]
    v_pk_fma_f32 v[30:31], v[30:31], v[214:215], v[158:159]
    ds_read_b128 v[156:159], v201 offset:15360
    v_cvt_pk_bf16_f32 v174, v28, v29
    v_cvt_pk_bf16_f32 v175, v30, v31
    ds_write_b128 v201, v[172:175] offset:3072
    s_waitcnt lgkmcnt(11)
    v_pk_mul_f32 v[128:129], v[128:129], v[216:217]
    v_pk_mul_f32 v[130:131], v[130:131], v[216:217]
    v_pk_fma_f32 v[32:33], v[32:33], v[212:213], v[128:129]
    v_pk_fma_f32 v[34:35], v[34:35], v[212:213], v[130:131]
    ds_read_b128 v[128:131], v201 offset:16384
    v_cvt_pk_bf16_f32 v176, v32, v33
    v_cvt_pk_bf16_f32 v177, v34, v35
    s_waitcnt lgkmcnt(11)
    v_pk_mul_f32 v[132:133], v[132:133], v[216:217]
    v_pk_mul_f32 v[134:135], v[134:135], v[216:217]
    v_pk_fma_f32 v[40:41], v[40:41], v[212:213], v[132:133]
    v_pk_fma_f32 v[42:43], v[42:43], v[212:213], v[134:135]
    ds_read_b128 v[132:135], v201 offset:18432
    v_cvt_pk_bf16_f32 v178, v40, v41
    v_cvt_pk_bf16_f32 v179, v42, v43
    ds_write_b128 v201, v[176:179] offset:4096
    s_waitcnt lgkmcnt(11)
    v_pk_mul_f32 v[136:137], v[136:137], v[218:219]
    v_pk_mul_f32 v[138:139], v[138:139], v[218:219]
    v_pk_fma_f32 v[36:37], v[36:37], v[214:215], v[136:137]
    v_pk_fma_f32 v[38:39], v[38:39], v[214:215], v[138:139]
    ds_read_b128 v[136:139], v201 offset:17408
    v_cvt_pk_bf16_f32 v180, v36, v37
    v_cvt_pk_bf16_f32 v181, v38, v39
    s_waitcnt lgkmcnt(11)
    v_pk_mul_f32 v[140:141], v[140:141], v[218:219]
    v_pk_mul_f32 v[142:143], v[142:143], v[218:219]
    v_pk_fma_f32 v[44:45], v[44:45], v[214:215], v[140:141]
    v_pk_fma_f32 v[46:47], v[46:47], v[214:215], v[142:143]
    ds_read_b128 v[140:143], v201 offset:19456
    v_cvt_pk_bf16_f32 v182, v44, v45
    v_cvt_pk_bf16_f32 v183, v46, v47
    ds_write_b128 v201, v[180:183] offset:5120
    s_waitcnt lgkmcnt(11)
    v_pk_mul_f32 v[144:145], v[144:145], v[216:217]
    v_pk_mul_f32 v[146:147], v[146:147], v[216:217]
    v_pk_fma_f32 v[48:49], v[48:49], v[212:213], v[144:145]
    v_pk_fma_f32 v[50:51], v[50:51], v[212:213], v[146:147]
    ds_read_b128 v[144:147], v201 offset:20480
    v_cvt_pk_bf16_f32 v184, v48, v49
    v_cvt_pk_bf16_f32 v185, v50, v51
    s_waitcnt lgkmcnt(11)
    v_pk_mul_f32 v[148:149], v[148:149], v[216:217]
    v_pk_mul_f32 v[150:151], v[150:151], v[216:217]
    v_pk_fma_f32 v[56:57], v[56:57], v[212:213], v[148:149]
    v_pk_fma_f32 v[58:59], v[58:59], v[212:213], v[150:151]
    ds_read_b128 v[148:151], v201 offset:22528
    v_cvt_pk_bf16_f32 v186, v56, v57
    v_cvt_pk_bf16_f32 v187, v58, v59
    ds_write_b128 v201, v[184:187] offset:6144
    s_waitcnt lgkmcnt(11)
    v_pk_mul_f32 v[152:153], v[152:153], v[218:219]
    v_pk_mul_f32 v[154:155], v[154:155], v[218:219]
    v_pk_fma_f32 v[52:53], v[52:53], v[214:215], v[152:153]
    v_pk_fma_f32 v[54:55], v[54:55], v[214:215], v[154:155]
    ds_read_b128 v[152:155], v201 offset:21504
    v_cvt_pk_bf16_f32 v188, v52, v53
    v_cvt_pk_bf16_f32 v189, v54, v55
    s_waitcnt lgkmcnt(11)
    v_pk_mul_f32 v[156:157], v[156:157], v[218:219]
    v_pk_mul_f32 v[158:159], v[158:159], v[218:219]
    v_pk_fma_f32 v[60:61], v[60:61], v[214:215], v[156:157]
    v_pk_fma_f32 v[62:63], v[62:63], v[214:215], v[158:159]
    ds_read_b128 v[156:159], v201 offset:23552
    v_cvt_pk_bf16_f32 v190, v60, v61
    v_cvt_pk_bf16_f32 v191, v62, v63
    ds_write_b128 v201, v[188:191] offset:7168
    s_waitcnt lgkmcnt(11)
    v_pk_mul_f32 v[128:129], v[128:129], v[216:217]
    v_pk_mul_f32 v[130:131], v[130:131], v[216:217]
    v_pk_fma_f32 v[64:65], v[64:65], v[212:213], v[128:129]
    v_pk_fma_f32 v[66:67], v[66:67], v[212:213], v[130:131]
    ds_read_b128 v[128:131], v201 offset:24576
    v_cvt_pk_bf16_f32 v160, v64, v65
    v_cvt_pk_bf16_f32 v161, v66, v67
    s_waitcnt lgkmcnt(11)
    v_pk_mul_f32 v[132:133], v[132:133], v[216:217]
    v_pk_mul_f32 v[134:135], v[134:135], v[216:217]
    v_pk_fma_f32 v[72:73], v[72:73], v[212:213], v[132:133]
    v_pk_fma_f32 v[74:75], v[74:75], v[212:213], v[134:135]
    ds_read_b128 v[132:135], v201 offset:26624
    v_cvt_pk_bf16_f32 v162, v72, v73
    v_cvt_pk_bf16_f32 v163, v74, v75
    ds_write_b128 v201, v[160:163] offset:8192
    s_waitcnt lgkmcnt(11)
    v_pk_mul_f32 v[136:137], v[136:137], v[218:219]
    v_pk_mul_f32 v[138:139], v[138:139], v[218:219]
    v_pk_fma_f32 v[68:69], v[68:69], v[214:215], v[136:137]
    v_pk_fma_f32 v[70:71], v[70:71], v[214:215], v[138:139]
    ds_read_b128 v[136:139], v201 offset:25600
    v_cvt_pk_bf16_f32 v164, v68, v69
    v_cvt_pk_bf16_f32 v165, v70, v71
    s_waitcnt lgkmcnt(11)
    v_pk_mul_f32 v[140:141], v[140:141], v[218:219]
    v_pk_mul_f32 v[142:143], v[142:143], v[218:219]
    v_pk_fma_f32 v[76:77], v[76:77], v[214:215], v[140:141]
    v_pk_fma_f32 v[78:79], v[78:79], v[214:215], v[142:143]
    ds_read_b128 v[140:143], v201 offset:27648
    v_cvt_pk_bf16_f32 v166, v76, v77
    v_cvt_pk_bf16_f32 v167, v78, v79
    ds_write_b128 v201, v[164:167] offset:9216
    s_waitcnt lgkmcnt(11)
    v_pk_mul_f32 v[144:145], v[144:145], v[216:217]
    v_pk_mul_f32 v[146:147], v[146:147], v[216:217]
    v_pk_fma_f32 v[80:81], v[80:81], v[212:213], v[144:145]
    v_pk_fma_f32 v[82:83], v[82:83], v[212:213], v[146:147]
    ds_read_b128 v[144:147], v201 offset:28672
    v_cvt_pk_bf16_f32 v168, v80, v81
    v_cvt_pk_bf16_f32 v169, v82, v83
    s_waitcnt lgkmcnt(11)
    v_pk_mul_f32 v[148:149], v[148:149], v[216:217]
    v_pk_mul_f32 v[150:151], v[150:151], v[216:217]
    v_pk_fma_f32 v[88:89], v[88:89], v[212:213], v[148:149]
    v_pk_fma_f32 v[90:91], v[90:91], v[212:213], v[150:151]
    ds_read_b128 v[148:151], v201 offset:30720
    v_cvt_pk_bf16_f32 v170, v88, v89
    v_cvt_pk_bf16_f32 v171, v90, v91
    ds_write_b128 v201, v[168:171] offset:10240
    s_waitcnt lgkmcnt(11)
    v_pk_mul_f32 v[152:153], v[152:153], v[218:219]
    v_pk_mul_f32 v[154:155], v[154:155], v[218:219]
    v_pk_fma_f32 v[84:85], v[84:85], v[214:215], v[152:153]
    v_pk_fma_f32 v[86:87], v[86:87], v[214:215], v[154:155]
    ds_read_b128 v[152:155], v201 offset:29696
    v_cvt_pk_bf16_f32 v172, v84, v85
    v_cvt_pk_bf16_f32 v173, v86, v87
    s_waitcnt lgkmcnt(11)
    v_pk_mul_f32 v[156:157], v[156:157], v[218:219]
    v_pk_mul_f32 v[158:159], v[158:159], v[218:219]
    v_pk_fma_f32 v[92:93], v[92:93], v[214:215], v[156:157]
    v_pk_fma_f32 v[94:95], v[94:95], v[214:215], v[158:159]
    ds_read_b128 v[156:159], v201 offset:31744
    v_cvt_pk_bf16_f32 v174, v92, v93
    v_cvt_pk_bf16_f32 v175, v94, v95
    ds_write_b128 v201, v[172:175] offset:11264
    s_waitcnt lgkmcnt(11)
    v_pk_mul_f32 v[128:129], v[128:129], v[216:217]
    v_pk_mul_f32 v[130:131], v[130:131], v[216:217]
    v_pk_fma_f32 v[96:97], v[96:97], v[212:213], v[128:129]
    v_pk_fma_f32 v[98:99], v[98:99], v[212:213], v[130:131]
    v_cvt_pk_bf16_f32 v176, v96, v97
    v_cvt_pk_bf16_f32 v177, v98, v99
    s_waitcnt lgkmcnt(10)
    v_pk_mul_f32 v[132:133], v[132:133], v[216:217]
    v_pk_mul_f32 v[134:135], v[134:135], v[216:217]
    v_pk_fma_f32 v[104:105], v[104:105], v[212:213], v[132:133]
    v_pk_fma_f32 v[106:107], v[106:107], v[212:213], v[134:135]
    v_cvt_pk_bf16_f32 v178, v104, v105
    v_cvt_pk_bf16_f32 v179, v106, v107
    ds_write_b128 v201, v[176:179] offset:12288
    s_waitcnt lgkmcnt(9)
    v_pk_mul_f32 v[136:137], v[136:137], v[218:219]
    v_pk_mul_f32 v[138:139], v[138:139], v[218:219]
    v_pk_fma_f32 v[100:101], v[100:101], v[214:215], v[136:137]
    v_pk_fma_f32 v[102:103], v[102:103], v[214:215], v[138:139]
    v_cvt_pk_bf16_f32 v180, v100, v101
    v_cvt_pk_bf16_f32 v181, v102, v103
    s_waitcnt lgkmcnt(8)
    v_pk_mul_f32 v[140:141], v[140:141], v[218:219]
    v_pk_mul_f32 v[142:143], v[142:143], v[218:219]
    v_pk_fma_f32 v[108:109], v[108:109], v[214:215], v[140:141]
    v_pk_fma_f32 v[110:111], v[110:111], v[214:215], v[142:143]
    v_cvt_pk_bf16_f32 v182, v108, v109
    v_cvt_pk_bf16_f32 v183, v110, v111
    ds_write_b128 v201, v[180:183] offset:13312
    s_waitcnt lgkmcnt(7)
    v_pk_mul_f32 v[144:145], v[144:145], v[216:217]
    v_pk_mul_f32 v[146:147], v[146:147], v[216:217]
    v_pk_fma_f32 v[112:113], v[112:113], v[212:213], v[144:145]
    v_pk_fma_f32 v[114:115], v[114:115], v[212:213], v[146:147]
    v_cvt_pk_bf16_f32 v184, v112, v113
    v_cvt_pk_bf16_f32 v185, v114, v115
    s_waitcnt lgkmcnt(6)
    v_pk_mul_f32 v[148:149], v[148:149], v[216:217]
    v_pk_mul_f32 v[150:151], v[150:151], v[216:217]
    v_pk_fma_f32 v[120:121], v[120:121], v[212:213], v[148:149]
    v_pk_fma_f32 v[122:123], v[122:123], v[212:213], v[150:151]
    v_cvt_pk_bf16_f32 v186, v120, v121
    v_cvt_pk_bf16_f32 v187, v122, v123
    ds_write_b128 v201, v[184:187] offset:14336
    s_waitcnt lgkmcnt(5)
    v_pk_mul_f32 v[152:153], v[152:153], v[218:219]
    v_pk_mul_f32 v[154:155], v[154:155], v[218:219]
    v_pk_fma_f32 v[116:117], v[116:117], v[214:215], v[152:153]
    v_pk_fma_f32 v[118:119], v[118:119], v[214:215], v[154:155]
    v_cvt_pk_bf16_f32 v188, v116, v117
    v_cvt_pk_bf16_f32 v189, v118, v119
    s_waitcnt lgkmcnt(4)
    v_pk_mul_f32 v[156:157], v[156:157], v[218:219]
    v_pk_mul_f32 v[158:159], v[158:159], v[218:219]
    v_pk_fma_f32 v[124:125], v[124:125], v[214:215], v[156:157]
    v_pk_fma_f32 v[126:127], v[126:127], v[214:215], v[158:159]
    v_cvt_pk_bf16_f32 v190, v124, v125
    v_cvt_pk_bf16_f32 v191, v126, v127
    ds_write_b128 v201, v[188:191] offset:15360
    s_branch L_combdone
L_comb1:
    ds_write_b128 v200, a[0:3] offset:0
    v_accvgpr_read_b32 v0, a8
    v_accvgpr_read_b32 v1, a9
    v_accvgpr_read_b32 v2, a10
    v_accvgpr_read_b32 v3, a11
    s_mul_i32 s60, s34, 224
    s_mov_b32 s61, 0x124925
    v_add_u32 v192, 0, v252
    v_mul_u32_u24 v193, s61, v192
    ds_write_b128 v200, a[4:7] offset:1024
    v_accvgpr_read_b32 v4, a12
    v_accvgpr_read_b32 v5, a13
    v_accvgpr_read_b32 v6, a14
    v_accvgpr_read_b32 v7, a15
    v_lshrrev_b32 v193, 24, v193
    v_mul_u32_u24 v194, 14, v193
    v_sub_u32 v194, v192, v194
    v_mul_u32_u24 v193, 896, v193
    ds_write_b128 v200, a[16:19] offset:2048
    v_accvgpr_read_b32 v8, a24
    v_accvgpr_read_b32 v9, a25
    v_accvgpr_read_b32 v10, a26
    v_accvgpr_read_b32 v11, a27
    v_lshl_add_u32 v193, v194, 4, v193
    v_add_u32 v232, s60, v193
    v_add_u32 v192, 64, v252
    v_mul_u32_u24 v193, s61, v192
    ds_write_b128 v200, a[20:23] offset:3072
    v_accvgpr_read_b32 v12, a28
    v_accvgpr_read_b32 v13, a29
    v_accvgpr_read_b32 v14, a30
    v_accvgpr_read_b32 v15, a31
    v_lshrrev_b32 v193, 24, v193
    v_mul_u32_u24 v194, 14, v193
    v_sub_u32 v194, v192, v194
    v_mul_u32_u24 v193, 896, v193
    ds_write_b128 v200, a[32:35] offset:4096
    v_accvgpr_read_b32 v16, a40
    v_accvgpr_read_b32 v17, a41
    v_accvgpr_read_b32 v18, a42
    v_accvgpr_read_b32 v19, a43
    v_lshl_add_u32 v193, v194, 4, v193
    v_add_u32 v233, s60, v193
    v_add_u32 v192, 128, v252
    v_mul_u32_u24 v193, s61, v192
    ds_write_b128 v200, a[36:39] offset:5120
    v_accvgpr_read_b32 v20, a44
    v_accvgpr_read_b32 v21, a45
    v_accvgpr_read_b32 v22, a46
    v_accvgpr_read_b32 v23, a47
    v_lshrrev_b32 v193, 24, v193
    v_mul_u32_u24 v194, 14, v193
    v_sub_u32 v194, v192, v194
    v_mul_u32_u24 v193, 896, v193
    ds_write_b128 v200, a[48:51] offset:6144
    v_accvgpr_read_b32 v24, a56
    v_accvgpr_read_b32 v25, a57
    v_accvgpr_read_b32 v26, a58
    v_accvgpr_read_b32 v27, a59
    v_lshl_add_u32 v193, v194, 4, v193
    v_add_u32 v234, s60, v193
    v_add_u32 v192, 192, v252
    v_mul_u32_u24 v193, s61, v192
    ds_write_b128 v200, a[52:55] offset:7168
    v_accvgpr_read_b32 v28, a60
    v_accvgpr_read_b32 v29, a61
    v_accvgpr_read_b32 v30, a62
    v_accvgpr_read_b32 v31, a63
    v_lshrrev_b32 v193, 24, v193
    v_mul_u32_u24 v194, 14, v193
    v_sub_u32 v194, v192, v194
    v_mul_u32_u24 v193, 896, v193
    ds_write_b128 v200, a[64:67] offset:8192
    v_accvgpr_read_b32 v32, a72
    v_accvgpr_read_b32 v33, a73
    v_accvgpr_read_b32 v34, a74
    v_accvgpr_read_b32 v35, a75
    v_lshl_add_u32 v193, v194, 4, v193
    v_add_u32 v235, s60, v193
    v_add_u32 v192, 256, v252
    v_mul_u32_u24 v193, s61, v192
    ds_write_b128 v200, a[68:71] offset:9216
    v_accvgpr_read_b32 v36, a76
    v_accvgpr_read_b32 v37, a77
    v_accvgpr_read_b32 v38, a78
    v_accvgpr_read_b32 v39, a79
    v_lshrrev_b32 v193, 24, v193
    v_mul_u32_u24 v194, 14, v193
    v_sub_u32 v194, v192, v194
    v_mul_u32_u24 v193, 896, v193
    ds_write_b128 v200, a[80:83] offset:10240
    v_accvgpr_read_b32 v40, a88
    v_accvgpr_read_b32 v41, a89
    v_accvgpr_read_b32 v42, a90
    v_accvgpr_read_b32 v43, a91
    v_lshl_add_u32 v193, v194, 4, v193
    v_add_u32 v236, s60, v193
    v_add_u32 v192, 320, v252
    v_mul_u32_u24 v193, s61, v192
    ds_write_b128 v200, a[84:87] offset:11264
    v_accvgpr_read_b32 v44, a92
    v_accvgpr_read_b32 v45, a93
    v_accvgpr_read_b32 v46, a94
    v_accvgpr_read_b32 v47, a95
    v_lshrrev_b32 v193, 24, v193
    v_mul_u32_u24 v194, 14, v193
    v_sub_u32 v194, v192, v194
    v_mul_u32_u24 v193, 896, v193
    ds_write_b128 v200, a[96:99] offset:12288
    v_accvgpr_read_b32 v48, a104
    v_accvgpr_read_b32 v49, a105
    v_accvgpr_read_b32 v50, a106
    v_accvgpr_read_b32 v51, a107
    v_lshl_add_u32 v193, v194, 4, v193
    v_add_u32 v237, s60, v193
    v_add_u32 v192, 384, v252
    v_mul_u32_u24 v193, s61, v192
    ds_write_b128 v200, a[100:103] offset:13312
    v_accvgpr_read_b32 v52, a108
    v_accvgpr_read_b32 v53, a109
    v_accvgpr_read_b32 v54, a110
    v_accvgpr_read_b32 v55, a111
    v_lshrrev_b32 v193, 24, v193
    v_mul_u32_u24 v194, 14, v193
    v_sub_u32 v194, v192, v194
    v_mul_u32_u24 v193, 896, v193
    ds_write_b128 v200, a[112:115] offset:14336
    v_accvgpr_read_b32 v56, a120
    v_accvgpr_read_b32 v57, a121
    v_accvgpr_read_b32 v58, a122
    v_accvgpr_read_b32 v59, a123
    v_lshl_add_u32 v193, v194, 4, v193
    v_add_u32 v238, s60, v193
    s_mul_i32 s60, s34, 7168
    s_add_u32 s60, s60, 135168
    ds_write_b128 v200, a[116:119] offset:15360
    v_accvgpr_read_b32 v60, a124
    v_accvgpr_read_b32 v61, a125
    v_accvgpr_read_b32 v62, a126
    v_accvgpr_read_b32 v63, a127
    s_mul_i32 s61, s34, 32768
    s_add_u32 s61, s61, 16384
    s_add_u32 s62, s61, 7168
    s_mov_b32 s65, 0
    ds_write_b128 v200, a[128:131] offset:16384
    v_accvgpr_read_b32 v64, a136
    v_accvgpr_read_b32 v65, a137
    v_accvgpr_read_b32 v66, a138
    v_accvgpr_read_b32 v67, a139
    s_add_u32 m0, s60, 0
    s_nop 0
    buffer_load_dwordx4 v232, s[48:51], s65 offen lds
    s_add_u32 m0, s60, 1024
    ds_write_b128 v200, a[132:135] offset:17408
    v_accvgpr_read_b32 v68, a140
    v_accvgpr_read_b32 v69, a141
    v_accvgpr_read_b32 v70, a142
    v_accvgpr_read_b32 v71, a143
    s_nop 0
    buffer_load_dwordx4 v233, s[48:51], s65 offen lds
    s_add_u32 m0, s60, 2048
    s_nop 0
    ds_write_b128 v200, a[144:147] offset:18432
    v_accvgpr_read_b32 v72, a152
    v_accvgpr_read_b32 v73, a153
    v_accvgpr_read_b32 v74, a154
    v_accvgpr_read_b32 v75, a155
    buffer_load_dwordx4 v234, s[48:51], s65 offen lds
    s_add_u32 m0, s60, 3072
    s_nop 0
    buffer_load_dwordx4 v235, s[48:51], s65 offen lds
    ds_write_b128 v200, a[148:151] offset:19456
    v_accvgpr_read_b32 v76, a156
    v_accvgpr_read_b32 v77, a157
    v_accvgpr_read_b32 v78, a158
    v_accvgpr_read_b32 v79, a159
    s_add_u32 m0, s60, 4096
    s_nop 0
    buffer_load_dwordx4 v236, s[48:51], s65 offen lds
    s_add_u32 m0, s60, 5120
    ds_write_b128 v200, a[160:163] offset:20480
    v_accvgpr_read_b32 v80, a168
    v_accvgpr_read_b32 v81, a169
    v_accvgpr_read_b32 v82, a170
    v_accvgpr_read_b32 v83, a171
    s_nop 0
    buffer_load_dwordx4 v237, s[48:51], s65 offen lds
    s_add_u32 m0, s60, 6144
    s_nop 0
    ds_write_b128 v200, a[164:167] offset:21504
    v_accvgpr_read_b32 v84, a172
    v_accvgpr_read_b32 v85, a173
    v_accvgpr_read_b32 v86, a174
    v_accvgpr_read_b32 v87, a175
    buffer_load_dwordx4 v238, s[48:51], s65 offen lds
    s_mov_b32 s65, 28672
    v_lshrrev_b32 v192, 2, v252
    v_mul_u32_u24 v192, 224, v192
    ds_write_b128 v200, a[176:179] offset:22528
    v_accvgpr_read_b32 v88, a184
    v_accvgpr_read_b32 v89, a185
    v_accvgpr_read_b32 v90, a186
    v_accvgpr_read_b32 v91, a187
    v_and_b32 v193, 3, v252
    v_lshl_add_u32 v192, v193, 3, v192
    v_add_u32 v224, s60, v192
    v_add_u32 v225, s61, v192
    ds_write_b128 v200, a[180:183] offset:23552
    v_accvgpr_read_b32 v92, a188
    v_accvgpr_read_b32 v93, a189
    v_accvgpr_read_b32 v94, a190
    v_accvgpr_read_b32 v95, a191
    v_add_u32 v226, s62, v192
    v_lshlrev_b32 v192, 4, v252
    v_add_u32 v228, 0, v192
    v_add_u32 v229, 32768, v192
    ds_write_b128 v200, a[192:195] offset:24576
    v_accvgpr_read_b32 v96, a200
    v_accvgpr_read_b32 v97, a201
    v_accvgpr_read_b32 v98, a202
    v_accvgpr_read_b32 v99, a203
    v_add_u32 v230, 65536, v192
    v_add_u32 v231, 98304, v192
    ds_write_b128 v200, a[196:199] offset:25600
    v_accvgpr_read_b32 v100, a204
    v_accvgpr_read_b32 v101, a205
    v_accvgpr_read_b32 v102, a206
    v_accvgpr_read_b32 v103, a207
    ds_write_b128 v200, a[208:211] offset:26624
    v_accvgpr_read_b32 v104, a216
    v_accvgpr_read_b32 v105, a217
    v_accvgpr_read_b32 v106, a218
    v_accvgpr_read_b32 v107, a219
    ds_write_b128 v200, a[212:215] offset:27648
    v_accvgpr_read_b32 v108, a220
    v_accvgpr_read_b32 v109, a221
    v_accvgpr_read_b32 v110, a222
    v_accvgpr_read_b32 v111, a223
    ds_write_b128 v200, a[224:227] offset:28672
    v_accvgpr_read_b32 v112, a232
    v_accvgpr_read_b32 v113, a233
    v_accvgpr_read_b32 v114, a234
    v_accvgpr_read_b32 v115, a235
    ds_write_b128 v200, a[228:231] offset:29696
    v_accvgpr_read_b32 v116, a236
    v_accvgpr_read_b32 v117, a237
    v_accvgpr_read_b32 v118, a238
    v_accvgpr_read_b32 v119, a239
    ds_write_b128 v200, a[240:243] offset:30720
    v_accvgpr_read_b32 v120, a248
    v_accvgpr_read_b32 v121, a249
    v_accvgpr_read_b32 v122, a250
    v_accvgpr_read_b32 v123, a251
    ds_write_b128 v200, a[244:247] offset:31744
    v_accvgpr_read_b32 v124, a252
    v_accvgpr_read_b32 v125, a253
    v_accvgpr_read_b32 v126, a254
    v_accvgpr_read_b32 v127, a255
    s_waitcnt lgkmcnt(0)
    s_barrier
    ds_read_b128 v[204:207], v203
    ds_read_b128 v[208:211], v203 offset:16
    ds_read_b128 v[128:131], v201 offset:0
    ds_read_b128 v[132:135], v201 offset:2048
    ds_read_b128 v[136:139], v201 offset:1024
    ds_read_b128 v[140:143], v201 offset:3072
    ds_read_b128 v[144:147], v201 offset:4096
    ds_read_b128 v[148:151], v201 offset:6144
    ds_read_b128 v[152:155], v201 offset:5120
    ds_read_b128 v[156:159], v201 offset:7168
    s_waitcnt lgkmcnt(9)
    v_min_f32 v220, v242, v206
    v_sub_f32 v221, v220, v242
    v_sub_f32 v222, v220, v206
    v_exp_f32 v221, v221
    v_exp_f32 v222, v222
    s_nop 0
    v_mul_f32 v223, v221, v246
    s_waitcnt lgkmcnt(8)
    v_fmac_f32 v223, v222, v210
    v_rcp_f32 v223, v223
    s_nop 0
    v_mul_f32 v212, v221, v223
    v_mul_f32 v216, v222, v223
    v_mov_b32 v213, v212
    v_mov_b32 v217, v216
    v_min_f32 v220, v243, v207
    v_sub_f32 v221, v220, v243
    v_sub_f32 v222, v220, v207
    v_exp_f32 v221, v221
    v_exp_f32 v222, v222
    s_nop 0
    v_mul_f32 v223, v221, v247
    v_fmac_f32 v223, v222, v211
    v_rcp_f32 v223, v223
    s_nop 0
    v_mul_f32 v214, v221, v223
    v_mul_f32 v218, v222, v223
    v_mov_b32 v215, v214
    v_mov_b32 v219, v218
    s_waitcnt lgkmcnt(7)
    v_pk_mul_f32 v[128:129], v[128:129], v[216:217]
    v_pk_mul_f32 v[130:131], v[130:131], v[216:217]
    v_pk_fma_f32 v[0:1], v[0:1], v[212:213], v[128:129]
    v_pk_fma_f32 v[2:3], v[2:3], v[212:213], v[130:131]
    ds_read_b128 v[128:131], v201 offset:8192
    v_cvt_pk_bf16_f32 v160, v0, v1
    v_cvt_pk_bf16_f32 v161, v2, v3
    s_waitcnt lgkmcnt(7)
    v_pk_mul_f32 v[132:133], v[132:133], v[216:217]
    v_pk_mul_f32 v[134:135], v[134:135], v[216:217]
    v_pk_fma_f32 v[8:9], v[8:9], v[212:213], v[132:133]
    v_pk_fma_f32 v[10:11], v[10:11], v[212:213], v[134:135]
    ds_read_b128 v[132:135], v201 offset:10240
    v_cvt_pk_bf16_f32 v162, v8, v9
    v_cvt_pk_bf16_f32 v163, v10, v11
    ds_write_b128 v201, v[160:163] offset:0
    s_waitcnt lgkmcnt(8)
    v_pk_mul_f32 v[136:137], v[136:137], v[218:219]
    v_pk_mul_f32 v[138:139], v[138:139], v[218:219]
    v_pk_fma_f32 v[4:5], v[4:5], v[214:215], v[136:137]
    v_pk_fma_f32 v[6:7], v[6:7], v[214:215], v[138:139]
    ds_read_b128 v[136:139], v201 offset:9216
    v_cvt_pk_bf16_f32 v164, v4, v5
    v_cvt_pk_bf16_f32 v165, v6, v7
    s_waitcnt lgkmcnt(8)
    v_pk_mul_f32 v[140:141], v[140:141], v[218:219]
    v_pk_mul_f32 v[142:143], v[142:143], v[218:219]
    v_pk_fma_f32 v[12:13], v[12:13], v[214:215], v[140:141]
    v_pk_fma_f32 v[14:15], v[14:15], v[214:215], v[142:143]
    ds_read_b128 v[140:143], v201 offset:11264
    v_cvt_pk_bf16_f32 v166, v12, v13
    v_cvt_pk_bf16_f32 v167, v14, v15
    ds_write_b128 v201, v[164:167] offset:1024
    s_waitcnt lgkmcnt(9)
    v_pk_mul_f32 v[144:145], v[144:145], v[216:217]
    v_pk_mul_f32 v[146:147], v[146:147], v[216:217]
    v_pk_fma_f32 v[16:17], v[16:17], v[212:213], v[144:145]
    v_pk_fma_f32 v[18:19], v[18:19], v[212:213], v[146:147]
    ds_read_b128 v[144:147], v201 offset:12288
    v_cvt_pk_bf16_f32 v168, v16, v17
    v_cvt_pk_bf16_f32 v169, v18, v19
    s_waitcnt lgkmcnt(9)
    v_pk_mul_f32 v[148:149], v[148:149], v[216:217]
    v_pk_mul_f32 v[150:151], v[150:151], v[216:217]
    v_pk_fma_f32 v[24:25], v[24:25], v[212:213], v[148:149]
    v_pk_fma_f32 v[26:27], v[26:27], v[212:213], v[150:151]
    ds_read_b128 v[148:151], v201 offset:14336
    v_cvt_pk_bf16_f32 v170, v24, v25
    v_cvt_pk_bf16_f32 v171, v26, v27
    ds_write_b128 v201, v[168:171] offset:2048
    s_waitcnt lgkmcnt(10)
    v_pk_mul_f32 v[152:153], v[152:153], v[218:219]
    v_pk_mul_f32 v[154:155], v[154:155], v[218:219]
    v_pk_fma_f32 v[20:21], v[20:21], v[214:215], v[152:153]
    v_pk_fma_f32 v[22:23], v[22:23], v[214:215], v[154:155]
    ds_read_b128 v[152:155], v201 offset:13312
    v_cvt_pk_bf16_f32 v172, v20, v21
    v_cvt_pk_bf16_f32 v173, v22, v23
    s_waitcnt lgkmcnt(10)
    v_pk_mul_f32 v[156:157], v[156:157], v[218:219]
    v_pk_mul_f32 v[158:159], v[158:159], v[218:219]
    v_pk_fma_f32 v[28:29], v[28:29], v[214:215], v[156:157]
    v_pk_fma_f32 v[30:31], v[30:31], v[214:215], v[158:159]
    ds_read_b128 v[156:159], v201 offset:15360
    v_cvt_pk_bf16_f32 v174, v28, v29
    v_cvt_pk_bf16_f32 v175, v30, v31
    ds_write_b128 v201, v[172:175] offset:3072
    s_waitcnt lgkmcnt(11)
    v_pk_mul_f32 v[128:129], v[128:129], v[216:217]
    v_pk_mul_f32 v[130:131], v[130:131], v[216:217]
    v_pk_fma_f32 v[32:33], v[32:33], v[212:213], v[128:129]
    v_pk_fma_f32 v[34:35], v[34:35], v[212:213], v[130:131]
    ds_read_b128 v[128:131], v201 offset:16384
    v_cvt_pk_bf16_f32 v176, v32, v33
    v_cvt_pk_bf16_f32 v177, v34, v35
    s_waitcnt lgkmcnt(11)
    v_pk_mul_f32 v[132:133], v[132:133], v[216:217]
    v_pk_mul_f32 v[134:135], v[134:135], v[216:217]
    v_pk_fma_f32 v[40:41], v[40:41], v[212:213], v[132:133]
    v_pk_fma_f32 v[42:43], v[42:43], v[212:213], v[134:135]
    ds_read_b128 v[132:135], v201 offset:18432
    v_cvt_pk_bf16_f32 v178, v40, v41
    v_cvt_pk_bf16_f32 v179, v42, v43
    ds_write_b128 v201, v[176:179] offset:4096
    s_waitcnt lgkmcnt(11)
    v_pk_mul_f32 v[136:137], v[136:137], v[218:219]
    v_pk_mul_f32 v[138:139], v[138:139], v[218:219]
    v_pk_fma_f32 v[36:37], v[36:37], v[214:215], v[136:137]
    v_pk_fma_f32 v[38:39], v[38:39], v[214:215], v[138:139]
    ds_read_b128 v[136:139], v201 offset:17408
    v_cvt_pk_bf16_f32 v180, v36, v37
    v_cvt_pk_bf16_f32 v181, v38, v39
    s_waitcnt lgkmcnt(11)
    v_pk_mul_f32 v[140:141], v[140:141], v[218:219]
    v_pk_mul_f32 v[142:143], v[142:143], v[218:219]
    v_pk_fma_f32 v[44:45], v[44:45], v[214:215], v[140:141]
    v_pk_fma_f32 v[46:47], v[46:47], v[214:215], v[142:143]
    ds_read_b128 v[140:143], v201 offset:19456
    v_cvt_pk_bf16_f32 v182, v44, v45
    v_cvt_pk_bf16_f32 v183, v46, v47
    ds_write_b128 v201, v[180:183] offset:5120
    s_waitcnt lgkmcnt(11)
    v_pk_mul_f32 v[144:145], v[144:145], v[216:217]
    v_pk_mul_f32 v[146:147], v[146:147], v[216:217]
    v_pk_fma_f32 v[48:49], v[48:49], v[212:213], v[144:145]
    v_pk_fma_f32 v[50:51], v[50:51], v[212:213], v[146:147]
    ds_read_b128 v[144:147], v201 offset:20480
    v_cvt_pk_bf16_f32 v184, v48, v49
    v_cvt_pk_bf16_f32 v185, v50, v51
    s_waitcnt lgkmcnt(11)
    v_pk_mul_f32 v[148:149], v[148:149], v[216:217]
    v_pk_mul_f32 v[150:151], v[150:151], v[216:217]
    v_pk_fma_f32 v[56:57], v[56:57], v[212:213], v[148:149]
    v_pk_fma_f32 v[58:59], v[58:59], v[212:213], v[150:151]
    ds_read_b128 v[148:151], v201 offset:22528
    v_cvt_pk_bf16_f32 v186, v56, v57
    v_cvt_pk_bf16_f32 v187, v58, v59
    ds_write_b128 v201, v[184:187] offset:6144
    s_waitcnt lgkmcnt(11)
    v_pk_mul_f32 v[152:153], v[152:153], v[218:219]
    v_pk_mul_f32 v[154:155], v[154:155], v[218:219]
    v_pk_fma_f32 v[52:53], v[52:53], v[214:215], v[152:153]
    v_pk_fma_f32 v[54:55], v[54:55], v[214:215], v[154:155]
    ds_read_b128 v[152:155], v201 offset:21504
    v_cvt_pk_bf16_f32 v188, v52, v53
    v_cvt_pk_bf16_f32 v189, v54, v55
    s_waitcnt lgkmcnt(11)
    v_pk_mul_f32 v[156:157], v[156:157], v[218:219]
    v_pk_mul_f32 v[158:159], v[158:159], v[218:219]
    v_pk_fma_f32 v[60:61], v[60:61], v[214:215], v[156:157]
    v_pk_fma_f32 v[62:63], v[62:63], v[214:215], v[158:159]
    ds_read_b128 v[156:159], v201 offset:23552
    v_cvt_pk_bf16_f32 v190, v60, v61
    v_cvt_pk_bf16_f32 v191, v62, v63
    ds_write_b128 v201, v[188:191] offset:7168
    s_waitcnt lgkmcnt(11)
    v_pk_mul_f32 v[128:129], v[128:129], v[216:217]
    v_pk_mul_f32 v[130:131], v[130:131], v[216:217]
    v_pk_fma_f32 v[64:65], v[64:65], v[212:213], v[128:129]
    v_pk_fma_f32 v[66:67], v[66:67], v[212:213], v[130:131]
    ds_read_b128 v[128:131], v201 offset:24576
    v_cvt_pk_bf16_f32 v160, v64, v65
    v_cvt_pk_bf16_f32 v161, v66, v67
    s_waitcnt lgkmcnt(11)
    v_pk_mul_f32 v[132:133], v[132:133], v[216:217]
    v_pk_mul_f32 v[134:135], v[134:135], v[216:217]
    v_pk_fma_f32 v[72:73], v[72:73], v[212:213], v[132:133]
    v_pk_fma_f32 v[74:75], v[74:75], v[212:213], v[134:135]
    ds_read_b128 v[132:135], v201 offset:26624
    v_cvt_pk_bf16_f32 v162, v72, v73
    v_cvt_pk_bf16_f32 v163, v74, v75
    ds_write_b128 v201, v[160:163] offset:8192
    s_waitcnt lgkmcnt(11)
    v_pk_mul_f32 v[136:137], v[136:137], v[218:219]
    v_pk_mul_f32 v[138:139], v[138:139], v[218:219]
    v_pk_fma_f32 v[68:69], v[68:69], v[214:215], v[136:137]
    v_pk_fma_f32 v[70:71], v[70:71], v[214:215], v[138:139]
    ds_read_b128 v[136:139], v201 offset:25600
    v_cvt_pk_bf16_f32 v164, v68, v69
    v_cvt_pk_bf16_f32 v165, v70, v71
    s_waitcnt lgkmcnt(11)
    v_pk_mul_f32 v[140:141], v[140:141], v[218:219]
    v_pk_mul_f32 v[142:143], v[142:143], v[218:219]
    v_pk_fma_f32 v[76:77], v[76:77], v[214:215], v[140:141]
    v_pk_fma_f32 v[78:79], v[78:79], v[214:215], v[142:143]
    ds_read_b128 v[140:143], v201 offset:27648
    v_cvt_pk_bf16_f32 v166, v76, v77
    v_cvt_pk_bf16_f32 v167, v78, v79
    ds_write_b128 v201, v[164:167] offset:9216
    s_waitcnt lgkmcnt(11)
    v_pk_mul_f32 v[144:145], v[144:145], v[216:217]
    v_pk_mul_f32 v[146:147], v[146:147], v[216:217]
    v_pk_fma_f32 v[80:81], v[80:81], v[212:213], v[144:145]
    v_pk_fma_f32 v[82:83], v[82:83], v[212:213], v[146:147]
    ds_read_b128 v[144:147], v201 offset:28672
    v_cvt_pk_bf16_f32 v168, v80, v81
    v_cvt_pk_bf16_f32 v169, v82, v83
    s_waitcnt lgkmcnt(11)
    v_pk_mul_f32 v[148:149], v[148:149], v[216:217]
    v_pk_mul_f32 v[150:151], v[150:151], v[216:217]
    v_pk_fma_f32 v[88:89], v[88:89], v[212:213], v[148:149]
    v_pk_fma_f32 v[90:91], v[90:91], v[212:213], v[150:151]
    ds_read_b128 v[148:151], v201 offset:30720
    v_cvt_pk_bf16_f32 v170, v88, v89
    v_cvt_pk_bf16_f32 v171, v90, v91
    ds_write_b128 v201, v[168:171] offset:10240
    s_waitcnt lgkmcnt(11)
    v_pk_mul_f32 v[152:153], v[152:153], v[218:219]
    v_pk_mul_f32 v[154:155], v[154:155], v[218:219]
    v_pk_fma_f32 v[84:85], v[84:85], v[214:215], v[152:153]
    v_pk_fma_f32 v[86:87], v[86:87], v[214:215], v[154:155]
    ds_read_b128 v[152:155], v201 offset:29696
    v_cvt_pk_bf16_f32 v172, v84, v85
    v_cvt_pk_bf16_f32 v173, v86, v87
    s_waitcnt lgkmcnt(11)
    v_pk_mul_f32 v[156:157], v[156:157], v[218:219]
    v_pk_mul_f32 v[158:159], v[158:159], v[218:219]
    v_pk_fma_f32 v[92:93], v[92:93], v[214:215], v[156:157]
    v_pk_fma_f32 v[94:95], v[94:95], v[214:215], v[158:159]
    ds_read_b128 v[156:159], v201 offset:31744
    v_cvt_pk_bf16_f32 v174, v92, v93
    v_cvt_pk_bf16_f32 v175, v94, v95
    ds_write_b128 v201, v[172:175] offset:11264
    s_waitcnt lgkmcnt(11)
    v_pk_mul_f32 v[128:129], v[128:129], v[216:217]
    v_pk_mul_f32 v[130:131], v[130:131], v[216:217]
    v_pk_fma_f32 v[96:97], v[96:97], v[212:213], v[128:129]
    v_pk_fma_f32 v[98:99], v[98:99], v[212:213], v[130:131]
    v_cvt_pk_bf16_f32 v176, v96, v97
    v_cvt_pk_bf16_f32 v177, v98, v99
    s_waitcnt lgkmcnt(10)
    v_pk_mul_f32 v[132:133], v[132:133], v[216:217]
    v_pk_mul_f32 v[134:135], v[134:135], v[216:217]
    v_pk_fma_f32 v[104:105], v[104:105], v[212:213], v[132:133]
    v_pk_fma_f32 v[106:107], v[106:107], v[212:213], v[134:135]
    v_cvt_pk_bf16_f32 v178, v104, v105
    v_cvt_pk_bf16_f32 v179, v106, v107
    ds_write_b128 v201, v[176:179] offset:12288
    s_waitcnt lgkmcnt(9)
    v_pk_mul_f32 v[136:137], v[136:137], v[218:219]
    v_pk_mul_f32 v[138:139], v[138:139], v[218:219]
    v_pk_fma_f32 v[100:101], v[100:101], v[214:215], v[136:137]
    v_pk_fma_f32 v[102:103], v[102:103], v[214:215], v[138:139]
    v_cvt_pk_bf16_f32 v180, v100, v101
    v_cvt_pk_bf16_f32 v181, v102, v103
    s_waitcnt lgkmcnt(8)
    v_pk_mul_f32 v[140:141], v[140:141], v[218:219]
    v_pk_mul_f32 v[142:143], v[142:143], v[218:219]
    v_pk_fma_f32 v[108:109], v[108:109], v[214:215], v[140:141]
    v_pk_fma_f32 v[110:111], v[110:111], v[214:215], v[142:143]
    v_cvt_pk_bf16_f32 v182, v108, v109
    v_cvt_pk_bf16_f32 v183, v110, v111
    ds_write_b128 v201, v[180:183] offset:13312
    s_waitcnt lgkmcnt(7)
    v_pk_mul_f32 v[144:145], v[144:145], v[216:217]
    v_pk_mul_f32 v[146:147], v[146:147], v[216:217]
    v_pk_fma_f32 v[112:113], v[112:113], v[212:213], v[144:145]
    v_pk_fma_f32 v[114:115], v[114:115], v[212:213], v[146:147]
    v_cvt_pk_bf16_f32 v184, v112, v113
    v_cvt_pk_bf16_f32 v185, v114, v115
    s_waitcnt lgkmcnt(6)
    v_pk_mul_f32 v[148:149], v[148:149], v[216:217]
    v_pk_mul_f32 v[150:151], v[150:151], v[216:217]
    v_pk_fma_f32 v[120:121], v[120:121], v[212:213], v[148:149]
    v_pk_fma_f32 v[122:123], v[122:123], v[212:213], v[150:151]
    v_cvt_pk_bf16_f32 v186, v120, v121
    v_cvt_pk_bf16_f32 v187, v122, v123
    ds_write_b128 v201, v[184:187] offset:14336
    s_waitcnt lgkmcnt(5)
    v_pk_mul_f32 v[152:153], v[152:153], v[218:219]
    v_pk_mul_f32 v[154:155], v[154:155], v[218:219]
    v_pk_fma_f32 v[116:117], v[116:117], v[214:215], v[152:153]
    v_pk_fma_f32 v[118:119], v[118:119], v[214:215], v[154:155]
    v_cvt_pk_bf16_f32 v188, v116, v117
    v_cvt_pk_bf16_f32 v189, v118, v119
    s_waitcnt lgkmcnt(4)
    v_pk_mul_f32 v[156:157], v[156:157], v[218:219]
    v_pk_mul_f32 v[158:159], v[158:159], v[218:219]
    v_pk_fma_f32 v[124:125], v[124:125], v[214:215], v[156:157]
    v_pk_fma_f32 v[126:127], v[126:127], v[214:215], v[158:159]
    v_cvt_pk_bf16_f32 v190, v124, v125
    v_cvt_pk_bf16_f32 v191, v126, v127
    ds_write_b128 v201, v[188:191] offset:15360
L_combdone:
    s_load_dwordx2 s[4:5], s[0:1], 48
    s_load_dwordx2 s[6:7], s[0:1], 96
    s_load_dwordx4 s[28:31], s[0:1], 56
    s_load_dwordx2 s[32:33], s[0:1], 72
    v_mov_b32 v250, 0
    buffer_load_dword v251, v250, s[88:91], 0 offen offset:64 sc1
    s_waitcnt lgkmcnt(0)
    s_barrier
    s_add_u32 m0, s61, 0
    s_nop 0
    buffer_load_dwordx4 v232, s[48:51], s65 offen lds
    s_add_u32 m0, s61, 1024
    s_nop 0
    buffer_load_dwordx4 v233, s[48:51], s65 offen lds
    s_add_u32 m0, s61, 2048
    s_nop 0
    buffer_load_dwordx4 v234, s[48:51], s65 offen lds
    s_add_u32 m0, s61, 3072
    s_nop 0
    buffer_load_dwordx4 v235, s[48:51], s65 offen lds
    s_add_u32 m0, s61, 4096
    s_nop 0
    buffer_load_dwordx4 v236, s[48:51], s65 offen lds
    s_add_u32 m0, s61, 5120
    s_nop 0
    buffer_load_dwordx4 v237, s[48:51], s65 offen lds
    s_add_u32 m0, s61, 6144
    s_nop 0
    buffer_load_dwordx4 v238, s[48:51], s65 offen lds
    s_mov_b32 s65, 57344
    s_waitcnt vmcnt(8)
    ds_read_b128 v[112:115], v230 offset:0
    ds_read_b128 v[116:119], v230 offset:1024
    ds_read_b128 v[120:123], v231 offset:0
    ds_read_b128 v[124:127], v231 offset:1024
    ds_read_b64_tr_b16 v[208:209], v224 offset:0
    ds_read_b64_tr_b16 v[210:211], v224 offset:3584
    ds_read_b64_tr_b16 v[212:213], v224 offset:32
    ds_read_b64_tr_b16 v[214:215], v224 offset:3616
    ds_read_b64_tr_b16 v[216:217], v224 offset:64
    ds_read_b64_tr_b16 v[218:219], v224 offset:3648
    s_waitcnt lgkmcnt(4)
    v_mfma_f32_16x16x32_bf16 v[0:3], v[208:211], v[112:115], 0
    ds_read_b64_tr_b16 v[220:221], v224 offset:96
    ds_read_b64_tr_b16 v[222:223], v224 offset:3680
    v_mfma_f32_16x16x32_bf16 v[4:7], v[208:211], v[116:119], 0
    s_add_u32 m0, s62, 0
    v_mfma_f32_16x16x32_bf16 v[8:11], v[208:211], v[120:123], 0
    buffer_load_dwordx4 v232, s[48:51], s65 offen lds
    v_mfma_f32_16x16x32_bf16 v[12:15], v[208:211], v[124:127], 0
    s_waitcnt lgkmcnt(4)
    v_mfma_f32_16x16x32_bf16 v[16:19], v[212:215], v[112:115], 0
    ds_read_b64_tr_b16 v[208:209], v224 offset:128
    ds_read_b64_tr_b16 v[210:211], v224 offset:3712
    v_mfma_f32_16x16x32_bf16 v[20:23], v[212:215], v[116:119], 0
    s_add_u32 m0, s62, 1024
    v_mfma_f32_16x16x32_bf16 v[24:27], v[212:215], v[120:123], 0
    buffer_load_dwordx4 v233, s[48:51], s65 offen lds
    v_mfma_f32_16x16x32_bf16 v[28:31], v[212:215], v[124:127], 0
    s_waitcnt lgkmcnt(4)
    v_mfma_f32_16x16x32_bf16 v[32:35], v[216:219], v[112:115], 0
    ds_read_b64_tr_b16 v[212:213], v224 offset:160
    ds_read_b64_tr_b16 v[214:215], v224 offset:3744
    v_mfma_f32_16x16x32_bf16 v[36:39], v[216:219], v[116:119], 0
    s_add_u32 m0, s62, 2048
    v_mfma_f32_16x16x32_bf16 v[40:43], v[216:219], v[120:123], 0
    buffer_load_dwordx4 v234, s[48:51], s65 offen lds
    v_mfma_f32_16x16x32_bf16 v[44:47], v[216:219], v[124:127], 0
    s_waitcnt lgkmcnt(4)
    v_mfma_f32_16x16x32_bf16 v[48:51], v[220:223], v[112:115], 0
    ds_read_b64_tr_b16 v[216:217], v224 offset:192
    ds_read_b64_tr_b16 v[218:219], v224 offset:3776
    v_mfma_f32_16x16x32_bf16 v[52:55], v[220:223], v[116:119], 0
    s_add_u32 m0, s62, 3072
    ds_read_b128 v[128:131], v230 offset:2048
    v_mfma_f32_16x16x32_bf16 v[56:59], v[220:223], v[120:123], 0
    buffer_load_dwordx4 v235, s[48:51], s65 offen lds
    v_mfma_f32_16x16x32_bf16 v[60:63], v[220:223], v[124:127], 0
    s_waitcnt lgkmcnt(5)
    v_mfma_f32_16x16x32_bf16 v[64:67], v[208:211], v[112:115], 0
    s_waitcnt vmcnt(4)
    ds_read_b64_tr_b16 v[220:221], v225 offset:0
    ds_read_b64_tr_b16 v[222:223], v225 offset:3584
    v_mfma_f32_16x16x32_bf16 v[68:71], v[208:211], v[116:119], 0
    s_add_u32 m0, s62, 4096
    ds_read_b128 v[132:135], v230 offset:3072
    v_mfma_f32_16x16x32_bf16 v[72:75], v[208:211], v[120:123], 0
    buffer_load_dwordx4 v236, s[48:51], s65 offen lds
    v_mfma_f32_16x16x32_bf16 v[76:79], v[208:211], v[124:127], 0
    s_waitcnt lgkmcnt(6)
    v_mfma_f32_16x16x32_bf16 v[80:83], v[212:215], v[112:115], 0
    ds_read_b64_tr_b16 v[208:209], v225 offset:32
    ds_read_b64_tr_b16 v[210:211], v225 offset:3616
    v_mfma_f32_16x16x32_bf16 v[84:87], v[212:215], v[116:119], 0
    s_add_u32 m0, s62, 5120
    ds_read_b128 v[136:139], v231 offset:2048
    v_mfma_f32_16x16x32_bf16 v[88:91], v[212:215], v[120:123], 0
    buffer_load_dwordx4 v237, s[48:51], s65 offen lds
    v_mfma_f32_16x16x32_bf16 v[92:95], v[212:215], v[124:127], 0
    s_waitcnt lgkmcnt(7)
    v_mfma_f32_16x16x32_bf16 v[96:99], v[216:219], v[112:115], 0
    ds_read_b64_tr_b16 v[212:213], v225 offset:64
    ds_read_b64_tr_b16 v[214:215], v225 offset:3648
    v_mfma_f32_16x16x32_bf16 v[100:103], v[216:219], v[116:119], 0
    s_add_u32 m0, s62, 6144
    ds_read_b128 v[140:143], v231 offset:3072
    v_mfma_f32_16x16x32_bf16 v[104:107], v[216:219], v[120:123], 0
    buffer_load_dwordx4 v238, s[48:51], s65 offen lds
    v_mfma_f32_16x16x32_bf16 v[108:111], v[216:219], v[124:127], 0
    s_waitcnt lgkmcnt(7)
    s_add_u32 s65, s65, 28672
    v_mfma_f32_16x16x32_bf16 v[0:3], v[220:223], v[128:131], v[0:3]
    s_waitcnt lgkmcnt(6)
    ds_read_b64_tr_b16 v[216:217], v225 offset:96
    ds_read_b64_tr_b16 v[218:219], v225 offset:3680
    v_mfma_f32_16x16x32_bf16 v[4:7], v[220:223], v[132:135], v[4:7]
    s_waitcnt lgkmcnt(5)
    s_add_u32 m0, s60, 0
    v_mfma_f32_16x16x32_bf16 v[8:11], v[220:223], v[136:139], v[8:11]
    s_waitcnt lgkmcnt(2)
    buffer_load_dwordx4 v232, s[48:51], s65 offen lds
    v_mfma_f32_16x16x32_bf16 v[12:15], v[220:223], v[140:143], v[12:15]
    v_mfma_f32_16x16x32_bf16 v[16:19], v[208:211], v[128:131], v[16:19]
    ds_read_b64_tr_b16 v[220:221], v225 offset:128
    ds_read_b64_tr_b16 v[222:223], v225 offset:3712
    v_mfma_f32_16x16x32_bf16 v[20:23], v[208:211], v[132:135], v[20:23]
    s_add_u32 m0, s60, 1024
    v_mfma_f32_16x16x32_bf16 v[24:27], v[208:211], v[136:139], v[24:27]
    buffer_load_dwordx4 v233, s[48:51], s65 offen lds
    v_mfma_f32_16x16x32_bf16 v[28:31], v[208:211], v[140:143], v[28:31]
    v_mfma_f32_16x16x32_bf16 v[32:35], v[212:215], v[128:131], v[32:35]
    ds_read_b64_tr_b16 v[208:209], v225 offset:160
    ds_read_b64_tr_b16 v[210:211], v225 offset:3744
    v_mfma_f32_16x16x32_bf16 v[36:39], v[212:215], v[132:135], v[36:39]
    s_add_u32 m0, s60, 2048
    v_mfma_f32_16x16x32_bf16 v[40:43], v[212:215], v[136:139], v[40:43]
    buffer_load_dwordx4 v234, s[48:51], s65 offen lds
    v_mfma_f32_16x16x32_bf16 v[44:47], v[212:215], v[140:143], v[44:47]
    s_waitcnt lgkmcnt(4)
    v_mfma_f32_16x16x32_bf16 v[48:51], v[216:219], v[128:131], v[48:51]
    ds_read_b64_tr_b16 v[212:213], v225 offset:192
    ds_read_b64_tr_b16 v[214:215], v225 offset:3776
    v_mfma_f32_16x16x32_bf16 v[52:55], v[216:219], v[132:135], v[52:55]
    s_add_u32 m0, s60, 3072
    ds_read_b128 v[112:115], v230 offset:4096
    v_mfma_f32_16x16x32_bf16 v[56:59], v[216:219], v[136:139], v[56:59]
    buffer_load_dwordx4 v235, s[48:51], s65 offen lds
    v_mfma_f32_16x16x32_bf16 v[60:63], v[216:219], v[140:143], v[60:63]
    s_waitcnt lgkmcnt(5)
    v_mfma_f32_16x16x32_bf16 v[64:67], v[220:223], v[128:131], v[64:67]
    s_waitcnt vmcnt(4)
    ds_read_b64_tr_b16 v[216:217], v226 offset:0
    ds_read_b64_tr_b16 v[218:219], v226 offset:3584
    v_mfma_f32_16x16x32_bf16 v[68:71], v[220:223], v[132:135], v[68:71]
    s_add_u32 m0, s60, 4096
    ds_read_b128 v[116:119], v230 offset:5120
    v_mfma_f32_16x16x32_bf16 v[72:75], v[220:223], v[136:139], v[72:75]
    buffer_load_dwordx4 v236, s[48:51], s65 offen lds
    v_mfma_f32_16x16x32_bf16 v[76:79], v[220:223], v[140:143], v[76:79]
    s_waitcnt lgkmcnt(6)
    v_mfma_f32_16x16x32_bf16 v[80:83], v[208:211], v[128:131], v[80:83]
    ds_read_b64_tr_b16 v[220:221], v226 offset:32
    ds_read_b64_tr_b16 v[222:223], v226 offset:3616
    v_mfma_f32_16x16x32_bf16 v[84:87], v[208:211], v[132:135], v[84:87]
    s_add_u32 m0, s60, 5120
    ds_read_b128 v[120:123], v231 offset:4096
    v_mfma_f32_16x16x32_bf16 v[88:91], v[208:211], v[136:139], v[88:91]
    buffer_load_dwordx4 v237, s[48:51], s65 offen lds
    v_mfma_f32_16x16x32_bf16 v[92:95], v[208:211], v[140:143], v[92:95]
    s_waitcnt lgkmcnt(7)
    v_mfma_f32_16x16x32_bf16 v[96:99], v[212:215], v[128:131], v[96:99]
    ds_read_b64_tr_b16 v[208:209], v226 offset:64
    ds_read_b64_tr_b16 v[210:211], v226 offset:3648
    v_mfma_f32_16x16x32_bf16 v[100:103], v[212:215], v[132:135], v[100:103]
    s_add_u32 m0, s60, 6144
    ds_read_b128 v[124:127], v231 offset:5120
    v_mfma_f32_16x16x32_bf16 v[104:107], v[212:215], v[136:139], v[104:107]
    buffer_load_dwordx4 v238, s[48:51], s65 offen lds
    v_mfma_f32_16x16x32_bf16 v[108:111], v[212:215], v[140:143], v[108:111]
    s_waitcnt lgkmcnt(7)
    s_add_u32 s65, s65, 28672
    v_mfma_f32_16x16x32_bf16 v[0:3], v[216:219], v[112:115], v[0:3]
    s_waitcnt lgkmcnt(6)
    ds_read_b64_tr_b16 v[212:213], v226 offset:96
    ds_read_b64_tr_b16 v[214:215], v226 offset:3680
    v_mfma_f32_16x16x32_bf16 v[4:7], v[216:219], v[116:119], v[4:7]
    s_waitcnt lgkmcnt(5)
    s_add_u32 m0, s61, 0
    v_mfma_f32_16x16x32_bf16 v[8:11], v[216:219], v[120:123], v[8:11]
    s_waitcnt lgkmcnt(2)
    buffer_load_dwordx4 v232, s[48:51], s65 offen lds
    v_mfma_f32_16x16x32_bf16 v[12:15], v[216:219], v[124:127], v[12:15]
    v_mfma_f32_16x16x32_bf16 v[16:19], v[220:223], v[112:115], v[16:19]
    ds_read_b64_tr_b16 v[216:217], v226 offset:128
    ds_read_b64_tr_b16 v[218:219], v226 offset:3712
    v_mfma_f32_16x16x32_bf16 v[20:23], v[220:223], v[116:119], v[20:23]
    s_add_u32 m0, s61, 1024
    v_mfma_f32_16x16x32_bf16 v[24:27], v[220:223], v[120:123], v[24:27]
    buffer_load_dwordx4 v233, s[48:51], s65 offen lds
    v_mfma_f32_16x16x32_bf16 v[28:31], v[220:223], v[124:127], v[28:31]
    v_mfma_f32_16x16x32_bf16 v[32:35], v[208:211], v[112:115], v[32:35]
    ds_read_b64_tr_b16 v[220:221], v226 offset:160
    ds_read_b64_tr_b16 v[222:223], v226 offset:3744
    v_mfma_f32_16x16x32_bf16 v[36:39], v[208:211], v[116:119], v[36:39]
    s_add_u32 m0, s61, 2048
    v_mfma_f32_16x16x32_bf16 v[40:43], v[208:211], v[120:123], v[40:43]
    buffer_load_dwordx4 v234, s[48:51], s65 offen lds
    v_mfma_f32_16x16x32_bf16 v[44:47], v[208:211], v[124:127], v[44:47]
    s_waitcnt lgkmcnt(4)
    v_mfma_f32_16x16x32_bf16 v[48:51], v[212:215], v[112:115], v[48:51]
    ds_read_b64_tr_b16 v[208:209], v226 offset:192
    ds_read_b64_tr_b16 v[210:211], v226 offset:3776
    v_mfma_f32_16x16x32_bf16 v[52:55], v[212:215], v[116:119], v[52:55]
    s_add_u32 m0, s61, 3072
    ds_read_b128 v[128:131], v230 offset:6144
    v_mfma_f32_16x16x32_bf16 v[56:59], v[212:215], v[120:123], v[56:59]
    buffer_load_dwordx4 v235, s[48:51], s65 offen lds
    v_mfma_f32_16x16x32_bf16 v[60:63], v[212:215], v[124:127], v[60:63]
    s_waitcnt lgkmcnt(5)
    v_mfma_f32_16x16x32_bf16 v[64:67], v[216:219], v[112:115], v[64:67]
    s_waitcnt vmcnt(4)
    ds_read_b64_tr_b16 v[212:213], v224 offset:0
    ds_read_b64_tr_b16 v[214:215], v224 offset:3584
    v_mfma_f32_16x16x32_bf16 v[68:71], v[216:219], v[116:119], v[68:71]
    s_add_u32 m0, s61, 4096
    ds_read_b128 v[132:135], v230 offset:7168
    v_mfma_f32_16x16x32_bf16 v[72:75], v[216:219], v[120:123], v[72:75]
    buffer_load_dwordx4 v236, s[48:51], s65 offen lds
    v_mfma_f32_16x16x32_bf16 v[76:79], v[216:219], v[124:127], v[76:79]
    s_waitcnt lgkmcnt(6)
    v_mfma_f32_16x16x32_bf16 v[80:83], v[220:223], v[112:115], v[80:83]
    ds_read_b64_tr_b16 v[216:217], v224 offset:32
    ds_read_b64_tr_b16 v[218:219], v224 offset:3616
    v_mfma_f32_16x16x32_bf16 v[84:87], v[220:223], v[116:119], v[84:87]
    s_add_u32 m0, s61, 5120
    ds_read_b128 v[136:139], v231 offset:6144
    v_mfma_f32_16x16x32_bf16 v[88:91], v[220:223], v[120:123], v[88:91]
    buffer_load_dwordx4 v237, s[48:51], s65 offen lds
    v_mfma_f32_16x16x32_bf16 v[92:95], v[220:223], v[124:127], v[92:95]
    s_waitcnt lgkmcnt(7)
    v_mfma_f32_16x16x32_bf16 v[96:99], v[208:211], v[112:115], v[96:99]
    ds_read_b64_tr_b16 v[220:221], v224 offset:64
    ds_read_b64_tr_b16 v[222:223], v224 offset:3648
    v_mfma_f32_16x16x32_bf16 v[100:103], v[208:211], v[116:119], v[100:103]
    s_add_u32 m0, s61, 6144
    ds_read_b128 v[140:143], v231 offset:7168
    v_mfma_f32_16x16x32_bf16 v[104:107], v[208:211], v[120:123], v[104:107]
    buffer_load_dwordx4 v238, s[48:51], s65 offen lds
    v_mfma_f32_16x16x32_bf16 v[108:111], v[208:211], v[124:127], v[108:111]
    s_waitcnt lgkmcnt(7)
    s_add_u32 s65, s65, 28672
    v_mfma_f32_16x16x32_bf16 v[0:3], v[212:215], v[128:131], v[0:3]
    s_waitcnt lgkmcnt(6)
    ds_read_b64_tr_b16 v[208:209], v224 offset:96
    ds_read_b64_tr_b16 v[210:211], v224 offset:3680
    v_mfma_f32_16x16x32_bf16 v[4:7], v[212:215], v[132:135], v[4:7]
    s_waitcnt lgkmcnt(5)
    s_add_u32 m0, s62, 0
    v_mfma_f32_16x16x32_bf16 v[8:11], v[212:215], v[136:139], v[8:11]
    s_waitcnt lgkmcnt(2)
    buffer_load_dwordx4 v232, s[48:51], s65 offen lds
    v_mfma_f32_16x16x32_bf16 v[12:15], v[212:215], v[140:143], v[12:15]
    v_mfma_f32_16x16x32_bf16 v[16:19], v[216:219], v[128:131], v[16:19]
    ds_read_b64_tr_b16 v[212:213], v224 offset:128
    ds_read_b64_tr_b16 v[214:215], v224 offset:3712
    v_mfma_f32_16x16x32_bf16 v[20:23], v[216:219], v[132:135], v[20:23]
    s_add_u32 m0, s62, 1024
    v_mfma_f32_16x16x32_bf16 v[24:27], v[216:219], v[136:139], v[24:27]
    buffer_load_dwordx4 v233, s[48:51], s65 offen lds
    v_mfma_f32_16x16x32_bf16 v[28:31], v[216:219], v[140:143], v[28:31]
    v_mfma_f32_16x16x32_bf16 v[32:35], v[220:223], v[128:131], v[32:35]
    ds_read_b64_tr_b16 v[216:217], v224 offset:160
    ds_read_b64_tr_b16 v[218:219], v224 offset:3744
    v_mfma_f32_16x16x32_bf16 v[36:39], v[220:223], v[132:135], v[36:39]
    s_add_u32 m0, s62, 2048
    v_mfma_f32_16x16x32_bf16 v[40:43], v[220:223], v[136:139], v[40:43]
    buffer_load_dwordx4 v234, s[48:51], s65 offen lds
    v_mfma_f32_16x16x32_bf16 v[44:47], v[220:223], v[140:143], v[44:47]
    s_waitcnt lgkmcnt(4)
    v_mfma_f32_16x16x32_bf16 v[48:51], v[208:211], v[128:131], v[48:51]
    ds_read_b64_tr_b16 v[220:221], v224 offset:192
    ds_read_b64_tr_b16 v[222:223], v224 offset:3776
    v_mfma_f32_16x16x32_bf16 v[52:55], v[208:211], v[132:135], v[52:55]
    s_add_u32 m0, s62, 3072
    ds_read_b128 v[112:115], v230 offset:8192
    v_mfma_f32_16x16x32_bf16 v[56:59], v[208:211], v[136:139], v[56:59]
    buffer_load_dwordx4 v235, s[48:51], s65 offen lds
    v_mfma_f32_16x16x32_bf16 v[60:63], v[208:211], v[140:143], v[60:63]
    s_waitcnt lgkmcnt(5)
    v_mfma_f32_16x16x32_bf16 v[64:67], v[212:215], v[128:131], v[64:67]
    s_waitcnt vmcnt(4)
    ds_read_b64_tr_b16 v[208:209], v225 offset:0
    ds_read_b64_tr_b16 v[210:211], v225 offset:3584
    v_mfma_f32_16x16x32_bf16 v[68:71], v[212:215], v[132:135], v[68:71]
    s_add_u32 m0, s62, 4096
    ds_read_b128 v[116:119], v230 offset:9216
    v_mfma_f32_16x16x32_bf16 v[72:75], v[212:215], v[136:139], v[72:75]
    buffer_load_dwordx4 v236, s[48:51], s65 offen lds
    v_mfma_f32_16x16x32_bf16 v[76:79], v[212:215], v[140:143], v[76:79]
    s_waitcnt lgkmcnt(6)
    v_mfma_f32_16x16x32_bf16 v[80:83], v[216:219], v[128:131], v[80:83]
    ds_read_b64_tr_b16 v[212:213], v225 offset:32
    ds_read_b64_tr_b16 v[214:215], v225 offset:3616
    v_mfma_f32_16x16x32_bf16 v[84:87], v[216:219], v[132:135], v[84:87]
    s_add_u32 m0, s62, 5120
    ds_read_b128 v[120:123], v231 offset:8192
    v_mfma_f32_16x16x32_bf16 v[88:91], v[216:219], v[136:139], v[88:91]
    buffer_load_dwordx4 v237, s[48:51], s65 offen lds
    v_mfma_f32_16x16x32_bf16 v[92:95], v[216:219], v[140:143], v[92:95]
    s_waitcnt lgkmcnt(7)
    v_mfma_f32_16x16x32_bf16 v[96:99], v[220:223], v[128:131], v[96:99]
    ds_read_b64_tr_b16 v[216:217], v225 offset:64
    ds_read_b64_tr_b16 v[218:219], v225 offset:3648
    v_mfma_f32_16x16x32_bf16 v[100:103], v[220:223], v[132:135], v[100:103]
    s_add_u32 m0, s62, 6144
    ds_read_b128 v[124:127], v231 offset:9216
    v_mfma_f32_16x16x32_bf16 v[104:107], v[220:223], v[136:139], v[104:107]
    buffer_load_dwordx4 v238, s[48:51], s65 offen lds
    v_mfma_f32_16x16x32_bf16 v[108:111], v[220:223], v[140:143], v[108:111]
    s_waitcnt lgkmcnt(7)
    s_add_u32 s65, s65, 28672
    v_mfma_f32_16x16x32_bf16 v[0:3], v[208:211], v[112:115], v[0:3]
    s_waitcnt lgkmcnt(6)
    ds_read_b64_tr_b16 v[220:221], v225 offset:96
    ds_read_b64_tr_b16 v[222:223], v225 offset:3680
    v_mfma_f32_16x16x32_bf16 v[4:7], v[208:211], v[116:119], v[4:7]
    s_waitcnt lgkmcnt(5)
    s_add_u32 m0, s60, 0
    v_mfma_f32_16x16x32_bf16 v[8:11], v[208:211], v[120:123], v[8:11]
    s_waitcnt lgkmcnt(2)
    buffer_load_dwordx4 v232, s[48:51], s65 offen lds
    v_mfma_f32_16x16x32_bf16 v[12:15], v[208:211], v[124:127], v[12:15]
    v_mfma_f32_16x16x32_bf16 v[16:19], v[212:215], v[112:115], v[16:19]
    ds_read_b64_tr_b16 v[208:209], v225 offset:128
    ds_read_b64_tr_b16 v[210:211], v225 offset:3712
    v_mfma_f32_16x16x32_bf16 v[20:23], v[212:215], v[116:119], v[20:23]
    s_add_u32 m0, s60, 1024
    v_mfma_f32_16x16x32_bf16 v[24:27], v[212:215], v[120:123], v[24:27]
    buffer_load_dwordx4 v233, s[48:51], s65 offen lds
    v_mfma_f32_16x16x32_bf16 v[28:31], v[212:215], v[124:127], v[28:31]
    v_mfma_f32_16x16x32_bf16 v[32:35], v[216:219], v[112:115], v[32:35]
    ds_read_b64_tr_b16 v[212:213], v225 offset:160
    ds_read_b64_tr_b16 v[214:215], v225 offset:3744
    v_mfma_f32_16x16x32_bf16 v[36:39], v[216:219], v[116:119], v[36:39]
    s_add_u32 m0, s60, 2048
    v_mfma_f32_16x16x32_bf16 v[40:43], v[216:219], v[120:123], v[40:43]
    buffer_load_dwordx4 v234, s[48:51], s65 offen lds
    v_mfma_f32_16x16x32_bf16 v[44:47], v[216:219], v[124:127], v[44:47]
    s_waitcnt lgkmcnt(4)
    v_mfma_f32_16x16x32_bf16 v[48:51], v[220:223], v[112:115], v[48:51]
    ds_read_b64_tr_b16 v[216:217], v225 offset:192
    ds_read_b64_tr_b16 v[218:219], v225 offset:3776
    v_mfma_f32_16x16x32_bf16 v[52:55], v[220:223], v[116:119], v[52:55]
    s_add_u32 m0, s60, 3072
    ds_read_b128 v[128:131], v230 offset:10240
    v_mfma_f32_16x16x32_bf16 v[56:59], v[220:223], v[120:123], v[56:59]
    buffer_load_dwordx4 v235, s[48:51], s65 offen lds
    v_mfma_f32_16x16x32_bf16 v[60:63], v[220:223], v[124:127], v[60:63]
    s_waitcnt lgkmcnt(5)
    v_mfma_f32_16x16x32_bf16 v[64:67], v[208:211], v[112:115], v[64:67]
    s_waitcnt vmcnt(4)
    ds_read_b64_tr_b16 v[220:221], v226 offset:0
    ds_read_b64_tr_b16 v[222:223], v226 offset:3584
    v_mfma_f32_16x16x32_bf16 v[68:71], v[208:211], v[116:119], v[68:71]
    s_add_u32 m0, s60, 4096
    ds_read_b128 v[132:135], v230 offset:11264
    v_mfma_f32_16x16x32_bf16 v[72:75], v[208:211], v[120:123], v[72:75]
    buffer_load_dwordx4 v236, s[48:51], s65 offen lds
    v_mfma_f32_16x16x32_bf16 v[76:79], v[208:211], v[124:127], v[76:79]
    s_waitcnt lgkmcnt(6)
    v_mfma_f32_16x16x32_bf16 v[80:83], v[212:215], v[112:115], v[80:83]
    ds_read_b64_tr_b16 v[208:209], v226 offset:32
    ds_read_b64_tr_b16 v[210:211], v226 offset:3616
    v_mfma_f32_16x16x32_bf16 v[84:87], v[212:215], v[116:119], v[84:87]
    s_add_u32 m0, s60, 5120
    ds_read_b128 v[136:139], v231 offset:10240
    v_mfma_f32_16x16x32_bf16 v[88:91], v[212:215], v[120:123], v[88:91]
    buffer_load_dwordx4 v237, s[48:51], s65 offen lds
    v_mfma_f32_16x16x32_bf16 v[92:95], v[212:215], v[124:127], v[92:95]
    s_waitcnt lgkmcnt(7)
    v_mfma_f32_16x16x32_bf16 v[96:99], v[216:219], v[112:115], v[96:99]
    ds_read_b64_tr_b16 v[212:213], v226 offset:64
    ds_read_b64_tr_b16 v[214:215], v226 offset:3648
    v_mfma_f32_16x16x32_bf16 v[100:103], v[216:219], v[116:119], v[100:103]
    s_add_u32 m0, s60, 6144
    ds_read_b128 v[140:143], v231 offset:11264
    v_mfma_f32_16x16x32_bf16 v[104:107], v[216:219], v[120:123], v[104:107]
    buffer_load_dwordx4 v238, s[48:51], s65 offen lds
    v_mfma_f32_16x16x32_bf16 v[108:111], v[216:219], v[124:127], v[108:111]
    s_waitcnt lgkmcnt(7)
    s_add_u32 s65, s65, 28672
    v_mfma_f32_16x16x32_bf16 v[0:3], v[220:223], v[128:131], v[0:3]
    s_waitcnt lgkmcnt(6)
    ds_read_b64_tr_b16 v[216:217], v226 offset:96
    ds_read_b64_tr_b16 v[218:219], v226 offset:3680
    v_mfma_f32_16x16x32_bf16 v[4:7], v[220:223], v[132:135], v[4:7]
    s_waitcnt lgkmcnt(5)
    s_add_u32 m0, s61, 0
    v_mfma_f32_16x16x32_bf16 v[8:11], v[220:223], v[136:139], v[8:11]
    s_waitcnt lgkmcnt(2)
    buffer_load_dwordx4 v232, s[48:51], s65 offen lds
    v_mfma_f32_16x16x32_bf16 v[12:15], v[220:223], v[140:143], v[12:15]
    v_mfma_f32_16x16x32_bf16 v[16:19], v[208:211], v[128:131], v[16:19]
    ds_read_b64_tr_b16 v[220:221], v226 offset:128
    ds_read_b64_tr_b16 v[222:223], v226 offset:3712
    v_mfma_f32_16x16x32_bf16 v[20:23], v[208:211], v[132:135], v[20:23]
    s_add_u32 m0, s61, 1024
    v_mfma_f32_16x16x32_bf16 v[24:27], v[208:211], v[136:139], v[24:27]
    buffer_load_dwordx4 v233, s[48:51], s65 offen lds
    v_mfma_f32_16x16x32_bf16 v[28:31], v[208:211], v[140:143], v[28:31]
    v_mfma_f32_16x16x32_bf16 v[32:35], v[212:215], v[128:131], v[32:35]
    ds_read_b64_tr_b16 v[208:209], v226 offset:160
    ds_read_b64_tr_b16 v[210:211], v226 offset:3744
    v_mfma_f32_16x16x32_bf16 v[36:39], v[212:215], v[132:135], v[36:39]
    s_add_u32 m0, s61, 2048
    v_mfma_f32_16x16x32_bf16 v[40:43], v[212:215], v[136:139], v[40:43]
    buffer_load_dwordx4 v234, s[48:51], s65 offen lds
    v_mfma_f32_16x16x32_bf16 v[44:47], v[212:215], v[140:143], v[44:47]
    s_waitcnt lgkmcnt(4)
    v_mfma_f32_16x16x32_bf16 v[48:51], v[216:219], v[128:131], v[48:51]
    ds_read_b64_tr_b16 v[212:213], v226 offset:192
    ds_read_b64_tr_b16 v[214:215], v226 offset:3776
    v_mfma_f32_16x16x32_bf16 v[52:55], v[216:219], v[132:135], v[52:55]
    s_add_u32 m0, s61, 3072
    ds_read_b128 v[112:115], v230 offset:12288
    v_mfma_f32_16x16x32_bf16 v[56:59], v[216:219], v[136:139], v[56:59]
    buffer_load_dwordx4 v235, s[48:51], s65 offen lds
    v_mfma_f32_16x16x32_bf16 v[60:63], v[216:219], v[140:143], v[60:63]
    s_waitcnt lgkmcnt(5)
    v_mfma_f32_16x16x32_bf16 v[64:67], v[220:223], v[128:131], v[64:67]
    s_waitcnt vmcnt(4)
    ds_read_b64_tr_b16 v[216:217], v224 offset:0
    ds_read_b64_tr_b16 v[218:219], v224 offset:3584
    v_mfma_f32_16x16x32_bf16 v[68:71], v[220:223], v[132:135], v[68:71]
    s_add_u32 m0, s61, 4096
    ds_read_b128 v[116:119], v230 offset:13312
    v_mfma_f32_16x16x32_bf16 v[72:75], v[220:223], v[136:139], v[72:75]
    buffer_load_dwordx4 v236, s[48:51], s65 offen lds
    v_mfma_f32_16x16x32_bf16 v[76:79], v[220:223], v[140:143], v[76:79]
    s_waitcnt lgkmcnt(6)
    v_mfma_f32_16x16x32_bf16 v[80:83], v[208:211], v[128:131], v[80:83]
    ds_read_b64_tr_b16 v[220:221], v224 offset:32
    ds_read_b64_tr_b16 v[222:223], v224 offset:3616
    v_mfma_f32_16x16x32_bf16 v[84:87], v[208:211], v[132:135], v[84:87]
    s_add_u32 m0, s61, 5120
    ds_read_b128 v[120:123], v231 offset:12288
    v_mfma_f32_16x16x32_bf16 v[88:91], v[208:211], v[136:139], v[88:91]
    buffer_load_dwordx4 v237, s[48:51], s65 offen lds
    v_mfma_f32_16x16x32_bf16 v[92:95], v[208:211], v[140:143], v[92:95]
    s_waitcnt lgkmcnt(7)
    v_mfma_f32_16x16x32_bf16 v[96:99], v[212:215], v[128:131], v[96:99]
    ds_read_b64_tr_b16 v[208:209], v224 offset:64
    ds_read_b64_tr_b16 v[210:211], v224 offset:3648
    v_mfma_f32_16x16x32_bf16 v[100:103], v[212:215], v[132:135], v[100:103]
    s_add_u32 m0, s61, 6144
    ds_read_b128 v[124:127], v231 offset:13312
    v_mfma_f32_16x16x32_bf16 v[104:107], v[212:215], v[136:139], v[104:107]
    buffer_load_dwordx4 v238, s[48:51], s65 offen lds
    v_mfma_f32_16x16x32_bf16 v[108:111], v[212:215], v[140:143], v[108:111]
    s_waitcnt lgkmcnt(7)
    s_add_u32 s65, s65, 28672
    v_mfma_f32_16x16x32_bf16 v[0:3], v[216:219], v[112:115], v[0:3]
    s_waitcnt lgkmcnt(6)
    ds_read_b64_tr_b16 v[212:213], v224 offset:96
    ds_read_b64_tr_b16 v[214:215], v224 offset:3680
    v_mfma_f32_16x16x32_bf16 v[4:7], v[216:219], v[116:119], v[4:7]
    s_waitcnt lgkmcnt(5)
    s_add_u32 m0, s62, 0
    v_mfma_f32_16x16x32_bf16 v[8:11], v[216:219], v[120:123], v[8:11]
    s_waitcnt lgkmcnt(2)
    buffer_load_dwordx4 v232, s[48:51], s65 offen lds
    v_mfma_f32_16x16x32_bf16 v[12:15], v[216:219], v[124:127], v[12:15]
    v_mfma_f32_16x16x32_bf16 v[16:19], v[220:223], v[112:115], v[16:19]
    ds_read_b64_tr_b16 v[216:217], v224 offset:128
    ds_read_b64_tr_b16 v[218:219], v224 offset:3712
    v_mfma_f32_16x16x32_bf16 v[20:23], v[220:223], v[116:119], v[20:23]
    s_add_u32 m0, s62, 1024
    v_mfma_f32_16x16x32_bf16 v[24:27], v[220:223], v[120:123], v[24:27]
    buffer_load_dwordx4 v233, s[48:51], s65 offen lds
    v_mfma_f32_16x16x32_bf16 v[28:31], v[220:223], v[124:127], v[28:31]
    v_mfma_f32_16x16x32_bf16 v[32:35], v[208:211], v[112:115], v[32:35]
    ds_read_b64_tr_b16 v[220:221], v224 offset:160
    ds_read_b64_tr_b16 v[222:223], v224 offset:3744
    v_mfma_f32_16x16x32_bf16 v[36:39], v[208:211], v[116:119], v[36:39]
    s_add_u32 m0, s62, 2048
    v_mfma_f32_16x16x32_bf16 v[40:43], v[208:211], v[120:123], v[40:43]
    buffer_load_dwordx4 v234, s[48:51], s65 offen lds
    v_mfma_f32_16x16x32_bf16 v[44:47], v[208:211], v[124:127], v[44:47]
    s_waitcnt lgkmcnt(4)
    v_mfma_f32_16x16x32_bf16 v[48:51], v[212:215], v[112:115], v[48:51]
    ds_read_b64_tr_b16 v[208:209], v224 offset:192
    ds_read_b64_tr_b16 v[210:211], v224 offset:3776
    v_mfma_f32_16x16x32_bf16 v[52:55], v[212:215], v[116:119], v[52:55]
    s_add_u32 m0, s62, 3072
    ds_read_b128 v[128:131], v230 offset:14336
    v_mfma_f32_16x16x32_bf16 v[56:59], v[212:215], v[120:123], v[56:59]
    buffer_load_dwordx4 v235, s[48:51], s65 offen lds
    v_mfma_f32_16x16x32_bf16 v[60:63], v[212:215], v[124:127], v[60:63]
    s_waitcnt lgkmcnt(5)
    v_mfma_f32_16x16x32_bf16 v[64:67], v[216:219], v[112:115], v[64:67]
    s_waitcnt vmcnt(4)
    ds_read_b64_tr_b16 v[212:213], v225 offset:0
    ds_read_b64_tr_b16 v[214:215], v225 offset:3584
    v_mfma_f32_16x16x32_bf16 v[68:71], v[216:219], v[116:119], v[68:71]
    s_add_u32 m0, s62, 4096
    ds_read_b128 v[132:135], v230 offset:15360
    v_mfma_f32_16x16x32_bf16 v[72:75], v[216:219], v[120:123], v[72:75]
    buffer_load_dwordx4 v236, s[48:51], s65 offen lds
    v_mfma_f32_16x16x32_bf16 v[76:79], v[216:219], v[124:127], v[76:79]
    s_waitcnt lgkmcnt(6)
    v_mfma_f32_16x16x32_bf16 v[80:83], v[220:223], v[112:115], v[80:83]
    ds_read_b64_tr_b16 v[216:217], v225 offset:32
    ds_read_b64_tr_b16 v[218:219], v225 offset:3616
    v_mfma_f32_16x16x32_bf16 v[84:87], v[220:223], v[116:119], v[84:87]
    s_add_u32 m0, s62, 5120
    ds_read_b128 v[136:139], v231 offset:14336
    v_mfma_f32_16x16x32_bf16 v[88:91], v[220:223], v[120:123], v[88:91]
    buffer_load_dwordx4 v237, s[48:51], s65 offen lds
    v_mfma_f32_16x16x32_bf16 v[92:95], v[220:223], v[124:127], v[92:95]
    s_waitcnt lgkmcnt(7)
    v_mfma_f32_16x16x32_bf16 v[96:99], v[208:211], v[112:115], v[96:99]
    ds_read_b64_tr_b16 v[220:221], v225 offset:64
    ds_read_b64_tr_b16 v[222:223], v225 offset:3648
    v_mfma_f32_16x16x32_bf16 v[100:103], v[208:211], v[116:119], v[100:103]
    s_add_u32 m0, s62, 6144
    ds_read_b128 v[140:143], v231 offset:15360
    v_mfma_f32_16x16x32_bf16 v[104:107], v[208:211], v[120:123], v[104:107]
    buffer_load_dwordx4 v238, s[48:51], s65 offen lds
    v_mfma_f32_16x16x32_bf16 v[108:111], v[208:211], v[124:127], v[108:111]
    s_waitcnt lgkmcnt(7)
    s_add_u32 s65, s65, 28672
    v_mfma_f32_16x16x32_bf16 v[0:3], v[212:215], v[128:131], v[0:3]
    s_waitcnt lgkmcnt(6)
    ds_read_b64_tr_b16 v[208:209], v225 offset:96
    ds_read_b64_tr_b16 v[210:211], v225 offset:3680
    v_mfma_f32_16x16x32_bf16 v[4:7], v[212:215], v[132:135], v[4:7]
    s_waitcnt lgkmcnt(5)
    s_add_u32 m0, s60, 0
    v_mfma_f32_16x16x32_bf16 v[8:11], v[212:215], v[136:139], v[8:11]
    s_waitcnt lgkmcnt(2)
    buffer_load_dwordx4 v232, s[48:51], s65 offen lds
    v_mfma_f32_16x16x32_bf16 v[12:15], v[212:215], v[140:143], v[12:15]
    v_mfma_f32_16x16x32_bf16 v[16:19], v[216:219], v[128:131], v[16:19]
    ds_read_b64_tr_b16 v[212:213], v225 offset:128
    ds_read_b64_tr_b16 v[214:215], v225 offset:3712
    v_mfma_f32_16x16x32_bf16 v[20:23], v[216:219], v[132:135], v[20:23]
    s_add_u32 m0, s60, 1024
    v_mfma_f32_16x16x32_bf16 v[24:27], v[216:219], v[136:139], v[24:27]
    buffer_load_dwordx4 v233, s[48:51], s65 offen lds
    v_mfma_f32_16x16x32_bf16 v[28:31], v[216:219], v[140:143], v[28:31]
    v_mfma_f32_16x16x32_bf16 v[32:35], v[220:223], v[128:131], v[32:35]
    ds_read_b64_tr_b16 v[216:217], v225 offset:160
    ds_read_b64_tr_b16 v[218:219], v225 offset:3744
    v_mfma_f32_16x16x32_bf16 v[36:39], v[220:223], v[132:135], v[36:39]
    s_add_u32 m0, s60, 2048
    v_mfma_f32_16x16x32_bf16 v[40:43], v[220:223], v[136:139], v[40:43]
    buffer_load_dwordx4 v234, s[48:51], s65 offen lds
    v_mfma_f32_16x16x32_bf16 v[44:47], v[220:223], v[140:143], v[44:47]
    s_waitcnt lgkmcnt(4)
    v_mfma_f32_16x16x32_bf16 v[48:51], v[208:211], v[128:131], v[48:51]
    ds_read_b64_tr_b16 v[220:221], v225 offset:192
    ds_read_b64_tr_b16 v[222:223], v225 offset:3776
    v_mfma_f32_16x16x32_bf16 v[52:55], v[208:211], v[132:135], v[52:55]
    s_add_u32 m0, s60, 3072
    ds_read_b128 v[112:115], v228 offset:0
    v_mfma_f32_16x16x32_bf16 v[56:59], v[208:211], v[136:139], v[56:59]
    buffer_load_dwordx4 v235, s[48:51], s65 offen lds
    v_mfma_f32_16x16x32_bf16 v[60:63], v[208:211], v[140:143], v[60:63]
    s_waitcnt lgkmcnt(5)
    v_mfma_f32_16x16x32_bf16 v[64:67], v[212:215], v[128:131], v[64:67]
    s_waitcnt vmcnt(4)
    ds_read_b64_tr_b16 v[208:209], v226 offset:0
    ds_read_b64_tr_b16 v[210:211], v226 offset:3584
    v_mfma_f32_16x16x32_bf16 v[68:71], v[212:215], v[132:135], v[68:71]
    s_add_u32 m0, s60, 4096
    ds_read_b128 v[116:119], v228 offset:1024
    v_mfma_f32_16x16x32_bf16 v[72:75], v[212:215], v[136:139], v[72:75]
    buffer_load_dwordx4 v236, s[48:51], s65 offen lds
    v_mfma_f32_16x16x32_bf16 v[76:79], v[212:215], v[140:143], v[76:79]
    s_waitcnt lgkmcnt(6)
    v_mfma_f32_16x16x32_bf16 v[80:83], v[216:219], v[128:131], v[80:83]
    ds_read_b64_tr_b16 v[212:213], v226 offset:32
    ds_read_b64_tr_b16 v[214:215], v226 offset:3616
    v_mfma_f32_16x16x32_bf16 v[84:87], v[216:219], v[132:135], v[84:87]
    s_add_u32 m0, s60, 5120
    ds_read_b128 v[120:123], v229 offset:0
    v_mfma_f32_16x16x32_bf16 v[88:91], v[216:219], v[136:139], v[88:91]
    buffer_load_dwordx4 v237, s[48:51], s65 offen lds
    v_mfma_f32_16x16x32_bf16 v[92:95], v[216:219], v[140:143], v[92:95]
    s_waitcnt lgkmcnt(7)
    v_mfma_f32_16x16x32_bf16 v[96:99], v[220:223], v[128:131], v[96:99]
    ds_read_b64_tr_b16 v[216:217], v226 offset:64
    ds_read_b64_tr_b16 v[218:219], v226 offset:3648
    v_mfma_f32_16x16x32_bf16 v[100:103], v[220:223], v[132:135], v[100:103]
    s_add_u32 m0, s60, 6144
    ds_read_b128 v[124:127], v229 offset:1024
    v_mfma_f32_16x16x32_bf16 v[104:107], v[220:223], v[136:139], v[104:107]
    buffer_load_dwordx4 v238, s[48:51], s65 offen lds
    v_mfma_f32_16x16x32_bf16 v[108:111], v[220:223], v[140:143], v[108:111]
    s_waitcnt lgkmcnt(7)
    s_add_u32 s65, s65, 28672
    v_mfma_f32_16x16x32_bf16 v[0:3], v[208:211], v[112:115], v[0:3]
    s_waitcnt lgkmcnt(6)
    ds_read_b64_tr_b16 v[220:221], v226 offset:96
    ds_read_b64_tr_b16 v[222:223], v226 offset:3680
    v_mfma_f32_16x16x32_bf16 v[4:7], v[208:211], v[116:119], v[4:7]
    s_waitcnt lgkmcnt(5)
    s_add_u32 m0, s61, 0
    v_mfma_f32_16x16x32_bf16 v[8:11], v[208:211], v[120:123], v[8:11]
    s_waitcnt lgkmcnt(2)
    buffer_load_dwordx4 v232, s[48:51], s65 offen lds
    v_mfma_f32_16x16x32_bf16 v[12:15], v[208:211], v[124:127], v[12:15]
    v_mfma_f32_16x16x32_bf16 v[16:19], v[212:215], v[112:115], v[16:19]
    ds_read_b64_tr_b16 v[208:209], v226 offset:128
    ds_read_b64_tr_b16 v[210:211], v226 offset:3712
    v_mfma_f32_16x16x32_bf16 v[20:23], v[212:215], v[116:119], v[20:23]
    s_add_u32 m0, s61, 1024
    v_mfma_f32_16x16x32_bf16 v[24:27], v[212:215], v[120:123], v[24:27]
    buffer_load_dwordx4 v233, s[48:51], s65 offen lds
    v_mfma_f32_16x16x32_bf16 v[28:31], v[212:215], v[124:127], v[28:31]
    v_mfma_f32_16x16x32_bf16 v[32:35], v[216:219], v[112:115], v[32:35]
    ds_read_b64_tr_b16 v[212:213], v226 offset:160
    ds_read_b64_tr_b16 v[214:215], v226 offset:3744
    v_mfma_f32_16x16x32_bf16 v[36:39], v[216:219], v[116:119], v[36:39]
    s_add_u32 m0, s61, 2048
    v_mfma_f32_16x16x32_bf16 v[40:43], v[216:219], v[120:123], v[40:43]
    buffer_load_dwordx4 v234, s[48:51], s65 offen lds
    v_mfma_f32_16x16x32_bf16 v[44:47], v[216:219], v[124:127], v[44:47]
    s_waitcnt lgkmcnt(4)
    v_mfma_f32_16x16x32_bf16 v[48:51], v[220:223], v[112:115], v[48:51]
    ds_read_b64_tr_b16 v[216:217], v226 offset:192
    ds_read_b64_tr_b16 v[218:219], v226 offset:3776
    v_mfma_f32_16x16x32_bf16 v[52:55], v[220:223], v[116:119], v[52:55]
    s_add_u32 m0, s61, 3072
    ds_read_b128 v[128:131], v228 offset:2048
    v_mfma_f32_16x16x32_bf16 v[56:59], v[220:223], v[120:123], v[56:59]
    buffer_load_dwordx4 v235, s[48:51], s65 offen lds
    v_mfma_f32_16x16x32_bf16 v[60:63], v[220:223], v[124:127], v[60:63]
    s_waitcnt lgkmcnt(5)
    v_mfma_f32_16x16x32_bf16 v[64:67], v[208:211], v[112:115], v[64:67]
    s_waitcnt vmcnt(4)
    ds_read_b64_tr_b16 v[220:221], v224 offset:0
    ds_read_b64_tr_b16 v[222:223], v224 offset:3584
    v_mfma_f32_16x16x32_bf16 v[68:71], v[208:211], v[116:119], v[68:71]
    s_add_u32 m0, s61, 4096
    ds_read_b128 v[132:135], v228 offset:3072
    v_mfma_f32_16x16x32_bf16 v[72:75], v[208:211], v[120:123], v[72:75]
    buffer_load_dwordx4 v236, s[48:51], s65 offen lds
    v_mfma_f32_16x16x32_bf16 v[76:79], v[208:211], v[124:127], v[76:79]
    s_waitcnt lgkmcnt(6)
    v_mfma_f32_16x16x32_bf16 v[80:83], v[212:215], v[112:115], v[80:83]
    ds_read_b64_tr_b16 v[208:209], v224 offset:32
    ds_read_b64_tr_b16 v[210:211], v224 offset:3616
    v_mfma_f32_16x16x32_bf16 v[84:87], v[212:215], v[116:119], v[84:87]
    s_add_u32 m0, s61, 5120
    ds_read_b128 v[136:139], v229 offset:2048
    v_mfma_f32_16x16x32_bf16 v[88:91], v[212:215], v[120:123], v[88:91]
    buffer_load_dwordx4 v237, s[48:51], s65 offen lds
    v_mfma_f32_16x16x32_bf16 v[92:95], v[212:215], v[124:127], v[92:95]
    s_waitcnt lgkmcnt(7)
    v_mfma_f32_16x16x32_bf16 v[96:99], v[216:219], v[112:115], v[96:99]
    ds_read_b64_tr_b16 v[212:213], v224 offset:64
    ds_read_b64_tr_b16 v[214:215], v224 offset:3648
    v_mfma_f32_16x16x32_bf16 v[100:103], v[216:219], v[116:119], v[100:103]
    s_add_u32 m0, s61, 6144
    ds_read_b128 v[140:143], v229 offset:3072
    v_mfma_f32_16x16x32_bf16 v[104:107], v[216:219], v[120:123], v[104:107]
    buffer_load_dwordx4 v238, s[48:51], s65 offen lds
    v_mfma_f32_16x16x32_bf16 v[108:111], v[216:219], v[124:127], v[108:111]
    s_waitcnt lgkmcnt(7)
    s_add_u32 s65, s65, 28672
    v_mfma_f32_16x16x32_bf16 v[0:3], v[220:223], v[128:131], v[0:3]
    s_waitcnt lgkmcnt(6)
    ds_read_b64_tr_b16 v[216:217], v224 offset:96
    ds_read_b64_tr_b16 v[218:219], v224 offset:3680
    v_mfma_f32_16x16x32_bf16 v[4:7], v[220:223], v[132:135], v[4:7]
    s_waitcnt lgkmcnt(5)
    s_add_u32 m0, s62, 0
    v_mfma_f32_16x16x32_bf16 v[8:11], v[220:223], v[136:139], v[8:11]
    s_waitcnt lgkmcnt(2)
    buffer_load_dwordx4 v232, s[48:51], s65 offen lds
    v_mfma_f32_16x16x32_bf16 v[12:15], v[220:223], v[140:143], v[12:15]
    v_mfma_f32_16x16x32_bf16 v[16:19], v[208:211], v[128:131], v[16:19]
    ds_read_b64_tr_b16 v[220:221], v224 offset:128
    ds_read_b64_tr_b16 v[222:223], v224 offset:3712
    v_mfma_f32_16x16x32_bf16 v[20:23], v[208:211], v[132:135], v[20:23]
    s_add_u32 m0, s62, 1024
    v_mfma_f32_16x16x32_bf16 v[24:27], v[208:211], v[136:139], v[24:27]
    buffer_load_dwordx4 v233, s[48:51], s65 offen lds
    v_mfma_f32_16x16x32_bf16 v[28:31], v[208:211], v[140:143], v[28:31]
    v_mfma_f32_16x16x32_bf16 v[32:35], v[212:215], v[128:131], v[32:35]
    ds_read_b64_tr_b16 v[208:209], v224 offset:160
    ds_read_b64_tr_b16 v[210:211], v224 offset:3744
    v_mfma_f32_16x16x32_bf16 v[36:39], v[212:215], v[132:135], v[36:39]
    s_add_u32 m0, s62, 2048
    v_mfma_f32_16x16x32_bf16 v[40:43], v[212:215], v[136:139], v[40:43]
    buffer_load_dwordx4 v234, s[48:51], s65 offen lds
    v_mfma_f32_16x16x32_bf16 v[44:47], v[212:215], v[140:143], v[44:47]
    s_waitcnt lgkmcnt(4)
    v_mfma_f32_16x16x32_bf16 v[48:51], v[216:219], v[128:131], v[48:51]
    ds_read_b64_tr_b16 v[212:213], v224 offset:192
    ds_read_b64_tr_b16 v[214:215], v224 offset:3776
    v_mfma_f32_16x16x32_bf16 v[52:55], v[216:219], v[132:135], v[52:55]
    s_add_u32 m0, s62, 3072
    ds_read_b128 v[112:115], v228 offset:4096
    v_mfma_f32_16x16x32_bf16 v[56:59], v[216:219], v[136:139], v[56:59]
    buffer_load_dwordx4 v235, s[48:51], s65 offen lds
    v_mfma_f32_16x16x32_bf16 v[60:63], v[216:219], v[140:143], v[60:63]
    s_waitcnt lgkmcnt(5)
    v_mfma_f32_16x16x32_bf16 v[64:67], v[220:223], v[128:131], v[64:67]
    s_waitcnt vmcnt(4)
    ds_read_b64_tr_b16 v[216:217], v225 offset:0
    ds_read_b64_tr_b16 v[218:219], v225 offset:3584
    v_mfma_f32_16x16x32_bf16 v[68:71], v[220:223], v[132:135], v[68:71]
    s_add_u32 m0, s62, 4096
    ds_read_b128 v[116:119], v228 offset:5120
    v_mfma_f32_16x16x32_bf16 v[72:75], v[220:223], v[136:139], v[72:75]
    buffer_load_dwordx4 v236, s[48:51], s65 offen lds
    v_mfma_f32_16x16x32_bf16 v[76:79], v[220:223], v[140:143], v[76:79]
    s_waitcnt lgkmcnt(6)
    v_mfma_f32_16x16x32_bf16 v[80:83], v[208:211], v[128:131], v[80:83]
    ds_read_b64_tr_b16 v[220:221], v225 offset:32
    ds_read_b64_tr_b16 v[222:223], v225 offset:3616
    v_mfma_f32_16x16x32_bf16 v[84:87], v[208:211], v[132:135], v[84:87]
    s_add_u32 m0, s62, 5120
    ds_read_b128 v[120:123], v229 offset:4096
    v_mfma_f32_16x16x32_bf16 v[88:91], v[208:211], v[136:139], v[88:91]
    buffer_load_dwordx4 v237, s[48:51], s65 offen lds
    v_mfma_f32_16x16x32_bf16 v[92:95], v[208:211], v[140:143], v[92:95]
    s_waitcnt lgkmcnt(7)
    v_mfma_f32_16x16x32_bf16 v[96:99], v[212:215], v[128:131], v[96:99]
    ds_read_b64_tr_b16 v[208:209], v225 offset:64
    ds_read_b64_tr_b16 v[210:211], v225 offset:3648
    v_mfma_f32_16x16x32_bf16 v[100:103], v[212:215], v[132:135], v[100:103]
    s_add_u32 m0, s62, 6144
    ds_read_b128 v[124:127], v229 offset:5120
    v_mfma_f32_16x16x32_bf16 v[104:107], v[212:215], v[136:139], v[104:107]
    buffer_load_dwordx4 v238, s[48:51], s65 offen lds
    v_mfma_f32_16x16x32_bf16 v[108:111], v[212:215], v[140:143], v[108:111]
    s_waitcnt lgkmcnt(7)
    s_add_u32 s65, s65, 28672
    v_mfma_f32_16x16x32_bf16 v[0:3], v[216:219], v[112:115], v[0:3]
    s_waitcnt lgkmcnt(6)
    ds_read_b64_tr_b16 v[212:213], v225 offset:96
    ds_read_b64_tr_b16 v[214:215], v225 offset:3680
    v_mfma_f32_16x16x32_bf16 v[4:7], v[216:219], v[116:119], v[4:7]
    s_waitcnt lgkmcnt(5)
    s_add_u32 m0, s60, 0
    v_mfma_f32_16x16x32_bf16 v[8:11], v[216:219], v[120:123], v[8:11]
    s_waitcnt lgkmcnt(2)
    buffer_load_dwordx4 v232, s[48:51], s65 offen lds
    v_mfma_f32_16x16x32_bf16 v[12:15], v[216:219], v[124:127], v[12:15]
    v_mfma_f32_16x16x32_bf16 v[16:19], v[220:223], v[112:115], v[16:19]
    ds_read_b64_tr_b16 v[216:217], v225 offset:128
    ds_read_b64_tr_b16 v[218:219], v225 offset:3712
    v_mfma_f32_16x16x32_bf16 v[20:23], v[220:223], v[116:119], v[20:23]
    s_add_u32 m0, s60, 1024
    v_mfma_f32_16x16x32_bf16 v[24:27], v[220:223], v[120:123], v[24:27]
    buffer_load_dwordx4 v233, s[48:51], s65 offen lds
    v_mfma_f32_16x16x32_bf16 v[28:31], v[220:223], v[124:127], v[28:31]
    v_mfma_f32_16x16x32_bf16 v[32:35], v[208:211], v[112:115], v[32:35]
    ds_read_b64_tr_b16 v[220:221], v225 offset:160
    ds_read_b64_tr_b16 v[222:223], v225 offset:3744
    v_mfma_f32_16x16x32_bf16 v[36:39], v[208:211], v[116:119], v[36:39]
    s_add_u32 m0, s60, 2048
    v_mfma_f32_16x16x32_bf16 v[40:43], v[208:211], v[120:123], v[40:43]
    buffer_load_dwordx4 v234, s[48:51], s65 offen lds
    v_mfma_f32_16x16x32_bf16 v[44:47], v[208:211], v[124:127], v[44:47]
    s_waitcnt lgkmcnt(4)
    v_mfma_f32_16x16x32_bf16 v[48:51], v[212:215], v[112:115], v[48:51]
    ds_read_b64_tr_b16 v[208:209], v225 offset:192
    ds_read_b64_tr_b16 v[210:211], v225 offset:3776
    v_mfma_f32_16x16x32_bf16 v[52:55], v[212:215], v[116:119], v[52:55]
    s_add_u32 m0, s60, 3072
    ds_read_b128 v[128:131], v228 offset:6144
    v_mfma_f32_16x16x32_bf16 v[56:59], v[212:215], v[120:123], v[56:59]
    buffer_load_dwordx4 v235, s[48:51], s65 offen lds
    v_mfma_f32_16x16x32_bf16 v[60:63], v[212:215], v[124:127], v[60:63]
    s_waitcnt lgkmcnt(5)
    v_mfma_f32_16x16x32_bf16 v[64:67], v[216:219], v[112:115], v[64:67]
    s_waitcnt vmcnt(4)
    ds_read_b64_tr_b16 v[212:213], v226 offset:0
    ds_read_b64_tr_b16 v[214:215], v226 offset:3584
    v_mfma_f32_16x16x32_bf16 v[68:71], v[216:219], v[116:119], v[68:71]
    s_add_u32 m0, s60, 4096
    ds_read_b128 v[132:135], v228 offset:7168
    v_mfma_f32_16x16x32_bf16 v[72:75], v[216:219], v[120:123], v[72:75]
    buffer_load_dwordx4 v236, s[48:51], s65 offen lds
    v_mfma_f32_16x16x32_bf16 v[76:79], v[216:219], v[124:127], v[76:79]
    s_waitcnt lgkmcnt(6)
    v_mfma_f32_16x16x32_bf16 v[80:83], v[220:223], v[112:115], v[80:83]
    ds_read_b64_tr_b16 v[216:217], v226 offset:32
    ds_read_b64_tr_b16 v[218:219], v226 offset:3616
    v_mfma_f32_16x16x32_bf16 v[84:87], v[220:223], v[116:119], v[84:87]
    s_add_u32 m0, s60, 5120
    ds_read_b128 v[136:139], v229 offset:6144
    v_mfma_f32_16x16x32_bf16 v[88:91], v[220:223], v[120:123], v[88:91]
    buffer_load_dwordx4 v237, s[48:51], s65 offen lds
    v_mfma_f32_16x16x32_bf16 v[92:95], v[220:223], v[124:127], v[92:95]
    s_waitcnt lgkmcnt(7)
    v_mfma_f32_16x16x32_bf16 v[96:99], v[208:211], v[112:115], v[96:99]
    ds_read_b64_tr_b16 v[220:221], v226 offset:64
    ds_read_b64_tr_b16 v[222:223], v226 offset:3648
    v_mfma_f32_16x16x32_bf16 v[100:103], v[208:211], v[116:119], v[100:103]
    s_add_u32 m0, s60, 6144
    ds_read_b128 v[140:143], v229 offset:7168
    v_mfma_f32_16x16x32_bf16 v[104:107], v[208:211], v[120:123], v[104:107]
    buffer_load_dwordx4 v238, s[48:51], s65 offen lds
    v_mfma_f32_16x16x32_bf16 v[108:111], v[208:211], v[124:127], v[108:111]
    s_waitcnt lgkmcnt(7)
    s_add_u32 s65, s65, 28672
    v_mfma_f32_16x16x32_bf16 v[0:3], v[212:215], v[128:131], v[0:3]
    s_waitcnt lgkmcnt(6)
    ds_read_b64_tr_b16 v[208:209], v226 offset:96
    ds_read_b64_tr_b16 v[210:211], v226 offset:3680
    v_mfma_f32_16x16x32_bf16 v[4:7], v[212:215], v[132:135], v[4:7]
    s_waitcnt lgkmcnt(5)
    s_add_u32 m0, s61, 0
    v_mfma_f32_16x16x32_bf16 v[8:11], v[212:215], v[136:139], v[8:11]
    s_waitcnt lgkmcnt(2)
    buffer_load_dwordx4 v232, s[48:51], s65 offen lds
    v_mfma_f32_16x16x32_bf16 v[12:15], v[212:215], v[140:143], v[12:15]
    v_mfma_f32_16x16x32_bf16 v[16:19], v[216:219], v[128:131], v[16:19]
    ds_read_b64_tr_b16 v[212:213], v226 offset:128
    ds_read_b64_tr_b16 v[214:215], v226 offset:3712
    v_mfma_f32_16x16x32_bf16 v[20:23], v[216:219], v[132:135], v[20:23]
    s_add_u32 m0, s61, 1024
    v_mfma_f32_16x16x32_bf16 v[24:27], v[216:219], v[136:139], v[24:27]
    buffer_load_dwordx4 v233, s[48:51], s65 offen lds
    v_mfma_f32_16x16x32_bf16 v[28:31], v[216:219], v[140:143], v[28:31]
    v_mfma_f32_16x16x32_bf16 v[32:35], v[220:223], v[128:131], v[32:35]
    ds_read_b64_tr_b16 v[216:217], v226 offset:160
    ds_read_b64_tr_b16 v[218:219], v226 offset:3744
    v_mfma_f32_16x16x32_bf16 v[36:39], v[220:223], v[132:135], v[36:39]
    s_add_u32 m0, s61, 2048
    v_mfma_f32_16x16x32_bf16 v[40:43], v[220:223], v[136:139], v[40:43]
    buffer_load_dwordx4 v234, s[48:51], s65 offen lds
    v_mfma_f32_16x16x32_bf16 v[44:47], v[220:223], v[140:143], v[44:47]
    s_waitcnt lgkmcnt(4)
    v_mfma_f32_16x16x32_bf16 v[48:51], v[208:211], v[128:131], v[48:51]
    ds_read_b64_tr_b16 v[220:221], v226 offset:192
    ds_read_b64_tr_b16 v[222:223], v226 offset:3776
    v_mfma_f32_16x16x32_bf16 v[52:55], v[208:211], v[132:135], v[52:55]
    s_add_u32 m0, s61, 3072
    ds_read_b128 v[112:115], v228 offset:8192
    v_mfma_f32_16x16x32_bf16 v[56:59], v[208:211], v[136:139], v[56:59]
    buffer_load_dwordx4 v235, s[48:51], s65 offen lds
    v_mfma_f32_16x16x32_bf16 v[60:63], v[208:211], v[140:143], v[60:63]
    s_waitcnt lgkmcnt(5)
    v_mfma_f32_16x16x32_bf16 v[64:67], v[212:215], v[128:131], v[64:67]
    s_waitcnt vmcnt(4)
    ds_read_b64_tr_b16 v[208:209], v224 offset:0
    ds_read_b64_tr_b16 v[210:211], v224 offset:3584
    v_mfma_f32_16x16x32_bf16 v[68:71], v[212:215], v[132:135], v[68:71]
    s_add_u32 m0, s61, 4096
    ds_read_b128 v[116:119], v228 offset:9216
    v_mfma_f32_16x16x32_bf16 v[72:75], v[212:215], v[136:139], v[72:75]
    buffer_load_dwordx4 v236, s[48:51], s65 offen lds
    v_mfma_f32_16x16x32_bf16 v[76:79], v[212:215], v[140:143], v[76:79]
    s_waitcnt lgkmcnt(6)
    v_mfma_f32_16x16x32_bf16 v[80:83], v[216:219], v[128:131], v[80:83]
    ds_read_b64_tr_b16 v[212:213], v224 offset:32
    ds_read_b64_tr_b16 v[214:215], v224 offset:3616
    v_mfma_f32_16x16x32_bf16 v[84:87], v[216:219], v[132:135], v[84:87]
    s_add_u32 m0, s61, 5120
    ds_read_b128 v[120:123], v229 offset:8192
    v_mfma_f32_16x16x32_bf16 v[88:91], v[216:219], v[136:139], v[88:91]
    buffer_load_dwordx4 v237, s[48:51], s65 offen lds
    v_mfma_f32_16x16x32_bf16 v[92:95], v[216:219], v[140:143], v[92:95]
    s_waitcnt lgkmcnt(7)
    v_mfma_f32_16x16x32_bf16 v[96:99], v[220:223], v[128:131], v[96:99]
    ds_read_b64_tr_b16 v[216:217], v224 offset:64
    ds_read_b64_tr_b16 v[218:219], v224 offset:3648
    v_mfma_f32_16x16x32_bf16 v[100:103], v[220:223], v[132:135], v[100:103]
    s_add_u32 m0, s61, 6144
    ds_read_b128 v[124:127], v229 offset:9216
    v_mfma_f32_16x16x32_bf16 v[104:107], v[220:223], v[136:139], v[104:107]
    buffer_load_dwordx4 v238, s[48:51], s65 offen lds
    v_mfma_f32_16x16x32_bf16 v[108:111], v[220:223], v[140:143], v[108:111]
    s_waitcnt lgkmcnt(7)
    s_add_u32 s65, s65, 28672
    v_mfma_f32_16x16x32_bf16 v[0:3], v[208:211], v[112:115], v[0:3]
    s_waitcnt lgkmcnt(6)
    ds_read_b64_tr_b16 v[220:221], v224 offset:96
    ds_read_b64_tr_b16 v[222:223], v224 offset:3680
    v_mfma_f32_16x16x32_bf16 v[4:7], v[208:211], v[116:119], v[4:7]
    s_waitcnt lgkmcnt(5)
    s_add_u32 m0, s62, 0
    s_lshl_b32 s56, s37, 6
    s_lshl_b32 s57, s36, 3
    v_mfma_f32_16x16x32_bf16 v[8:11], v[208:211], v[120:123], v[8:11]
    s_waitcnt lgkmcnt(2)
    s_add_u32 s56, s56, s57
    s_lshl_b32 s58, s34, 1
    s_add_u32 s56, s56, s58
    buffer_load_dwordx4 v232, s[48:51], s65 offen lds
    v_mfma_f32_16x16x32_bf16 v[12:15], v[208:211], v[124:127], v[12:15]
    s_add_u32 s57, s57, s58
    s_mul_i32 s57, s57, 896
    s_mul_i32 s58, s56, 896
    v_mfma_f32_16x16x32_bf16 v[16:19], v[212:215], v[112:115], v[16:19]
    s_add_u32 s8, s24, 4194304
    s_addc_u32 s9, s25, 0
    s_mov_b32 s10, 14680064
    ds_read_b64_tr_b16 v[208:209], v224 offset:128
    ds_read_b64_tr_b16 v[210:211], v224 offset:3712
    v_mfma_f32_16x16x32_bf16 v[20:23], v[212:215], v[116:119], v[20:23]
    s_add_u32 m0, s62, 1024
    s_mov_b32 s11, 0x20000
    s_mov_b32 s12, s4
    v_mfma_f32_16x16x32_bf16 v[24:27], v[212:215], v[120:123], v[24:27]
    s_mov_b32 s13, s5
    s_mov_b32 s14, 896
    s_mov_b32 s15, 0x20000
    buffer_load_dwordx4 v233, s[48:51], s65 offen lds
    v_mfma_f32_16x16x32_bf16 v[28:31], v[212:215], v[124:127], v[28:31]
    s_mov_b32 s16, s6
    s_mov_b32 s17, s7
    s_mov_b32 s18, 1835008
    v_mfma_f32_16x16x32_bf16 v[32:35], v[216:219], v[112:115], v[32:35]
    s_mov_b32 s19, 0x20000
    s_add_u32 s20, s24, 1048576
    s_addc_u32 s21, s25, 0
    ds_read_b64_tr_b16 v[212:213], v224 offset:160
    ds_read_b64_tr_b16 v[214:215], v224 offset:3744
    v_mfma_f32_16x16x32_bf16 v[36:39], v[216:219], v[116:119], v[36:39]
    s_add_u32 m0, s62, 2048
    s_mov_b32 s22, 1835008
    s_mov_b32 s23, 0x20000
    v_mfma_f32_16x16x32_bf16 v[40:43], v[216:219], v[120:123], v[40:43]
    s_add_u32 s96, s24, 16384
    s_addc_u32 s97, s25, 0
    s_mov_b32 s98, 8192
    buffer_load_dwordx4 v234, s[48:51], s65 offen lds
    v_mfma_f32_16x16x32_bf16 v[44:47], v[216:219], v[124:127], v[44:47]
    s_waitcnt lgkmcnt(4)
    s_mov_b32 s99, 0x20000
    s_lshl_b32 s63, s37, 7
    s_add_u32 s63, s63, 131072
    v_mfma_f32_16x16x32_bf16 v[48:51], v[220:223], v[112:115], v[48:51]
    s_add_u32 s52, s24, s63
    s_addc_u32 s53, s25, 0
    s_mov_b32 s54, 128
    ds_read_b64_tr_b16 v[216:217], v224 offset:192
    ds_read_b64_tr_b16 v[218:219], v224 offset:3776
    v_mfma_f32_16x16x32_bf16 v[52:55], v[220:223], v[116:119], v[52:55]
    s_add_u32 m0, s62, 3072
    s_mov_b32 s55, 0x20000
    s_lshl_b32 s63, s36, 11
    ds_read_b128 v[128:131], v228 offset:10240
    v_mfma_f32_16x16x32_bf16 v[56:59], v[220:223], v[120:123], v[56:59]
    s_lshl_b32 s64, s37, 6
    s_add_u32 s63, s63, s64
    s_mul_i32 s63, s63, 896
    buffer_load_dwordx4 v235, s[48:51], s65 offen lds
    v_mfma_f32_16x16x32_bf16 v[60:63], v[220:223], v[124:127], v[60:63]
    s_waitcnt lgkmcnt(5)
    s_add_u32 s63, s63, 4194304
    s_add_u32 s68, s24, s63
    s_addc_u32 s69, s25, 0
    v_mfma_f32_16x16x32_bf16 v[64:67], v[208:211], v[112:115], v[64:67]
    s_waitcnt vmcnt(4)
    s_mov_b32 s70, 57344
    s_mov_b32 s71, 0x20000
    s_mul_i32 s63, s34, 224
    ds_read_b64_tr_b16 v[220:221], v225 offset:0
    ds_read_b64_tr_b16 v[222:223], v225 offset:3584
    v_mfma_f32_16x16x32_bf16 v[68:71], v[208:211], v[116:119], v[68:71]
    s_add_u32 m0, s62, 4096
    s_mul_i32 s64, s34, 14592
    s_mul_i32 s66, s34, 14336
    ds_read_b128 v[132:135], v228 offset:11264
    v_mfma_f32_16x16x32_bf16 v[72:75], v[208:211], v[120:123], v[72:75]
    s_lshl_b32 s67, s34, 10
    buffer_load_dwordx4 v236, s[48:51], s65 offen lds
    v_mfma_f32_16x16x32_bf16 v[76:79], v[208:211], v[124:127], v[76:79]
    s_waitcnt lgkmcnt(6)
    v_mfma_f32_16x16x32_bf16 v[80:83], v[212:215], v[112:115], v[80:83]
    ds_read_b64_tr_b16 v[208:209], v225 offset:32
    ds_read_b64_tr_b16 v[210:211], v225 offset:3616
    v_mfma_f32_16x16x32_bf16 v[84:87], v[212:215], v[116:119], v[84:87]
    s_add_u32 m0, s62, 5120
    ds_read_b128 v[136:139], v229 offset:10240
    v_mfma_f32_16x16x32_bf16 v[88:91], v[212:215], v[120:123], v[88:91]
    buffer_load_dwordx4 v237, s[48:51], s65 offen lds
    v_mfma_f32_16x16x32_bf16 v[92:95], v[212:215], v[124:127], v[92:95]
    s_waitcnt lgkmcnt(7)
    v_mfma_f32_16x16x32_bf16 v[96:99], v[216:219], v[112:115], v[96:99]
    ds_read_b64_tr_b16 v[212:213], v225 offset:64
    ds_read_b64_tr_b16 v[214:215], v225 offset:3648
    v_mfma_f32_16x16x32_bf16 v[100:103], v[216:219], v[116:119], v[100:103]
    s_add_u32 m0, s62, 6144
    ds_read_b128 v[140:143], v229 offset:11264
    v_mfma_f32_16x16x32_bf16 v[104:107], v[216:219], v[120:123], v[104:107]
    buffer_load_dwordx4 v238, s[48:51], s65 offen lds
    v_mfma_f32_16x16x32_bf16 v[108:111], v[216:219], v[124:127], v[108:111]
    s_waitcnt lgkmcnt(7)
    s_add_u32 s65, s65, 28672
    v_mfma_f32_16x16x32_bf16 v[0:3], v[220:223], v[128:131], v[0:3]
    s_waitcnt lgkmcnt(6)
    ds_read_b64_tr_b16 v[216:217], v225 offset:96
    ds_read_b64_tr_b16 v[218:219], v225 offset:3680
    v_mfma_f32_16x16x32_bf16 v[4:7], v[220:223], v[132:135], v[4:7]
    s_waitcnt lgkmcnt(5)
    s_add_u32 m0, s60, 0
    v_lshlrev_b32 v198, 4, v252
    v_lshlrev_b32 v199, 4, v252
    v_mfma_f32_16x16x32_bf16 v[8:11], v[220:223], v[136:139], v[8:11]
    s_waitcnt lgkmcnt(2)
    buffer_load_dwordx4 v232, s[48:51], s65 offen lds
    v_mfma_f32_16x16x32_bf16 v[12:15], v[220:223], v[140:143], v[12:15]
    v_mov_b32 v194, 0x40000000
    v_cmp_gt_u32 vcc, 56, v252
    v_mfma_f32_16x16x32_bf16 v[16:19], v[208:211], v[128:131], v[16:19]
    ds_read_b64_tr_b16 v[220:221], v225 offset:128
    ds_read_b64_tr_b16 v[222:223], v225 offset:3712
    v_mfma_f32_16x16x32_bf16 v[20:23], v[208:211], v[132:135], v[20:23]
    s_add_u32 m0, s60, 1024
    v_mov_b32 v196, 0x00003f80
    v_mov_b32 v197, 0x3f800000
    v_mfma_f32_16x16x32_bf16 v[24:27], v[208:211], v[136:139], v[24:27]
    buffer_load_dwordx4 v233, s[48:51], s65 offen lds
    v_mfma_f32_16x16x32_bf16 v[28:31], v[208:211], v[140:143], v[28:31]
    v_cndmask_b32 v198, v194, v198, vcc
    v_cndmask_b32 v193, 0, 1.0, vcc
    v_mfma_f32_16x16x32_bf16 v[32:35], v[212:215], v[128:131], v[32:35]
    ds_read_b64_tr_b16 v[208:209], v225 offset:160
    ds_read_b64_tr_b16 v[210:211], v225 offset:3744
    v_mfma_f32_16x16x32_bf16 v[36:39], v[212:215], v[132:135], v[36:39]
    s_add_u32 m0, s60, 2048
    v_add_u32 v192, s58, v198
    v_add_u32 v195, s57, v198
    v_mfma_f32_16x16x32_bf16 v[40:43], v[212:215], v[136:139], v[40:43]
    buffer_load_dwordx4 v234, s[48:51], s65 offen lds
    v_mfma_f32_16x16x32_bf16 v[44:47], v[212:215], v[140:143], v[44:47]
    s_waitcnt lgkmcnt(4)
    v_add_u32 v199, s67, v199
    v_add_u32 v205, 229376, v199
    v_mfma_f32_16x16x32_bf16 v[48:51], v[216:219], v[128:131], v[48:51]
    ds_read_b64_tr_b16 v[212:213], v225 offset:192
    ds_read_b64_tr_b16 v[214:215], v225 offset:3776
    v_mfma_f32_16x16x32_bf16 v[52:55], v[216:219], v[132:135], v[52:55]
    s_add_u32 m0, s60, 3072
    ds_read_b128 v[112:115], v228 offset:12288
    v_mfma_f32_16x16x32_bf16 v[56:59], v[216:219], v[136:139], v[56:59]
    buffer_load_dwordx4 v235, s[48:51], s65 offen lds
    v_mfma_f32_16x16x32_bf16 v[60:63], v[216:219], v[140:143], v[60:63]
    s_waitcnt lgkmcnt(5)
    v_and_b32 v200, 15, v252
    v_mul_u32_u24 v200, 912, v200
    v_mfma_f32_16x16x32_bf16 v[64:67], v[220:223], v[128:131], v[64:67]
    s_waitcnt vmcnt(4)
    ds_read_b64_tr_b16 v[216:217], v226 offset:0
    ds_read_b64_tr_b16 v[218:219], v226 offset:3584
    v_mfma_f32_16x16x32_bf16 v[68:71], v[220:223], v[132:135], v[68:71]
    s_add_u32 m0, s60, 4096
    ds_read_b128 v[116:119], v228 offset:13312
    v_mfma_f32_16x16x32_bf16 v[72:75], v[220:223], v[136:139], v[72:75]
    buffer_load_dwordx4 v236, s[48:51], s65 offen lds
    v_mfma_f32_16x16x32_bf16 v[76:79], v[220:223], v[140:143], v[76:79]
    s_waitcnt lgkmcnt(6)
    v_lshrrev_b32 v201, 4, v252
    v_lshl_add_u32 v200, v201, 3, v200
    v_mfma_f32_16x16x32_bf16 v[80:83], v[208:211], v[128:131], v[80:83]
    ds_read_b64_tr_b16 v[220:221], v226 offset:32
    ds_read_b64_tr_b16 v[222:223], v226 offset:3616
    v_mfma_f32_16x16x32_bf16 v[84:87], v[208:211], v[132:135], v[84:87]
    s_add_u32 m0, s60, 5120
    ds_read_b128 v[120:123], v229 offset:12288
    v_mfma_f32_16x16x32_bf16 v[88:91], v[208:211], v[136:139], v[88:91]
    buffer_load_dwordx4 v237, s[48:51], s65 offen lds
    v_mfma_f32_16x16x32_bf16 v[92:95], v[208:211], v[140:143], v[92:95]
    s_waitcnt lgkmcnt(7)
    v_add_u32 v200, s63, v200
    v_lshlrev_b32 v201, 4, v252
    v_mfma_f32_16x16x32_bf16 v[96:99], v[212:215], v[128:131], v[96:99]
    ds_read_b64_tr_b16 v[208:209], v226 offset:64
    ds_read_b64_tr_b16 v[210:211], v226 offset:3648
    v_mfma_f32_16x16x32_bf16 v[100:103], v[212:215], v[132:135], v[100:103]
    s_add_u32 m0, s60, 6144
    ds_read_b128 v[124:127], v229 offset:13312
    v_mfma_f32_16x16x32_bf16 v[104:107], v[212:215], v[136:139], v[104:107]
    buffer_load_dwordx4 v238, s[48:51], s65 offen lds
    v_mfma_f32_16x16x32_bf16 v[108:111], v[212:215], v[140:143], v[108:111]
    s_waitcnt lgkmcnt(7)
    s_add_u32 s65, s65, 28672
    v_add_u32 v202, s64, v201
    v_add_u32 v203, s66, v201
    v_mfma_f32_16x16x32_bf16 v[0:3], v[216:219], v[112:115], v[0:3]
    s_waitcnt lgkmcnt(6)
    ds_read_b64_tr_b16 v[212:213], v226 offset:96
    ds_read_b64_tr_b16 v[214:215], v226 offset:3680
    v_mfma_f32_16x16x32_bf16 v[4:7], v[216:219], v[116:119], v[4:7]
    s_waitcnt lgkmcnt(5)
    v_cndmask_b32 v203, v194, v203, vcc
    v_mfma_f32_16x16x32_bf16 v[8:11], v[216:219], v[120:123], v[8:11]
    s_waitcnt lgkmcnt(2)
    v_mfma_f32_16x16x32_bf16 v[12:15], v[216:219], v[124:127], v[12:15]
    v_mfma_f32_16x16x32_bf16 v[16:19], v[220:223], v[112:115], v[16:19]
    ds_read_b64_tr_b16 v[216:217], v226 offset:128
    ds_read_b64_tr_b16 v[218:219], v226 offset:3712
    v_mfma_f32_16x16x32_bf16 v[20:23], v[220:223], v[116:119], v[20:23]
    v_mfma_f32_16x16x32_bf16 v[24:27], v[220:223], v[120:123], v[24:27]
    v_mfma_f32_16x16x32_bf16 v[28:31], v[220:223], v[124:127], v[28:31]
    v_mfma_f32_16x16x32_bf16 v[32:35], v[208:211], v[112:115], v[32:35]
    ds_read_b64_tr_b16 v[220:221], v226 offset:160
    ds_read_b64_tr_b16 v[222:223], v226 offset:3744
    v_mfma_f32_16x16x32_bf16 v[36:39], v[208:211], v[116:119], v[36:39]
    v_mfma_f32_16x16x32_bf16 v[40:43], v[208:211], v[120:123], v[40:43]
    v_mfma_f32_16x16x32_bf16 v[44:47], v[208:211], v[124:127], v[44:47]
    s_waitcnt lgkmcnt(4)
    v_mfma_f32_16x16x32_bf16 v[48:51], v[212:215], v[112:115], v[48:51]
    ds_read_b64_tr_b16 v[208:209], v226 offset:192
    ds_read_b64_tr_b16 v[210:211], v226 offset:3776
    v_mfma_f32_16x16x32_bf16 v[52:55], v[212:215], v[116:119], v[52:55]
    ds_read_b128 v[128:131], v228 offset:14336
    v_mfma_f32_16x16x32_bf16 v[56:59], v[212:215], v[120:123], v[56:59]
    v_mfma_f32_16x16x32_bf16 v[60:63], v[212:215], v[124:127], v[60:63]
    s_waitcnt lgkmcnt(5)
    v_mfma_f32_16x16x32_bf16 v[64:67], v[216:219], v[112:115], v[64:67]
    s_waitcnt vmcnt(0)
    ds_read_b64_tr_b16 v[212:213], v224 offset:0
    ds_read_b64_tr_b16 v[214:215], v224 offset:3584
    v_mfma_f32_16x16x32_bf16 v[68:71], v[216:219], v[116:119], v[68:71]
    v_readfirstlane_b32 s59, v251
    s_cmp_eq_u32 s59, 112
    s_cbranch_scc0 L_a2rare
L_a2ok:
    ds_read_b128 v[132:135], v228 offset:15360
    v_mfma_f32_16x16x32_bf16 v[72:75], v[216:219], v[120:123], v[72:75]
    buffer_load_dwordx4 v[144:147], v195, s[40:43], 0 offen offset:0
    v_mfma_f32_16x16x32_bf16 v[76:79], v[216:219], v[124:127], v[76:79]
    s_waitcnt lgkmcnt(6)
    v_mfma_f32_16x16x32_bf16 v[80:83], v[220:223], v[112:115], v[80:83]
    ds_read_b64_tr_b16 v[216:217], v224 offset:32
    ds_read_b64_tr_b16 v[218:219], v224 offset:3616
    v_mfma_f32_16x16x32_bf16 v[84:87], v[220:223], v[116:119], v[84:87]
    ds_read_b128 v[136:139], v229 offset:14336
    v_mfma_f32_16x16x32_bf16 v[88:91], v[220:223], v[120:123], v[88:91]
    buffer_load_dwordx4 v[148:151], v195, s[40:43], 0 offen offset:896
    v_mfma_f32_16x16x32_bf16 v[92:95], v[220:223], v[124:127], v[92:95]
    s_waitcnt lgkmcnt(7)
    v_mfma_f32_16x16x32_bf16 v[96:99], v[208:211], v[112:115], v[96:99]
    ds_read_b64_tr_b16 v[220:221], v224 offset:64
    ds_read_b64_tr_b16 v[222:223], v224 offset:3648
    v_mfma_f32_16x16x32_bf16 v[100:103], v[208:211], v[116:119], v[100:103]
    ds_read_b128 v[140:143], v229 offset:15360
    v_mfma_f32_16x16x32_bf16 v[104:107], v[208:211], v[120:123], v[104:107]
    s_mov_b32 s59, 0
    buffer_load_dwordx4 v[160:163], v205, s[24:27], s59 offen sc1
    v_mfma_f32_16x16x32_bf16 v[108:111], v[208:211], v[124:127], v[108:111]
    s_waitcnt lgkmcnt(7)
    v_mfma_f32_16x16x32_bf16 v[0:3], v[212:215], v[128:131], v[0:3]
    s_waitcnt lgkmcnt(6)
    ds_read_b64_tr_b16 v[208:209], v224 offset:96
    ds_read_b64_tr_b16 v[210:211], v224 offset:3680
    v_mfma_f32_16x16x32_bf16 v[4:7], v[212:215], v[132:135], v[4:7]
    s_waitcnt lgkmcnt(5)
    s_mov_b32 s59, 4096
    buffer_load_dwordx4 v[164:167], v205, s[24:27], s59 offen sc1
    v_mfma_f32_16x16x32_bf16 v[8:11], v[212:215], v[136:139], v[8:11]
    s_waitcnt lgkmcnt(2)
    v_mfma_f32_16x16x32_bf16 v[12:15], v[212:215], v[140:143], v[12:15]
    s_mov_b32 s59, 7168
    buffer_load_dwordx4 v[168:171], v205, s[24:27], s59 offen sc1
    v_mfma_f32_16x16x32_bf16 v[16:19], v[216:219], v[128:131], v[16:19]
    ds_read_b64_tr_b16 v[212:213], v224 offset:128
    ds_read_b64_tr_b16 v[214:215], v224 offset:3712
    v_mfma_f32_16x16x32_bf16 v[20:23], v[216:219], v[132:135], v[20:23]
    s_mov_b32 s59, 11264
    buffer_load_dwordx4 v[172:175], v205, s[24:27], s59 offen sc1
    v_mfma_f32_16x16x32_bf16 v[24:27], v[216:219], v[136:139], v[24:27]
    v_mfma_f32_16x16x32_bf16 v[28:31], v[216:219], v[140:143], v[28:31]
    s_mov_b32 s59, 14336
    buffer_load_dwordx4 v[176:179], v205, s[24:27], s59 offen sc1
    v_mfma_f32_16x16x32_bf16 v[32:35], v[220:223], v[128:131], v[32:35]
    ds_read_b64_tr_b16 v[216:217], v224 offset:160
    ds_read_b64_tr_b16 v[218:219], v224 offset:3744
    v_mfma_f32_16x16x32_bf16 v[36:39], v[220:223], v[132:135], v[36:39]
    s_mov_b32 s59, 18432
    buffer_load_dwordx4 v[180:183], v205, s[24:27], s59 offen sc1
    v_mfma_f32_16x16x32_bf16 v[40:43], v[220:223], v[136:139], v[40:43]
    v_mfma_f32_16x16x32_bf16 v[44:47], v[220:223], v[140:143], v[44:47]
    s_waitcnt lgkmcnt(4)
    s_mov_b32 s59, 21504
    buffer_load_dwordx4 v[184:187], v205, s[24:27], s59 offen sc1
    v_mfma_f32_16x16x32_bf16 v[48:51], v[208:211], v[128:131], v[48:51]
    ds_read_b64_tr_b16 v[220:221], v224 offset:192
    ds_read_b64_tr_b16 v[222:223], v224 offset:3776
    v_mfma_f32_16x16x32_bf16 v[52:55], v[208:211], v[132:135], v[52:55]
    s_mov_b32 s59, 25600
    buffer_load_dwordx4 v[188:191], v205, s[24:27], s59 offen sc1
    v_mfma_f32_16x16x32_bf16 v[56:59], v[208:211], v[136:139], v[56:59]
    v_mfma_f32_16x16x32_bf16 v[60:63], v[208:211], v[140:143], v[60:63]
    s_waitcnt lgkmcnt(4)
    buffer_load_dwordx4 v[152:155], v198, s[12:15], 0 offen
    v_mfma_f32_16x16x32_bf16 v[64:67], v[212:215], v[128:131], v[64:67]
    v_mfma_f32_16x16x32_bf16 v[68:71], v[212:215], v[132:135], v[68:71]
    v_mfma_f32_16x16x32_bf16 v[72:75], v[212:215], v[136:139], v[72:75]
    v_mfma_f32_16x16x32_bf16 v[76:79], v[212:215], v[140:143], v[76:79]
    s_waitcnt lgkmcnt(2)
    v_mfma_f32_16x16x32_bf16 v[80:83], v[216:219], v[128:131], v[80:83]
    v_mfma_f32_16x16x32_bf16 v[84:87], v[216:219], v[132:135], v[84:87]
    v_mfma_f32_16x16x32_bf16 v[88:91], v[216:219], v[136:139], v[88:91]
    v_mfma_f32_16x16x32_bf16 v[92:95], v[216:219], v[140:143], v[92:95]
    s_waitcnt lgkmcnt(0)
    v_mfma_f32_16x16x32_bf16 v[96:99], v[220:223], v[128:131], v[96:99]
    v_mfma_f32_16x16x32_bf16 v[100:103], v[220:223], v[132:135], v[100:103]
    v_mfma_f32_16x16x32_bf16 v[104:107], v[220:223], v[136:139], v[104:107]
    v_mfma_f32_16x16x32_bf16 v[108:111], v[220:223], v[140:143], v[108:111]
    s_nop 7
    s_barrier
    v_cvt_pk_bf16_f32 v112, v0, v1
    v_cvt_pk_bf16_f32 v113, v2, v3
    ds_write_b64 v200, v[112:113] offset:0
    v_cvt_pk_bf16_f32 v114, v16, v17
    v_cvt_pk_bf16_f32 v115, v18, v19
    ds_write_b64 v200, v[114:115] offset:32
    v_cvt_pk_bf16_f32 v116, v32, v33
    v_cvt_pk_bf16_f32 v117, v34, v35
    ds_write_b64 v200, v[116:117] offset:64
    v_cvt_pk_bf16_f32 v118, v48, v49
    v_cvt_pk_bf16_f32 v119, v50, v51
    ds_write_b64 v200, v[118:119] offset:96
    v_cvt_pk_bf16_f32 v120, v64, v65
    v_cvt_pk_bf16_f32 v121, v66, v67
    ds_write_b64 v200, v[120:121] offset:128
    v_cvt_pk_bf16_f32 v122, v80, v81
    v_cvt_pk_bf16_f32 v123, v82, v83
    ds_write_b64 v200, v[122:123] offset:160
    v_cvt_pk_bf16_f32 v124, v96, v97
    v_cvt_pk_bf16_f32 v125, v98, v99
    ds_write_b64 v200, v[124:125] offset:192
    v_cvt_pk_bf16_f32 v126, v4, v5
    v_cvt_pk_bf16_f32 v127, v6, v7
    ds_write_b64 v200, v[126:127] offset:14592
    v_cvt_pk_bf16_f32 v128, v20, v21
    v_cvt_pk_bf16_f32 v129, v22, v23
    ds_write_b64 v200, v[128:129] offset:14624
    v_cvt_pk_bf16_f32 v130, v36, v37
    v_cvt_pk_bf16_f32 v131, v38, v39
    ds_write_b64 v200, v[130:131] offset:14656
    v_cvt_pk_bf16_f32 v132, v52, v53
    v_cvt_pk_bf16_f32 v133, v54, v55
    ds_write_b64 v200, v[132:133] offset:14688
    v_cvt_pk_bf16_f32 v134, v68, v69
    v_cvt_pk_bf16_f32 v135, v70, v71
    ds_write_b64 v200, v[134:135] offset:14720
    v_cvt_pk_bf16_f32 v136, v84, v85
    v_cvt_pk_bf16_f32 v137, v86, v87
    ds_write_b64 v200, v[136:137] offset:14752
    v_cvt_pk_bf16_f32 v138, v100, v101
    v_cvt_pk_bf16_f32 v139, v102, v103
    ds_write_b64 v200, v[138:139] offset:14784
    v_cvt_pk_bf16_f32 v140, v8, v9
    v_cvt_pk_bf16_f32 v141, v10, v11
    ds_write_b64 v200, v[140:141] offset:29184
    v_cvt_pk_bf16_f32 v142, v24, v25
    v_cvt_pk_bf16_f32 v143, v26, v27
    ds_write_b64 v200, v[142:143] offset:29216
    v_cvt_pk_bf16_f32 v112, v40, v41
    v_cvt_pk_bf16_f32 v113, v42, v43
    ds_write_b64 v200, v[112:113] offset:29248
    v_cvt_pk_bf16_f32 v114, v56, v57
    v_cvt_pk_bf16_f32 v115, v58, v59
    ds_write_b64 v200, v[114:115] offset:29280
    v_cvt_pk_bf16_f32 v116, v72, v73
    v_cvt_pk_bf16_f32 v117, v74, v75
    ds_write_b64 v200, v[116:117] offset:29312
    v_cvt_pk_bf16_f32 v118, v88, v89
    v_cvt_pk_bf16_f32 v119, v90, v91
    ds_write_b64 v200, v[118:119] offset:29344
    v_cvt_pk_bf16_f32 v120, v104, v105
    v_cvt_pk_bf16_f32 v121, v106, v107
    ds_write_b64 v200, v[120:121] offset:29376
    v_cvt_pk_bf16_f32 v122, v12, v13
    v_cvt_pk_bf16_f32 v123, v14, v15
    ds_write_b64 v200, v[122:123] offset:43776
    v_cvt_pk_bf16_f32 v124, v28, v29
    v_cvt_pk_bf16_f32 v125, v30, v31
    ds_write_b64 v200, v[124:125] offset:43808
    v_cvt_pk_bf16_f32 v126, v44, v45
    v_cvt_pk_bf16_f32 v127, v46, v47
    ds_write_b64 v200, v[126:127] offset:43840
    v_cvt_pk_bf16_f32 v128, v60, v61
    v_cvt_pk_bf16_f32 v129, v62, v63
    ds_write_b64 v200, v[128:129] offset:43872
    v_cvt_pk_bf16_f32 v130, v76, v77
    v_cvt_pk_bf16_f32 v131, v78, v79
    ds_write_b64 v200, v[130:131] offset:43904
    v_cvt_pk_bf16_f32 v132, v92, v93
    v_cvt_pk_bf16_f32 v133, v94, v95
    ds_write_b64 v200, v[132:133] offset:43936
    v_cvt_pk_bf16_f32 v134, v108, v109
    v_cvt_pk_bf16_f32 v135, v110, v111
    ds_write_b64 v200, v[134:135] offset:43968
    s_waitcnt lgkmcnt(0)
    s_barrier
    ds_read_b128 v[0:3], v202 offset:0
    ds_read_b128 v[4:7], v202 offset:912
    ds_read_b128 v[8:11], v202 offset:1824
    ds_read_b128 v[12:15], v202 offset:2736
    ds_read_b128 v[16:19], v202 offset:3648
    ds_read_b128 v[20:23], v202 offset:4560
    ds_read_b128 v[24:27], v202 offset:5472
    ds_read_b128 v[28:31], v202 offset:6384
    ds_read_b128 v[32:35], v202 offset:7296
    ds_read_b128 v[36:39], v202 offset:8208
    ds_read_b128 v[40:43], v202 offset:9120
    ds_read_b128 v[44:47], v202 offset:10032
    ds_read_b128 v[48:51], v202 offset:10944
    ds_read_b128 v[52:55], v202 offset:11856
    ds_read_b128 v[56:59], v202 offset:12768
    ds_read_b128 v[60:63], v202 offset:13680
    s_waitcnt lgkmcnt(15)
    buffer_store_dwordx4 v[0:3], v203, s[68:71], 0 offen offset:0 sc1
    s_waitcnt lgkmcnt(14)
    buffer_store_dwordx4 v[4:7], v203, s[68:71], 0 offen offset:896 sc1
    s_waitcnt lgkmcnt(13)
    buffer_store_dwordx4 v[8:11], v203, s[68:71], 0 offen offset:1792 sc1
    s_waitcnt lgkmcnt(12)
    buffer_store_dwordx4 v[12:15], v203, s[68:71], 0 offen offset:2688 sc1
    v_add_u32 v203, 3584, v203
    s_waitcnt lgkmcnt(11)
    buffer_store_dwordx4 v[16:19], v203, s[68:71], 0 offen offset:0 sc1
    s_waitcnt lgkmcnt(10)
    buffer_store_dwordx4 v[20:23], v203, s[68:71], 0 offen offset:896 sc1
    s_waitcnt lgkmcnt(9)
    buffer_store_dwordx4 v[24:27], v203, s[68:71], 0 offen offset:1792 sc1
    s_waitcnt lgkmcnt(8)
    buffer_store_dwordx4 v[28:31], v203, s[68:71], 0 offen offset:2688 sc1
    v_add_u32 v203, 3584, v203
    s_waitcnt lgkmcnt(7)
    buffer_store_dwordx4 v[32:35], v203, s[68:71], 0 offen offset:0 sc1
    s_waitcnt lgkmcnt(6)
    buffer_store_dwordx4 v[36:39], v203, s[68:71], 0 offen offset:896 sc1
    s_waitcnt lgkmcnt(5)
    buffer_store_dwordx4 v[40:43], v203, s[68:71], 0 offen offset:1792 sc1
    s_waitcnt lgkmcnt(4)
    buffer_store_dwordx4 v[44:47], v203, s[68:71], 0 offen offset:2688 sc1
    v_add_u32 v203, 3584, v203
    s_waitcnt lgkmcnt(3)
    buffer_store_dwordx4 v[48:51], v203, s[68:71], 0 offen offset:0 sc1
    s_waitcnt lgkmcnt(2)
    buffer_store_dwordx4 v[52:55], v203, s[68:71], 0 offen offset:896 sc1
    s_waitcnt lgkmcnt(1)
    buffer_store_dwordx4 v[56:59], v203, s[68:71], 0 offen offset:1792 sc1
    s_waitcnt lgkmcnt(0)
    buffer_store_dwordx4 v[60:63], v203, s[68:71], 0 offen offset:2688 sc1
    s_waitcnt vmcnt(16)
    v_add_f32 v160, v160, v168
    v_add_f32 v176, v176, v184
    v_add_f32 v161, v161, v169
    v_add_f32 v177, v177, v185
    v_add_f32 v162, v162, v170
    v_add_f32 v178, v178, v186
    v_add_f32 v163, v163, v171
    v_add_f32 v179, v179, v187
    v_add_f32 v164, v164, v172
    v_add_f32 v180, v180, v188
    v_add_f32 v165, v165, v173
    v_add_f32 v181, v181, v189
    v_add_f32 v166, v166, v174
    v_add_f32 v182, v182, v190
    v_add_f32 v167, v167, v175
    v_add_f32 v183, v183, v191
    v_add_f32 v160, v160, v176
    v_add_f32 v161, v161, v177
    v_add_f32 v162, v162, v178
    v_add_f32 v163, v163, v179
    v_add_f32 v164, v164, v180
    v_add_f32 v165, v165, v181
    v_add_f32 v166, v166, v182
    v_add_f32 v167, v167, v183
    v_cvt_pk_bf16_f32 v160, v160, 0
    v_cvt_pk_bf16_f32 v161, v161, 0
    v_cvt_pk_bf16_f32 v162, v162, 0
    v_cvt_pk_bf16_f32 v163, v163, 0
    v_cvt_pk_bf16_f32 v164, v164, 0
    v_cvt_pk_bf16_f32 v165, v165, 0
    v_cvt_pk_bf16_f32 v166, v166, 0
    v_cvt_pk_bf16_f32 v167, v167, 0
    v_lshlrev_b32 v160, 16, v160
    v_lshlrev_b32 v161, 16, v161
    v_lshlrev_b32 v162, 16, v162
    v_lshlrev_b32 v163, 16, v163
    v_lshlrev_b32 v164, 16, v164
    v_lshlrev_b32 v165, 16, v165
    v_lshlrev_b32 v166, 16, v166
    v_lshlrev_b32 v167, 16, v167
    v_add_f32 v168, 1.0, v160
    v_add_f32 v169, 1.0, v161
    v_add_f32 v170, 1.0, v162
    v_add_f32 v171, 1.0, v163
    v_add_f32 v172, 1.0, v164
    v_add_f32 v173, 1.0, v165
    v_add_f32 v174, 1.0, v166
    v_add_f32 v175, 1.0, v167
    v_cvt_pk_bf16_f32 v168, v168, 0
    v_cvt_pk_bf16_f32 v169, v169, 0
    v_cvt_pk_bf16_f32 v170, v170, 0
    v_cvt_pk_bf16_f32 v171, v171, 0
    v_cvt_pk_bf16_f32 v172, v172, 0
    v_cvt_pk_bf16_f32 v173, v173, 0
    v_cvt_pk_bf16_f32 v174, v174, 0
    v_cvt_pk_bf16_f32 v175, v175, 0
    v_lshlrev_b32 v168, 16, v168
    v_lshlrev_b32 v169, 16, v169
    v_lshlrev_b32 v170, 16, v170
    v_lshlrev_b32 v171, 16, v171
    v_lshlrev_b32 v172, 16, v172
    v_lshlrev_b32 v173, 16, v173
    v_lshlrev_b32 v174, 16, v174
    v_lshlrev_b32 v175, 16, v175
    v_lshrrev_b32 v242, 2, v199
    v_add_u32 v243, 4294966400, v242
    v_cmp_gt_u32 vcc, 448, v243
    s_nop 1
    v_cndmask_b32 v160, v160, v168, vcc
    v_cndmask_b32 v161, v161, v169, vcc
    v_cndmask_b32 v162, v162, v170, vcc
    v_cndmask_b32 v163, v163, v171, vcc
    v_add_u32 v243, 128, v242
    v_cmp_gt_u32 vcc, 448, v243
    s_nop 1
    v_cndmask_b32 v164, v164, v172, vcc
    v_cndmask_b32 v165, v165, v173, vcc
    v_cndmask_b32 v166, v166, v174, vcc
    v_cndmask_b32 v167, v167, v175, vcc
    ds_write_b128 v199, v[160:163] offset:59392
    ds_write_b128 v199, v[164:167] offset:63488
    s_lshl_b32 s63, s36, 3
    s_lshl_b32 s64, s34, 1
    s_add_u32 s63, s63, s64
    s_mul_i32 s63, s63, 912
    v_min_u32 v240, 55, v252
    v_lshlrev_b32 v241, 4, v240
    v_add_u32 v241, s63, v241
    v_lshlrev_b32 v240, 5, v240
    s_add_u32 s59, s36, 1
    s_and_b32 s59, s59, 7
    s_mul_i32 s44, s59, 1835008
    s_add_u32 s59, s36, 2
    s_and_b32 s59, s59, 7
    s_mul_i32 s45, s59, 1835008
    s_add_u32 s59, s36, 3
    s_and_b32 s59, s59, 7
    s_mul_i32 s46, s59, 1835008
    s_add_u32 s59, s36, 4
    s_and_b32 s59, s59, 7
    s_mul_i32 s47, s59, 1835008
    s_add_u32 s59, s36, 5
    s_and_b32 s59, s59, 7
    s_mul_i32 s48, s59, 1835008
    s_add_u32 s59, s36, 6
    s_and_b32 s59, s59, 7
    s_mul_i32 s49, s59, 1835008
    s_add_u32 s59, s36, 7
    s_and_b32 s59, s59, 7
    s_mul_i32 s50, s59, 1835008
    s_waitcnt vmcnt(0) lgkmcnt(0)
    s_barrier
    s_cmp_lg_u32 s34, 0
    s_cbranch_scc1 L_grp_done
    v_mov_b32 v0, 1
    v_mov_b32 v1, 0
    v_cmp_eq_u32 vcc, 0, v252
    s_and_saveexec_b64 s[60:61], vcc
    buffer_atomic_add v0, v1, s[52:55], 0 offen sc1
    s_mov_b64 exec, s[60:61]
L_grp_poll:
    buffer_load_dword v2, v1, s[52:55], 0 offen sc1
    s_waitcnt vmcnt(0)
    v_readfirstlane_b32 s59, v2
    s_cmp_eq_u32 s59, 8
    s_cbranch_scc1 L_grp_done
    s_sleep 2
    s_branch L_grp_poll
L_grp_done:
    s_barrier
    buffer_load_dwordx4 v[4:7], v192, s[8:11], s44 offen offset:0 sc1
    buffer_load_dwordx4 v[8:11], v192, s[8:11], s45 offen offset:0 sc1
    buffer_load_dwordx4 v[12:15], v192, s[8:11], s46 offen offset:0 sc1
    buffer_load_dwordx4 v[16:19], v192, s[8:11], s47 offen offset:0 sc1
    buffer_load_dwordx4 v[20:23], v192, s[8:11], s48 offen offset:0 sc1
    buffer_load_dwordx4 v[24:27], v192, s[8:11], s49 offen offset:0 sc1
    buffer_load_dwordx4 v[28:31], v192, s[8:11], s50 offen offset:0 sc1
    buffer_load_dwordx4 v[36:39], v192, s[8:11], s44 offen offset:896 sc1
    buffer_load_dwordx4 v[40:43], v192, s[8:11], s45 offen offset:896 sc1
    buffer_load_dwordx4 v[44:47], v192, s[8:11], s46 offen offset:896 sc1
    buffer_load_dwordx4 v[48:51], v192, s[8:11], s47 offen offset:896 sc1
    buffer_load_dwordx4 v[52:55], v192, s[8:11], s48 offen offset:896 sc1
    buffer_load_dwordx4 v[56:59], v192, s[8:11], s49 offen offset:896 sc1
    buffer_load_dwordx4 v[60:63], v192, s[8:11], s50 offen offset:896 sc1
    ds_read_b128 v[0:3], v241 offset:0
    ds_read_b128 v[32:35], v241 offset:912
    ds_read_b128 v[160:163], v240 offset:59392
    ds_read_b128 v[164:167], v240 offset:59408
    ds_read_b128 v[168:171], v240 offset:61184
    ds_read_b128 v[172:175], v240 offset:61200
    ds_read_b128 v[176:179], v240 offset:62976
    ds_read_b128 v[180:183], v240 offset:62992
    ds_read_b128 v[184:187], v240 offset:64768
    ds_read_b128 v[188:191], v240 offset:64784
    v_mov_b32 v64, 0
    v_mov_b32 v65, 0
    v_mov_b32 v66, 0
    v_mov_b32 v67, 0
    v_mov_b32 v68, 0
    v_mov_b32 v69, 0
    v_mov_b32 v70, 0
    v_mov_b32 v71, 0
    v_mov_b32 v72, 0
    v_mov_b32 v73, 0
    v_mov_b32 v74, 0
    v_mov_b32 v75, 0
    v_mov_b32 v76, 0
    v_mov_b32 v77, 0
    v_mov_b32 v78, 0
    v_mov_b32 v79, 0
    v_cmp_gt_u32 vcc, 56, v252
    s_waitcnt lgkmcnt(0)
    s_nop 0
    v_cndmask_b32_e64 v0, 0, v0, vcc
    v_cndmask_b32_e64 v1, 0, v1, vcc
    v_cndmask_b32_e64 v2, 0, v2, vcc
    v_cndmask_b32_e64 v3, 0, v3, vcc
    v_cndmask_b32_e64 v32, 0, v32, vcc
    v_cndmask_b32_e64 v33, 0, v33, vcc
    v_cndmask_b32_e64 v34, 0, v34, vcc
    v_cndmask_b32_e64 v35, 0, v35, vcc
    s_waitcnt vmcnt(7)
    v_dot2_f32_bf16 v64, v0, v196, v64
    v_dot2_f32_bf16 v65, v0, v197, v65
    v_dot2_f32_bf16 v66, v1, v196, v66
    v_dot2_f32_bf16 v67, v1, v197, v67
    v_dot2_f32_bf16 v68, v2, v196, v68
    v_dot2_f32_bf16 v69, v2, v197, v69
    v_dot2_f32_bf16 v70, v3, v196, v70
    v_dot2_f32_bf16 v71, v3, v197, v71
    v_dot2_f32_bf16 v64, v4, v196, v64
    v_dot2_f32_bf16 v65, v4, v197, v65
    v_dot2_f32_bf16 v66, v5, v196, v66
    v_dot2_f32_bf16 v67, v5, v197, v67
    v_dot2_f32_bf16 v68, v6, v196, v68
    v_dot2_f32_bf16 v69, v6, v197, v69
    v_dot2_f32_bf16 v70, v7, v196, v70
    v_dot2_f32_bf16 v71, v7, v197, v71
    v_dot2_f32_bf16 v64, v8, v196, v64
    v_dot2_f32_bf16 v65, v8, v197, v65
    v_dot2_f32_bf16 v66, v9, v196, v66
    v_dot2_f32_bf16 v67, v9, v197, v67
    v_dot2_f32_bf16 v68, v10, v196, v68
    v_dot2_f32_bf16 v69, v10, v197, v69
    v_dot2_f32_bf16 v70, v11, v196, v70
    v_dot2_f32_bf16 v71, v11, v197, v71
    v_dot2_f32_bf16 v64, v12, v196, v64
    v_dot2_f32_bf16 v65, v12, v197, v65
    v_dot2_f32_bf16 v66, v13, v196, v66
    v_dot2_f32_bf16 v67, v13, v197, v67
    v_dot2_f32_bf16 v68, v14, v196, v68
    v_dot2_f32_bf16 v69, v14, v197, v69
    v_dot2_f32_bf16 v70, v15, v196, v70
    v_dot2_f32_bf16 v71, v15, v197, v71
    v_dot2_f32_bf16 v64, v16, v196, v64
    v_dot2_f32_bf16 v65, v16, v197, v65
    v_dot2_f32_bf16 v66, v17, v196, v66
    v_dot2_f32_bf16 v67, v17, v197, v67
    v_dot2_f32_bf16 v68, v18, v196, v68
    v_dot2_f32_bf16 v69, v18, v197, v69
    v_dot2_f32_bf16 v70, v19, v196, v70
    v_dot2_f32_bf16 v71, v19, v197, v71
    v_dot2_f32_bf16 v64, v20, v196, v64
    v_dot2_f32_bf16 v65, v20, v197, v65
    v_dot2_f32_bf16 v66, v21, v196, v66
    v_dot2_f32_bf16 v67, v21, v197, v67
    v_dot2_f32_bf16 v68, v22, v196, v68
    v_dot2_f32_bf16 v69, v22, v197, v69
    v_dot2_f32_bf16 v70, v23, v196, v70
    v_dot2_f32_bf16 v71, v23, v197, v71
    v_dot2_f32_bf16 v64, v24, v196, v64
    v_dot2_f32_bf16 v65, v24, v197, v65
    v_dot2_f32_bf16 v66, v25, v196, v66
    v_dot2_f32_bf16 v67, v25, v197, v67
    v_dot2_f32_bf16 v68, v26, v196, v68
    v_dot2_f32_bf16 v69, v26, v197, v69
    v_dot2_f32_bf16 v70, v27, v196, v70
    v_dot2_f32_bf16 v71, v27, v197, v71
    v_dot2_f32_bf16 v64, v28, v196, v64
    v_dot2_f32_bf16 v65, v28, v197, v65
    v_dot2_f32_bf16 v66, v29, v196, v66
    v_dot2_f32_bf16 v67, v29, v197, v67
    v_dot2_f32_bf16 v68, v30, v196, v68
    v_dot2_f32_bf16 v69, v30, v197, v69
    v_dot2_f32_bf16 v70, v31, v196, v70
    v_dot2_f32_bf16 v71, v31, v197, v71
    s_waitcnt vmcnt(0)
    v_dot2_f32_bf16 v72, v32, v196, v72
    v_dot2_f32_bf16 v73, v32, v197, v73
    v_dot2_f32_bf16 v74, v33, v196, v74
    v_dot2_f32_bf16 v75, v33, v197, v75
    v_dot2_f32_bf16 v76, v34, v196, v76
    v_dot2_f32_bf16 v77, v34, v197, v77
    v_dot2_f32_bf16 v78, v35, v196, v78
    v_dot2_f32_bf16 v79, v35, v197, v79
    v_dot2_f32_bf16 v72, v36, v196, v72
    v_dot2_f32_bf16 v73, v36, v197, v73
    v_dot2_f32_bf16 v74, v37, v196, v74
    v_dot2_f32_bf16 v75, v37, v197, v75
    v_dot2_f32_bf16 v76, v38, v196, v76
    v_dot2_f32_bf16 v77, v38, v197, v77
    v_dot2_f32_bf16 v78, v39, v196, v78
    v_dot2_f32_bf16 v79, v39, v197, v79
    v_dot2_f32_bf16 v72, v40, v196, v72
    v_dot2_f32_bf16 v73, v40, v197, v73
    v_dot2_f32_bf16 v74, v41, v196, v74
    v_dot2_f32_bf16 v75, v41, v197, v75
    v_dot2_f32_bf16 v76, v42, v196, v76
    v_dot2_f32_bf16 v77, v42, v197, v77
    v_dot2_f32_bf16 v78, v43, v196, v78
    v_dot2_f32_bf16 v79, v43, v197, v79
    v_dot2_f32_bf16 v72, v44, v196, v72
    v_dot2_f32_bf16 v73, v44, v197, v73
    v_dot2_f32_bf16 v74, v45, v196, v74
    v_dot2_f32_bf16 v75, v45, v197, v75
    v_dot2_f32_bf16 v76, v46, v196, v76
    v_dot2_f32_bf16 v77, v46, v197, v77
    v_dot2_f32_bf16 v78, v47, v196, v78
    v_dot2_f32_bf16 v79, v47, v197, v79
    v_dot2_f32_bf16 v72, v48, v196, v72
    v_dot2_f32_bf16 v73, v48, v197, v73
    v_dot2_f32_bf16 v74, v49, v196, v74
    v_dot2_f32_bf16 v75, v49, v197, v75
    v_dot2_f32_bf16 v76, v50, v196, v76
    v_dot2_f32_bf16 v77, v50, v197, v77
    v_dot2_f32_bf16 v78, v51, v196, v78
    v_dot2_f32_bf16 v79, v51, v197, v79
    v_dot2_f32_bf16 v72, v52, v196, v72
    v_dot2_f32_bf16 v73, v52, v197, v73
    v_dot2_f32_bf16 v74, v53, v196, v74
    v_dot2_f32_bf16 v75, v53, v197, v75
    v_dot2_f32_bf16 v76, v54, v196, v76
    v_dot2_f32_bf16 v77, v54, v197, v77
    v_dot2_f32_bf16 v78, v55, v196, v78
    v_dot2_f32_bf16 v79, v55, v197, v79
    v_dot2_f32_bf16 v72, v56, v196, v72
    v_dot2_f32_bf16 v73, v56, v197, v73
    v_dot2_f32_bf16 v74, v57, v196, v74
    v_dot2_f32_bf16 v75, v57, v197, v75
    v_dot2_f32_bf16 v76, v58, v196, v76
    v_dot2_f32_bf16 v77, v58, v197, v77
    v_dot2_f32_bf16 v78, v59, v196, v78
    v_dot2_f32_bf16 v79, v59, v197, v79
    v_dot2_f32_bf16 v72, v60, v196, v72
    v_dot2_f32_bf16 v73, v60, v197, v73
    v_dot2_f32_bf16 v74, v61, v196, v74
    v_dot2_f32_bf16 v75, v61, v197, v75
    v_dot2_f32_bf16 v76, v62, v196, v76
    v_dot2_f32_bf16 v77, v62, v197, v77
    v_dot2_f32_bf16 v78, v63, v196, v78
    v_dot2_f32_bf16 v79, v63, v197, v79
    s_nop 2
    v_mul_f32 v64, v64, v160
    v_mul_f32 v65, v65, v161
    v_mul_f32 v66, v66, v162
    v_mul_f32 v67, v67, v163
    v_mul_f32 v68, v68, v164
    v_mul_f32 v69, v69, v165
    v_mul_f32 v70, v70, v166
    v_mul_f32 v71, v71, v167
    v_dot2_f32_bf16 v64, v144, v196, v64
    v_dot2_f32_bf16 v65, v144, v197, v65
    v_dot2_f32_bf16 v66, v145, v196, v66
    v_dot2_f32_bf16 v67, v145, v197, v67
    v_dot2_f32_bf16 v68, v146, v196, v68
    v_dot2_f32_bf16 v69, v146, v197, v69
    v_dot2_f32_bf16 v70, v147, v196, v70
    v_dot2_f32_bf16 v71, v147, v197, v71
    v_mul_f32 v72, v72, v160
    v_mul_f32 v73, v73, v161
    v_mul_f32 v74, v74, v162
    v_mul_f32 v75, v75, v163
    v_mul_f32 v76, v76, v164
    v_mul_f32 v77, v77, v165
    v_mul_f32 v78, v78, v166
    v_mul_f32 v79, v79, v167
    v_dot2_f32_bf16 v72, v148, v196, v72
    v_dot2_f32_bf16 v73, v148, v197, v73
    v_dot2_f32_bf16 v74, v149, v196, v74
    v_dot2_f32_bf16 v75, v149, v197, v75
    v_dot2_f32_bf16 v76, v150, v196, v76
    v_dot2_f32_bf16 v77, v150, v197, v77
    v_dot2_f32_bf16 v78, v151, v196, v78
    v_dot2_f32_bf16 v79, v151, v197, v79
    s_nop 2
    v_cvt_pk_bf16_f32 v96, v64, v65
    v_cvt_pk_bf16_f32 v97, v66, v67
    v_cvt_pk_bf16_f32 v98, v68, v69
    v_cvt_pk_bf16_f32 v99, v70, v71
    v_cvt_pk_bf16_f32 v100, v72, v73
    v_cvt_pk_bf16_f32 v101, v74, v75
    v_cvt_pk_bf16_f32 v102, v76, v77
    v_cvt_pk_bf16_f32 v103, v78, v79
    v_lshlrev_b32 v80, 16, v96
    v_and_b32 v81, 0xffff0000, v96
    v_lshlrev_b32 v82, 16, v97
    v_and_b32 v83, 0xffff0000, v97
    v_lshlrev_b32 v84, 16, v98
    v_and_b32 v85, 0xffff0000, v98
    v_lshlrev_b32 v86, 16, v99
    v_and_b32 v87, 0xffff0000, v99
    v_lshlrev_b32 v88, 16, v100
    v_and_b32 v89, 0xffff0000, v100
    v_lshlrev_b32 v90, 16, v101
    v_and_b32 v91, 0xffff0000, v101
    v_lshlrev_b32 v92, 16, v102
    v_and_b32 v93, 0xffff0000, v102
    v_lshlrev_b32 v94, 16, v103
    v_and_b32 v95, 0xffff0000, v103
    v_add_f32 v104, v80, v81
    v_add_f32 v104, v104, v82
    v_add_f32 v104, v104, v83
    v_add_f32 v104, v104, v84
    v_add_f32 v104, v104, v85
    v_add_f32 v104, v104, v86
    v_add_f32 v104, v104, v87
    v_add_f32 v105, v88, v89
    v_add_f32 v105, v105, v90
    v_add_f32 v105, v105, v91
    v_add_f32 v105, v105, v92
    v_add_f32 v105, v105, v93
    v_add_f32 v105, v105, v94
    v_add_f32 v105, v105, v95
    s_nop 0
    v_add_f32_dpp v104, v104, v104 row_ror:1 row_mask:0xf bank_mask:0xf
    v_add_f32_dpp v105, v105, v105 row_ror:1 row_mask:0xf bank_mask:0xf
    s_nop 0
    v_add_f32_dpp v104, v104, v104 row_ror:2 row_mask:0xf bank_mask:0xf
    v_add_f32_dpp v105, v105, v105 row_ror:2 row_mask:0xf bank_mask:0xf
    s_nop 0
    v_add_f32_dpp v104, v104, v104 row_ror:4 row_mask:0xf bank_mask:0xf
    v_add_f32_dpp v105, v105, v105 row_ror:4 row_mask:0xf bank_mask:0xf
    s_nop 0
    v_add_f32_dpp v104, v104, v104 row_ror:8 row_mask:0xf bank_mask:0xf
    v_add_f32_dpp v105, v105, v105 row_ror:8 row_mask:0xf bank_mask:0xf
    s_nop 0
    v_mov_b32 v106, v104
    v_mov_b32 v107, v105
    s_nop 1
    v_permlane16_swap_b32 v104, v106
    v_permlane16_swap_b32 v105, v107
    s_nop 1
    v_add_f32 v104, v104, v106
    v_add_f32 v105, v105, v107
    s_nop 0
    v_mov_b32 v106, v104
    v_mov_b32 v107, v105
    s_nop 1
    v_permlane32_swap_b32 v104, v106
    v_permlane32_swap_b32 v105, v107
    s_nop 1
    v_add_f32 v104, v104, v106
    v_add_f32 v105, v105, v107
    v_mul_f32 v104, 0xbb124925, v104
    v_mul_f32 v105, 0xbb124925, v105
    v_add_f32 v64, v80, v104
    v_add_f32 v65, v81, v104
    v_add_f32 v66, v82, v104
    v_add_f32 v67, v83, v104
    v_add_f32 v68, v84, v104
    v_add_f32 v69, v85, v104
    v_add_f32 v70, v86, v104
    v_add_f32 v71, v87, v104
    v_add_f32 v72, v88, v105
    v_add_f32 v73, v89, v105
    v_add_f32 v74, v90, v105
    v_add_f32 v75, v91, v105
    v_add_f32 v76, v92, v105
    v_add_f32 v77, v93, v105
    v_add_f32 v78, v94, v105
    v_add_f32 v79, v95, v105
    v_mul_f32 v106, v64, v64
    v_fmac_f32 v106, v65, v65
    v_fmac_f32 v106, v66, v66
    v_fmac_f32 v106, v67, v67
    v_fmac_f32 v106, v68, v68
    v_fmac_f32 v106, v69, v69
    v_fmac_f32 v106, v70, v70
    v_fmac_f32 v106, v71, v71
    v_mul_f32 v107, v72, v72
    v_fmac_f32 v107, v73, v73
    v_fmac_f32 v107, v74, v74
    v_fmac_f32 v107, v75, v75
    v_fmac_f32 v107, v76, v76
    v_fmac_f32 v107, v77, v77
    v_fmac_f32 v107, v78, v78
    v_fmac_f32 v107, v79, v79
    v_mul_f32 v106, v106, v193
    v_mul_f32 v107, v107, v193
    s_nop 0
    v_add_f32_dpp v106, v106, v106 row_ror:1 row_mask:0xf bank_mask:0xf
    v_add_f32_dpp v107, v107, v107 row_ror:1 row_mask:0xf bank_mask:0xf
    s_nop 0
    v_add_f32_dpp v106, v106, v106 row_ror:2 row_mask:0xf bank_mask:0xf
    v_add_f32_dpp v107, v107, v107 row_ror:2 row_mask:0xf bank_mask:0xf
    s_nop 0
    v_add_f32_dpp v106, v106, v106 row_ror:4 row_mask:0xf bank_mask:0xf
    v_add_f32_dpp v107, v107, v107 row_ror:4 row_mask:0xf bank_mask:0xf
    s_nop 0
    v_add_f32_dpp v106, v106, v106 row_ror:8 row_mask:0xf bank_mask:0xf
    v_add_f32_dpp v107, v107, v107 row_ror:8 row_mask:0xf bank_mask:0xf
    s_nop 0
    v_mov_b32 v108, v106
    v_mov_b32 v109, v107
    s_nop 1
    v_permlane16_swap_b32 v106, v108
    v_permlane16_swap_b32 v107, v109
    s_nop 1
    v_add_f32 v106, v106, v108
    v_add_f32 v107, v107, v109
    s_nop 0
    v_mov_b32 v108, v106
    v_mov_b32 v109, v107
    s_nop 1
    v_permlane32_swap_b32 v106, v108
    v_permlane32_swap_b32 v107, v109
    s_nop 1
    v_add_f32 v106, v106, v108
    v_add_f32 v107, v107, v109
    v_mov_b32 v108, 0x3727c5ac
    v_fmac_f32 v108, 0x3b124925, v106
    v_mov_b32 v109, 0x3727c5ac
    v_fmac_f32 v109, 0x3b124925, v107
    v_rsq_f32 v106, v108
    v_rsq_f32 v107, v109
    s_nop 0
    v_mul_f32 v64, v64, v106
    v_mul_f32 v65, v65, v106
    v_mul_f32 v66, v66, v106
    v_mul_f32 v67, v67, v106
    v_mul_f32 v68, v68, v106
    v_mul_f32 v69, v69, v106
    v_mul_f32 v70, v70, v106
    v_mul_f32 v71, v71, v106
    v_fma_f32 v64, v64, v176, v168
    v_fma_f32 v65, v65, v177, v169
    v_fma_f32 v66, v66, v178, v170
    v_fma_f32 v67, v67, v179, v171
    v_fma_f32 v68, v68, v180, v172
    v_fma_f32 v69, v69, v181, v173
    v_fma_f32 v70, v70, v182, v174
    v_fma_f32 v71, v71, v183, v175
    v_cvt_pk_bf16_f32 v96, v64, v65
    v_cvt_pk_bf16_f32 v97, v66, v67
    v_cvt_pk_bf16_f32 v98, v68, v69
    v_cvt_pk_bf16_f32 v99, v70, v71
    v_mul_f32 v72, v72, v107
    v_mul_f32 v73, v73, v107
    v_mul_f32 v74, v74, v107
    v_mul_f32 v75, v75, v107
    v_mul_f32 v76, v76, v107
    v_mul_f32 v77, v77, v107
    v_mul_f32 v78, v78, v107
    v_mul_f32 v79, v79, v107
    v_fma_f32 v72, v72, v176, v168
    v_fma_f32 v73, v73, v177, v169
    v_fma_f32 v74, v74, v178, v170
    v_fma_f32 v75, v75, v179, v171
    v_fma_f32 v76, v76, v180, v172
    v_fma_f32 v77, v77, v181, v173
    v_fma_f32 v78, v78, v182, v174
    v_fma_f32 v79, v79, v183, v175
    v_cvt_pk_bf16_f32 v100, v72, v73
    v_cvt_pk_bf16_f32 v101, v74, v75
    v_cvt_pk_bf16_f32 v102, v76, v77
    v_cvt_pk_bf16_f32 v103, v78, v79
    buffer_store_dwordx4 v[96:99], v192, s[20:23], 0 offen offset:0 sc1
    buffer_store_dwordx4 v[100:103], v192, s[20:23], 0 offen offset:896 sc1
    v_mov_b32 v108, 0
    v_mov_b32 v109, 0
    v_dot2_f32_bf16 v108, v96, v152, v108
    v_dot2_f32_bf16 v109, v100, v152, v109
    v_dot2_f32_bf16 v108, v97, v153, v108
    v_dot2_f32_bf16 v109, v101, v153, v109
    v_dot2_f32_bf16 v108, v98, v154, v108
    v_dot2_f32_bf16 v109, v102, v154, v109
    v_dot2_f32_bf16 v108, v99, v155, v108
    v_dot2_f32_bf16 v109, v103, v155, v109
    v_lshlrev_b32 v64, 16, v96
    v_and_b32 v65, 0xffff0000, v96
    v_lshlrev_b32 v66, 16, v97
    v_and_b32 v67, 0xffff0000, v97
    v_lshlrev_b32 v68, 16, v98
    v_and_b32 v69, 0xffff0000, v98
    v_lshlrev_b32 v70, 16, v99
    v_and_b32 v71, 0xffff0000, v99
    v_fma_f32 v64, v64, v184, v80
    v_fma_f32 v65, v65, v185, v81
    v_fma_f32 v66, v66, v186, v82
    v_fma_f32 v67, v67, v187, v83
    v_fma_f32 v68, v68, v188, v84
    v_fma_f32 v69, v69, v189, v85
    v_fma_f32 v70, v70, v190, v86
    v_fma_f32 v71, v71, v191, v87
    v_cvt_pk_bf16_f32 v0, v64, v65
    v_cvt_pk_bf16_f32 v1, v66, v67
    v_cvt_pk_bf16_f32 v2, v68, v69
    v_cvt_pk_bf16_f32 v3, v70, v71
    buffer_store_dwordx4 v[0:3], v192, s[16:19], 0 offen offset:0 sc1
    v_lshlrev_b32 v72, 16, v100
    v_and_b32 v73, 0xffff0000, v100
    v_lshlrev_b32 v74, 16, v101
    v_and_b32 v75, 0xffff0000, v101
    v_lshlrev_b32 v76, 16, v102
    v_and_b32 v77, 0xffff0000, v102
    v_lshlrev_b32 v78, 16, v103
    v_and_b32 v79, 0xffff0000, v103
    v_fma_f32 v72, v72, v184, v88
    v_fma_f32 v73, v73, v185, v89
    v_fma_f32 v74, v74, v186, v90
    v_fma_f32 v75, v75, v187, v91
    v_fma_f32 v76, v76, v188, v92
    v_fma_f32 v77, v77, v189, v93
    v_fma_f32 v78, v78, v190, v94
    v_fma_f32 v79, v79, v191, v95
    v_cvt_pk_bf16_f32 v4, v72, v73
    v_cvt_pk_bf16_f32 v5, v74, v75
    v_cvt_pk_bf16_f32 v6, v76, v77
    v_cvt_pk_bf16_f32 v7, v78, v79
    buffer_store_dwordx4 v[4:7], v192, s[16:19], 0 offen offset:896 sc1
    s_nop 0
    v_add_f32_dpp v108, v108, v108 row_ror:1 row_mask:0xf bank_mask:0xf
    v_add_f32_dpp v109, v109, v109 row_ror:1 row_mask:0xf bank_mask:0xf
    s_nop 0
    v_add_f32_dpp v108, v108, v108 row_ror:2 row_mask:0xf bank_mask:0xf
    v_add_f32_dpp v109, v109, v109 row_ror:2 row_mask:0xf bank_mask:0xf
    s_nop 0
    v_add_f32_dpp v108, v108, v108 row_ror:4 row_mask:0xf bank_mask:0xf
    v_add_f32_dpp v109, v109, v109 row_ror:4 row_mask:0xf bank_mask:0xf
    s_nop 0
    v_add_f32_dpp v108, v108, v108 row_ror:8 row_mask:0xf bank_mask:0xf
    v_add_f32_dpp v109, v109, v109 row_ror:8 row_mask:0xf bank_mask:0xf
    s_nop 0
    v_mov_b32 v104, v108
    v_mov_b32 v105, v109
    s_nop 1
    v_permlane16_swap_b32 v108, v104
    v_permlane16_swap_b32 v109, v105
    s_nop 1
    v_add_f32 v108, v108, v104
    v_add_f32 v109, v109, v105
    s_nop 0
    v_mov_b32 v104, v108
    v_mov_b32 v105, v109
    s_nop 1
    v_permlane32_swap_b32 v108, v104
    v_permlane32_swap_b32 v109, v105
    s_nop 1
    v_add_f32 v108, v108, v104
    v_add_f32 v109, v109, v105
    v_cvt_pk_bf16_f32 v108, v108, 0
    v_cvt_pk_bf16_f32 v109, v109, 0
    v_cmp_eq_u32 vcc, 1, v252
    s_nop 1
    v_cndmask_b32 v108, v108, v109, vcc
    v_lshlrev_b32 v108, 16, v108
    v_ashrrev_i32 v109, 31, v108
    v_or_b32 v109, 0x80000000, v109
    v_xor_b32 v108, v108, v109
    v_and_b32 v108, 0xffff0000, v108
    v_add_u32 v104, s56, v252
    v_sub_u32 v105, 2047, v104
    v_or_b32 v108, v108, v105
    s_lshl_b32 s59, s34, 3
    s_add_u32 s59, s59, 68608
    v_lshl_add_u32 v104, v252, 2, s59
    v_cmp_gt_u32 vcc, 2, v252
    s_and_saveexec_b64 s[60:61], vcc
    ds_write_b32 v104, v108
    s_mov_b64 exec, s[60:61]
    s_waitcnt vmcnt(0) lgkmcnt(0)
    s_barrier
    s_cmp_lg_u32 s34, 0
    s_cbranch_scc1 L_key_done
    v_lshlrev_b32 v104, 2, v252
    v_add_u32 v107, 68608, v104
    ds_read_b32 v105, v107
    s_lshr_b32 s59, s56, 3
    s_lshl_b32 s59, s59, 5
    v_add_u32 v104, s59, v104
    v_mov_b32 v106, 0x40000000
    v_cmp_gt_u32 vcc, 8, v252
    s_waitcnt lgkmcnt(0)
    s_nop 0
    v_cndmask_b32 v104, v106, v104, vcc
    buffer_store_dword v105, v104, s[96:99], 0 offen sc1
L_key_done:
    s_cmp_ge_u32 s2, 84
    s_cbranch_scc1 L_st_end_k34
    s_mov_b32 s3, s34
    v_mov_b32 v1, v252
    s_lshl_b32 s41, s3, 6
    v_add_u32 v0, s41, v1
    v_lshlrev_b32 v5, 5, v0
L_keys_poll:
    s_sleep 24
    buffer_load_dwordx4 v[8:11], v5, s[96:99], 0 offen sc1
    buffer_load_dwordx4 v[12:15], v5, s[96:99], 0 offen offset:16 sc1
    s_waitcnt vmcnt(0)
    v_max3_u32 v16, v8, v9, v10
    v_max3_u32 v16, v16, v11, v12
    v_max3_u32 v16, v16, v13, v14
    v_max_u32 v16, v16, v15
    v_cmp_eq_u32 vcc, -1, v16
    s_nop 0
    s_cbranch_vccnz L_keys_poll
L_keys_ok:
    s_cmp_ge_u32 s2, 56
    s_cbranch_scc1 L_moe_pre_d
    s_cmp_ge_u32 s34, 2
    s_cselect_b32 s64, s30, s28
    s_cselect_b32 s65, s31, s29
    s_mov_b32 s66, 1605632
    s_mov_b32 s67, 0x20000
    s_and_b32 s40, s2, 7
    s_mul_i32 s40, s40, 7
    s_lshr_b32 s41, s2, 3
    s_add_u32 s40, s40, s41
    s_lshl_b32 s40, s40, 6
    s_and_b32 s41, s34, 1
    s_lshl_b32 s41, s41, 5
    s_add_u32 s40, s40, s41
    v_lshrrev_b32 v210, 1, v252
    v_mul_u32_u24 v210, 3584, v210
    s_mov_b32 s45, 114688
    s_branch L_moe_pre_go
L_moe_pre_d:
    s_sub_u32 s39, s2, 56
    s_mul_i32 s40, s34, 401408
    s_add_u32 s64, s32, s40
    s_addc_u32 s65, s33, 0
    s_mov_b32 s66, 401408
    s_mov_b32 s67, 0x20000
    s_and_b32 s47, s39, 7
    s_lshr_b32 s41, s39, 3
    s_lshl_b32 s42, s47, 2
    s_mul_i32 s43, s47, 3
    s_add_u32 s43, s43, 4
    s_cmp_lt_u32 s47, 4
    s_cselect_b32 s47, s42, s43
    s_add_u32 s47, s47, s41
    s_lshl_b32 s40, s47, 5
    v_lshrrev_b32 v210, 1, v252
    v_mul_u32_u24 v210, 896, v210
    s_mov_b32 s45, 28672
L_moe_pre_go:
    v_and_b32 v211, 1, v252
    v_lshl_add_u32 v210, v211, 4, v210
    v_add_u32 v210, s40, v210
    s_mul_i32 s46, s34, 14336
    s_mov_b32 s28, s16
    s_mov_b32 s29, s17
    s_mov_b32 s30, s18
    s_mov_b32 s31, s19
    s_mov_b32 s16, s20
    s_mov_b32 s17, s21
    s_mov_b32 s18, s22
    s_mov_b32 s19, s23
    s_add_u32 s20, s24, 65536
    s_addc_u32 s21, s25, 0
    s_mov_b32 s22, 28672
    s_mov_b32 s23, 0x20000
    s_cmp_ge_u32 s2, 56
    s_cbranch_scc1 L_moe_d
    v_and_b32 v16, 7, v1
    v_cmp_eq_u32 s[48:49], 0, v16
    v_cmp_eq_u32 s[50:51], 1, v16
    v_cmp_eq_u32 s[52:53], 2, v16
    v_cmp_eq_u32 s[54:55], 3, v16
    v_cmp_eq_u32 s[56:57], 4, v16
    v_cmp_eq_u32 s[58:59], 5, v16
    v_cmp_eq_u32 s[60:61], 6, v16
    v_cmp_eq_u32 s[62:63], 7, v16
    v_max_u32 v16, v8, v9
    v_min_u32 v9, v8, v9
    v_mov_b32 v8, v16
    v_max_u32 v16, v10, v11
    v_min_u32 v11, v10, v11
    v_mov_b32 v10, v16
    v_max_u32 v16, v12, v13
    v_min_u32 v13, v12, v13
    v_mov_b32 v12, v16
    v_max_u32 v16, v14, v15
    v_min_u32 v15, v14, v15
    v_mov_b32 v14, v16
    v_max_u32 v16, v8, v10
    v_min_u32 v10, v8, v10
    v_mov_b32 v8, v16
    v_max_u32 v16, v9, v11
    v_min_u32 v11, v9, v11
    v_mov_b32 v9, v16
    v_max_u32 v16, v12, v14
    v_min_u32 v14, v12, v14
    v_mov_b32 v12, v16
    v_max_u32 v16, v13, v15
    v_min_u32 v15, v13, v15
    v_mov_b32 v13, v16
    v_max_u32 v16, v9, v10
    v_min_u32 v10, v9, v10
    v_mov_b32 v9, v16
    v_max_u32 v16, v13, v14
    v_min_u32 v14, v13, v14
    v_mov_b32 v13, v16
    v_max_u32 v16, v8, v12
    v_min_u32 v12, v8, v12
    v_mov_b32 v8, v16
    v_max_u32 v16, v11, v15
    v_min_u32 v15, v11, v15
    v_mov_b32 v11, v16
    v_max_u32 v16, v9, v13
    v_min_u32 v13, v9, v13
    v_mov_b32 v9, v16
    v_max_u32 v16, v10, v14
    v_min_u32 v14, v10, v14
    v_mov_b32 v10, v16
    v_max_u32 v16, v9, v12
    v_min_u32 v12, v9, v12
    v_mov_b32 v9, v16
    v_max_u32 v16, v11, v14
    v_min_u32 v14, v11, v14
    v_mov_b32 v11, v16
    v_max_u32 v16, v10, v12
    v_min_u32 v12, v10, v12
    v_mov_b32 v10, v16
    v_max_u32 v16, v11, v13
    v_min_u32 v13, v11, v13
    v_mov_b32 v11, v16
    v_max_u32 v16, v11, v12
    v_min_u32 v12, v11, v12
    v_mov_b32 v11, v16
    v_mov_b32 v17, 0
    v_mov_b32 v16, v8
    s_nop 1
    v_max_u32_dpp v16, v16, v16 row_ror:1 row_mask:0xf bank_mask:0xf
    s_mov_b32 s44, 0
    s_add_u32 m0, s46, 0
    s_nop 0
    buffer_load_dwordx4 v210, s[64:67], s44 offen lds
    s_nop 1
    v_max_u32_dpp v16, v16, v16 row_ror:2 row_mask:0xf bank_mask:0xf
    s_add_u32 s44, s44, s45
    s_add_u32 m0, s46, 1024
    s_nop 0
    buffer_load_dwordx4 v210, s[64:67], s44 offen lds
    s_nop 1
    v_max_u32_dpp v16, v16, v16 row_ror:4 row_mask:0xf bank_mask:0xf
    s_add_u32 s44, s44, s45
    s_add_u32 m0, s46, 2048
    s_nop 0
    buffer_load_dwordx4 v210, s[64:67], s44 offen lds
    s_nop 1
    v_max_u32_dpp v16, v16, v16 row_ror:8 row_mask:0xf bank_mask:0xf
    v_cndmask_b32_e64 v17, v17, v16, s[48:49]
    v_cmp_eq_u32 vcc, v8, v16
    s_nop 1
    v_cndmask_b32 v8, v8, v9, vcc
    v_mov_b32 v16, v8
    v_cndmask_b32 v9, v9, v10, vcc
    v_cndmask_b32 v10, v10, v11, vcc
    v_max_u32_dpp v16, v16, v16 row_ror:1 row_mask:0xf bank_mask:0xf
    s_add_u32 s44, s44, s45
    s_add_u32 m0, s46, 3072
    s_nop 0
    buffer_load_dwordx4 v210, s[64:67], s44 offen lds
    v_cndmask_b32 v11, v11, v12, vcc
    v_cndmask_b32 v12, v12, v13, vcc
    v_max_u32_dpp v16, v16, v16 row_ror:2 row_mask:0xf bank_mask:0xf
    v_cndmask_b32 v13, v13, v14, vcc
    v_cndmask_b32 v14, v14, v15, vcc
    v_max_u32_dpp v16, v16, v16 row_ror:4 row_mask:0xf bank_mask:0xf
    s_nop 1
    v_max_u32_dpp v16, v16, v16 row_ror:8 row_mask:0xf bank_mask:0xf
    v_cndmask_b32_e64 v17, v17, v16, s[50:51]
    v_cmp_eq_u32 vcc, v8, v16
    s_nop 1
    v_cndmask_b32 v8, v8, v9, vcc
    v_mov_b32 v16, v8
    v_cndmask_b32 v9, v9, v10, vcc
    v_cndmask_b32 v10, v10, v11, vcc
    v_max_u32_dpp v16, v16, v16 row_ror:1 row_mask:0xf bank_mask:0xf
    v_cndmask_b32 v11, v11, v12, vcc
    v_cndmask_b32 v12, v12, v13, vcc
    v_max_u32_dpp v16, v16, v16 row_ror:2 row_mask:0xf bank_mask:0xf
    s_add_u32 s44, s44, s45
    s_add_u32 m0, s46, 4096
    s_nop 0
    buffer_load_dwordx4 v210, s[64:67], s44 offen lds
    v_cndmask_b32 v13, v13, v14, vcc
    s_nop 0
    v_max_u32_dpp v16, v16, v16 row_ror:4 row_mask:0xf bank_mask:0xf
    s_nop 1
    v_max_u32_dpp v16, v16, v16 row_ror:8 row_mask:0xf bank_mask:0xf
    v_cndmask_b32_e64 v17, v17, v16, s[52:53]
    v_cmp_eq_u32 vcc, v8, v16
    s_nop 1
    v_cndmask_b32 v8, v8, v9, vcc
    v_mov_b32 v16, v8
    v_cndmask_b32 v9, v9, v10, vcc
    v_cndmask_b32 v10, v10, v11, vcc
    v_max_u32_dpp v16, v16, v16 row_ror:1 row_mask:0xf bank_mask:0xf
    v_cndmask_b32 v11, v11, v12, vcc
    v_cndmask_b32 v12, v12, v13, vcc
    v_max_u32_dpp v16, v16, v16 row_ror:2 row_mask:0xf bank_mask:0xf
    s_nop 1
    v_max_u32_dpp v16, v16, v16 row_ror:4 row_mask:0xf bank_mask:0xf
    s_add_u32 s44, s44, s45
    s_add_u32 m0, s46, 5120
    s_nop 0
    buffer_load_dwordx4 v210, s[64:67], s44 offen lds
    s_nop 1
    v_max_u32_dpp v16, v16, v16 row_ror:8 row_mask:0xf bank_mask:0xf
    v_cndmask_b32_e64 v17, v17, v16, s[54:55]
    v_cmp_eq_u32 vcc, v8, v16
    s_nop 1
    v_cndmask_b32 v8, v8, v9, vcc
    v_mov_b32 v16, v8
    v_cndmask_b32 v9, v9, v10, vcc
    v_cndmask_b32 v10, v10, v11, vcc
    v_max_u32_dpp v16, v16, v16 row_ror:1 row_mask:0xf bank_mask:0xf
    v_cndmask_b32 v11, v11, v12, vcc
    s_nop 0
    v_max_u32_dpp v16, v16, v16 row_ror:2 row_mask:0xf bank_mask:0xf
    s_nop 1
    v_max_u32_dpp v16, v16, v16 row_ror:4 row_mask:0xf bank_mask:0xf
    s_nop 1
    v_max_u32_dpp v16, v16, v16 row_ror:8 row_mask:0xf bank_mask:0xf
    v_cndmask_b32_e64 v17, v17, v16, s[56:57]
    v_cmp_eq_u32 vcc, v8, v16
    s_nop 1
    v_cndmask_b32 v8, v8, v9, vcc
    v_mov_b32 v16, v8
    v_cndmask_b32 v9, v9, v10, vcc
    v_cndmask_b32 v10, v10, v11, vcc
    v_max_u32_dpp v16, v16, v16 row_ror:1 row_mask:0xf bank_mask:0xf
    s_add_u32 s44, s44, s45
    s_add_u32 m0, s46, 6144
    s_nop 0
    buffer_load_dwordx4 v210, s[64:67], s44 offen lds
    s_nop 1
    v_max_u32_dpp v16, v16, v16 row_ror:2 row_mask:0xf bank_mask:0xf
    s_nop 1
    v_max_u32_dpp v16, v16, v16 row_ror:4 row_mask:0xf bank_mask:0xf
    s_nop 1
    v_max_u32_dpp v16, v16, v16 row_ror:8 row_mask:0xf bank_mask:0xf
    v_cndmask_b32_e64 v17, v17, v16, s[58:59]
    v_cmp_eq_u32 vcc, v8, v16
    s_nop 1
    v_cndmask_b32 v8, v8, v9, vcc
    v_mov_b32 v16, v8
    v_cndmask_b32 v9, v9, v10, vcc
    s_nop 0
    v_max_u32_dpp v16, v16, v16 row_ror:1 row_mask:0xf bank_mask:0xf
    s_nop 1
    v_max_u32_dpp v16, v16, v16 row_ror:2 row_mask:0xf bank_mask:0xf
    s_add_u32 s44, s44, s45
    s_add_u32 m0, s46, 7168
    s_nop 0
    buffer_load_dwordx4 v210, s[64:67], s44 offen lds
    s_nop 1
    v_max_u32_dpp v16, v16, v16 row_ror:4 row_mask:0xf bank_mask:0xf
    s_nop 1
    v_max_u32_dpp v16, v16, v16 row_ror:8 row_mask:0xf bank_mask:0xf
    v_cndmask_b32_e64 v17, v17, v16, s[60:61]
    v_cmp_eq_u32 vcc, v8, v16
    s_nop 1
    v_cndmask_b32 v8, v8, v9, vcc
    v_mov_b32 v16, v8
    s_nop 1
    v_max_u32_dpp v16, v16, v16 row_ror:1 row_mask:0xf bank_mask:0xf
    s_nop 1
    v_max_u32_dpp v16, v16, v16 row_ror:2 row_mask:0xf bank_mask:0xf
    s_nop 1
    v_max_u32_dpp v16, v16, v16 row_ror:4 row_mask:0xf bank_mask:0xf
    s_nop 1
    v_max_u32_dpp v16, v16, v16 row_ror:8 row_mask:0xf bank_mask:0xf
    v_cndmask_b32_e64 v17, v17, v16, s[62:63]
    v_lshrrev_b32 v16, 4, v0
    v_lshlrev_b32 v16, 5, v16
    v_and_b32 v18, 7, v1
    v_lshl_add_u32 v16, v18, 2, v16
    ds_write_b32 v16, v17 offset:57344
    s_waitcnt lgkmcnt(0)
    s_barrier
    v_and_b32 v16, 15, v1
    v_lshlrev_b32 v16, 5, v16
    ds_read_b128 v[8:11], v16 offset:57344
    ds_read_b128 v[12:15], v16 offset:57360
    v_mov_b32 v17, 0
    s_waitcnt lgkmcnt(0)
    v_mov_b32 v16, v8
    s_nop 1
    v_max_u32_dpp v16, v16, v16 row_ror:1 row_mask:0xf bank_mask:0xf
    s_add_u32 s44, s44, s45
    s_add_u32 m0, s46, 8192
    s_nop 0
    buffer_load_dwordx4 v210, s[64:67], s44 offen lds
    s_nop 1
    v_max_u32_dpp v16, v16, v16 row_ror:2 row_mask:0xf bank_mask:0xf
    s_nop 1
    v_max_u32_dpp v16, v16, v16 row_ror:4 row_mask:0xf bank_mask:0xf
    s_nop 1
    v_max_u32_dpp v16, v16, v16 row_ror:8 row_mask:0xf bank_mask:0xf
    s_add_u32 s44, s44, s45
    s_add_u32 m0, s46, 9216
    s_nop 0
    buffer_load_dwordx4 v210, s[64:67], s44 offen lds
    v_cndmask_b32_e64 v17, v17, v16, s[48:49]
    v_cmp_eq_u32 vcc, v8, v16
    s_nop 1
    v_cndmask_b32 v8, v8, v9, vcc
    v_mov_b32 v16, v8
    v_cndmask_b32 v9, v9, v10, vcc
    v_cndmask_b32 v10, v10, v11, vcc
    v_max_u32_dpp v16, v16, v16 row_ror:1 row_mask:0xf bank_mask:0xf
    v_cndmask_b32 v11, v11, v12, vcc
    v_cndmask_b32 v12, v12, v13, vcc
    v_max_u32_dpp v16, v16, v16 row_ror:2 row_mask:0xf bank_mask:0xf
    v_cndmask_b32 v13, v13, v14, vcc
    v_cndmask_b32 v14, v14, v15, vcc
    v_max_u32_dpp v16, v16, v16 row_ror:4 row_mask:0xf bank_mask:0xf
    s_nop 1
    v_max_u32_dpp v16, v16, v16 row_ror:8 row_mask:0xf bank_mask:0xf
    v_cndmask_b32_e64 v17, v17, v16, s[50:51]
    v_cmp_eq_u32 vcc, v8, v16
    s_nop 1
    v_cndmask_b32 v8, v8, v9, vcc
    v_mov_b32 v16, v8
    v_cndmask_b32 v9, v9, v10, vcc
    v_cndmask_b32 v10, v10, v11, vcc
    v_max_u32_dpp v16, v16, v16 row_ror:1 row_mask:0xf bank_mask:0xf
    s_add_u32 s44, s44, s45
    s_add_u32 m0, s46, 10240
    s_nop 0
    buffer_load_dwordx4 v210, s[64:67], s44 offen lds
    v_cndmask_b32 v11, v11, v12, vcc
    v_cndmask_b32 v12, v12, v13, vcc
    v_max_u32_dpp v16, v16, v16 row_ror:2 row_mask:0xf bank_mask:0xf
    v_cndmask_b32 v13, v13, v14, vcc
    s_nop 0
    v_max_u32_dpp v16, v16, v16 row_ror:4 row_mask:0xf bank_mask:0xf
    s_nop 1
    v_max_u32_dpp v16, v16, v16 row_ror:8 row_mask:0xf bank_mask:0xf
    v_cndmask_b32_e64 v17, v17, v16, s[52:53]
    v_cmp_eq_u32 vcc, v8, v16
    s_nop 1
    v_cndmask_b32 v8, v8, v9, vcc
    v_mov_b32 v16, v8
    v_cndmask_b32 v9, v9, v10, vcc
    v_cndmask_b32 v10, v10, v11, vcc
    v_max_u32_dpp v16, v16, v16 row_ror:1 row_mask:0xf bank_mask:0xf
    s_add_u32 s44, s44, s45
    s_add_u32 m0, s46, 11264
    s_nop 0
    buffer_load_dwordx4 v210, s[64:67], s44 offen lds
    v_cndmask_b32 v11, v11, v12, vcc
    v_cndmask_b32 v12, v12, v13, vcc
    v_max_u32_dpp v16, v16, v16 row_ror:2 row_mask:0xf bank_mask:0xf
    s_nop 1
    v_max_u32_dpp v16, v16, v16 row_ror:4 row_mask:0xf bank_mask:0xf
    s_nop 1
    v_max_u32_dpp v16, v16, v16 row_ror:8 row_mask:0xf bank_mask:0xf
    v_cndmask_b32_e64 v17, v17, v16, s[54:55]
    v_cmp_eq_u32 vcc, v8, v16
    s_nop 1
    v_cndmask_b32 v8, v8, v9, vcc
    v_mov_b32 v16, v8
    v_cndmask_b32 v9, v9, v10, vcc
    v_cndmask_b32 v10, v10, v11, vcc
    v_max_u32_dpp v16, v16, v16 row_ror:1 row_mask:0xf bank_mask:0xf
    v_cndmask_b32 v11, v11, v12, vcc
    s_nop 0
    v_max_u32_dpp v16, v16, v16 row_ror:2 row_mask:0xf bank_mask:0xf
    s_nop 1
    v_max_u32_dpp v16, v16, v16 row_ror:4 row_mask:0xf bank_mask:0xf
    s_add_u32 s44, s44, s45
    s_add_u32 m0, s46, 12288
    s_nop 0
    buffer_load_dwordx4 v210, s[64:67], s44 offen lds
    s_nop 1
    v_max_u32_dpp v16, v16, v16 row_ror:8 row_mask:0xf bank_mask:0xf
    v_cndmask_b32_e64 v17, v17, v16, s[56:57]
    v_cmp_eq_u32 vcc, v8, v16
    s_nop 1
    v_cndmask_b32 v8, v8, v9, vcc
    v_mov_b32 v16, v8
    v_cndmask_b32 v9, v9, v10, vcc
    v_cndmask_b32 v10, v10, v11, vcc
    v_max_u32_dpp v16, v16, v16 row_ror:1 row_mask:0xf bank_mask:0xf
    s_nop 1
    v_max_u32_dpp v16, v16, v16 row_ror:2 row_mask:0xf bank_mask:0xf
    s_nop 1
    v_max_u32_dpp v16, v16, v16 row_ror:4 row_mask:0xf bank_mask:0xf
    s_nop 1
    v_max_u32_dpp v16, v16, v16 row_ror:8 row_mask:0xf bank_mask:0xf
    v_cndmask_b32_e64 v17, v17, v16, s[58:59]
    v_cmp_eq_u32 vcc, v8, v16
    s_nop 1
    v_cndmask_b32 v8, v8, v9, vcc
    v_mov_b32 v16, v8
    v_cndmask_b32 v9, v9, v10, vcc
    s_nop 0
    v_max_u32_dpp v16, v16, v16 row_ror:1 row_mask:0xf bank_mask:0xf
    s_add_u32 s44, s44, s45
    s_add_u32 m0, s46, 13312
    s_nop 0
    buffer_load_dwordx4 v210, s[64:67], s44 offen lds
    s_nop 1
    v_max_u32_dpp v16, v16, v16 row_ror:2 row_mask:0xf bank_mask:0xf
    s_nop 1
    v_max_u32_dpp v16, v16, v16 row_ror:4 row_mask:0xf bank_mask:0xf
    s_nop 1
    v_max_u32_dpp v16, v16, v16 row_ror:8 row_mask:0xf bank_mask:0xf
    v_cndmask_b32_e64 v17, v17, v16, s[60:61]
    v_cmp_eq_u32 vcc, v8, v16
    s_nop 1
    v_cndmask_b32 v8, v8, v9, vcc
    v_mov_b32 v16, v8
    s_nop 1
    v_max_u32_dpp v16, v16, v16 row_ror:1 row_mask:0xf bank_mask:0xf
    s_nop 1
    v_max_u32_dpp v16, v16, v16 row_ror:2 row_mask:0xf bank_mask:0xf
    s_nop 1
    v_max_u32_dpp v16, v16, v16 row_ror:4 row_mask:0xf bank_mask:0xf
    s_nop 1
    v_max_u32_dpp v16, v16, v16 row_ror:8 row_mask:0xf bank_mask:0xf
    v_cndmask_b32_e64 v17, v17, v16, s[62:63]
    v_and_b32 v20, 0xffff, v17
    v_sub_u32 v20, 2047, v20
    v_mul_u32_u24 v22, 896, v20
    v_lshrrev_b32 v23, 4, v1
    v_lshl_add_u32 v22, v23, 4, v22
    buffer_load_dwordx4 v[32:35], v22, s[16:19], 0 offen offset:0 sc1
    buffer_load_dwordx4 v[36:39], v22, s[16:19], 0 offen offset:64 sc1
    buffer_load_dwordx4 v[40:43], v22, s[16:19], 0 offen offset:128 sc1
    buffer_load_dwordx4 v[44:47], v22, s[16:19], 0 offen offset:192 sc1
    buffer_load_dwordx4 v[48:51], v22, s[16:19], 0 offen offset:256 sc1
    buffer_load_dwordx4 v[52:55], v22, s[16:19], 0 offen offset:320 sc1
    buffer_load_dwordx4 v[56:59], v22, s[16:19], 0 offen offset:384 sc1
    buffer_load_dwordx4 v[60:63], v22, s[16:19], 0 offen offset:448 sc1
    buffer_load_dwordx4 v[64:67], v22, s[16:19], 0 offen offset:512 sc1
    buffer_load_dwordx4 v[68:71], v22, s[16:19], 0 offen offset:576 sc1
    buffer_load_dwordx4 v[72:75], v22, s[16:19], 0 offen offset:640 sc1
    buffer_load_dwordx4 v[76:79], v22, s[16:19], 0 offen offset:704 sc1
    buffer_load_dwordx4 v[80:83], v22, s[16:19], 0 offen offset:768 sc1
    buffer_load_dwordx4 v[84:87], v22, s[16:19], 0 offen offset:832 sc1
    v_lshrrev_b32 v28, 4, v1
    v_lshlrev_b32 v28, 3, v28
    v_bfe_u32 v29, v1, 2, 2
    v_add_u32 v28, v28, v29
    v_lshlrev_b32 v28, 5, v28
    v_and_b32 v29, 3, v1
    v_lshl_add_u32 v28, v29, 3, v28
    v_add_u32 v28, s46, v28
    s_waitcnt vmcnt(14)
    ds_read_b64_tr_b16 v[96:97], v28 offset:0
    ds_read_b64_tr_b16 v[98:99], v28 offset:128
    ds_read_b64_tr_b16 v[100:101], v28 offset:1024
    ds_read_b64_tr_b16 v[102:103], v28 offset:1152
    ds_read_b64_tr_b16 v[104:105], v28 offset:2048
    ds_read_b64_tr_b16 v[106:107], v28 offset:2176
    ds_read_b64_tr_b16 v[108:109], v28 offset:3072
    ds_read_b64_tr_b16 v[110:111], v28 offset:3200
    ds_read_b64_tr_b16 v[112:113], v28 offset:4096
    ds_read_b64_tr_b16 v[114:115], v28 offset:4224
    ds_read_b64_tr_b16 v[116:117], v28 offset:5120
    ds_read_b64_tr_b16 v[118:119], v28 offset:5248
    ds_read_b64_tr_b16 v[120:121], v28 offset:6144
    ds_read_b64_tr_b16 v[122:123], v28 offset:6272
    ds_read_b64_tr_b16 v[124:125], v28 offset:7168
    ds_read_b64_tr_b16 v[126:127], v28 offset:7296
    ds_read_b64_tr_b16 v[128:129], v28 offset:8192
    ds_read_b64_tr_b16 v[130:131], v28 offset:8320
    ds_read_b64_tr_b16 v[132:133], v28 offset:9216
    ds_read_b64_tr_b16 v[134:135], v28 offset:9344
    ds_read_b64_tr_b16 v[136:137], v28 offset:10240
    ds_read_b64_tr_b16 v[138:139], v28 offset:10368
    ds_read_b64_tr_b16 v[140:141], v28 offset:11264
    ds_read_b64_tr_b16 v[142:143], v28 offset:11392
    ds_read_b64_tr_b16 v[144:145], v28 offset:12288
    ds_read_b64_tr_b16 v[146:147], v28 offset:12416
    ds_read_b64_tr_b16 v[148:149], v28 offset:13312
    ds_read_b64_tr_b16 v[150:151], v28 offset:13440
    s_waitcnt vmcnt(0) lgkmcnt(0)
    v_mfma_f32_16x16x32_bf16 v[160:163], v[32:35], v[96:99], 0
    v_mfma_f32_16x16x32_bf16 v[160:163], v[36:39], v[100:103], v[160:163]
    v_mfma_f32_16x16x32_bf16 v[160:163], v[40:43], v[104:107], v[160:163]
    v_mfma_f32_16x16x32_bf16 v[160:163], v[44:47], v[108:111], v[160:163]
    v_mfma_f32_16x16x32_bf16 v[160:163], v[48:51], v[112:115], v[160:163]
    v_mfma_f32_16x16x32_bf16 v[160:163], v[52:55], v[116:119], v[160:163]
    v_mfma_f32_16x16x32_bf16 v[160:163], v[56:59], v[120:123], v[160:163]
    v_mfma_f32_16x16x32_bf16 v[160:163], v[60:63], v[124:127], v[160:163]
    v_mfma_f32_16x16x32_bf16 v[160:163], v[64:67], v[128:131], v[160:163]
    v_mfma_f32_16x16x32_bf16 v[160:163], v[68:71], v[132:135], v[160:163]
    v_mfma_f32_16x16x32_bf16 v[160:163], v[72:75], v[136:139], v[160:163]
    v_mfma_f32_16x16x32_bf16 v[160:163], v[76:79], v[140:143], v[160:163]
    v_mfma_f32_16x16x32_bf16 v[160:163], v[80:83], v[144:147], v[160:163]
    v_mfma_f32_16x16x32_bf16 v[160:163], v[84:87], v[148:151], v[160:163]
    s_nop 7
    v_cvt_pk_bf16_f32 v164, v160, v161
    v_cvt_pk_bf16_f32 v165, v162, v163
    v_lshlrev_b32 v160, 16, v164
    v_and_b32 v161, 0xffff0000, v164
    v_lshlrev_b32 v162, 16, v165
    v_and_b32 v163, 0xffff0000, v165
    s_and_b32 s41, s3, 1
    s_lshl_b32 s41, s41, 10
    v_lshlrev_b32 v30, 4, v1
    v_add_u32 v30, s41, v30
    v_add_u32 v30, 57856, v30
    s_cmp_ge_u32 s3, 2
    s_cbranch_scc0 L_k34_gate
    ds_write_b128 v30, v[160:163]
    s_waitcnt lgkmcnt(0)
    s_barrier
    s_nop 0
    s_branch L_st_end_k34
L_k34_gate:
    v_mul_f32 v166, 0xbfb8aa3b, v160
    v_mul_f32 v167, 0xbfb8aa3b, v161
    v_mul_f32 v168, 0xbfb8aa3b, v162
    v_mul_f32 v169, 0xbfb8aa3b, v163
    v_exp_f32 v166, v166
    v_exp_f32 v167, v167
    v_exp_f32 v168, v168
    v_exp_f32 v169, v169
    v_add_f32 v166, 1.0, v166
    v_add_f32 v167, 1.0, v167
    v_add_f32 v168, 1.0, v168
    v_add_f32 v169, 1.0, v169
    v_rcp_f32 v166, v166
    v_rcp_f32 v167, v167
    v_rcp_f32 v168, v168
    v_rcp_f32 v169, v169
    s_nop 0
    v_mul_f32 v160, v160, v166
    v_mul_f32 v161, v161, v167
    v_mul_f32 v162, v162, v168
    v_mul_f32 v163, v163, v169
    v_cvt_pk_bf16_f32 v164, v160, v161
    v_cvt_pk_bf16_f32 v165, v162, v163
    v_lshlrev_b32 v160, 16, v164
    v_and_b32 v161, 0xffff0000, v164
    v_lshlrev_b32 v162, 16, v165
    v_and_b32 v163, 0xffff0000, v165
    s_waitcnt lgkmcnt(0)
    s_barrier
    ds_read_b128 v[164:167], v30
    s_waitcnt lgkmcnt(0)
    v_mul_f32 v160, v160, v164
    v_mul_f32 v161, v161, v165
    v_mul_f32 v162, v162, v166
    v_mul_f32 v163, v163, v167
    v_cvt_pk_bf16_f32 v160, v160, 0
    v_cvt_pk_bf16_f32 v161, v161, 0
    v_cvt_pk_bf16_f32 v162, v162, 0
    v_cvt_pk_bf16_f32 v163, v163, 0
    s_nop 1
    v_mov_b32_dpp v164, v160 quad_perm:[1,0,3,2] row_mask:0xf bank_mask:0xf
    v_mov_b32_dpp v165, v161 quad_perm:[1,0,3,2] row_mask:0xf bank_mask:0xf
    v_mov_b32_dpp v166, v162 quad_perm:[1,0,3,2] row_mask:0xf bank_mask:0xf
    v_mov_b32_dpp v167, v163 quad_perm:[1,0,3,2] row_mask:0xf bank_mask:0xf
    v_lshl_or_b32 v160, v164, 16, v160
    v_lshl_or_b32 v161, v165, 16, v161
    v_lshl_or_b32 v162, v166, 16, v162
    v_lshl_or_b32 v163, v167, 16, v163
    v_mov_b32 v168, 0x7fff7fff
    v_cmp_eq_u32 vcc, -1, v160
    s_nop 1
    v_cndmask_b32 v160, v160, v168, vcc
    v_cmp_eq_u32 vcc, -1, v161
    s_nop 1
    v_cndmask_b32 v161, v161, v168, vcc
    v_cmp_eq_u32 vcc, -1, v162
    s_nop 1
    v_cndmask_b32 v162, v162, v168, vcc
    v_cmp_eq_u32 vcc, -1, v163
    s_nop 1
    v_cndmask_b32 v163, v163, v168, vcc
    v_lshrrev_b32 v23, 4, v1
    v_mul_u32_u24 v24, 14336, v23
    v_and_b32 v25, 15, v1
    v_lshl_add_u32 v24, v25, 1, v24
    v_add_u32 v24, s40, v24
    v_mov_b32 v27, 0x40000000
    v_and_b32 v25, 0x21, v1
    v_cmp_eq_u32 vcc, 0, v25
    s_mov_b32 s41, 7168
    s_nop 0
    v_cndmask_b32 v24, v27, v24, vcc
    buffer_store_dword v160, v24, s[20:23], 0 offen sc1
    buffer_store_dword v161, v24, s[20:23], 0 offen offset:3584 sc1
    buffer_store_dword v162, v24, s[20:23], s41 offen sc1
    buffer_store_dword v163, v24, s[20:23], s41 offen offset:3584 sc1
    s_branch L_st_end_k34
    s_waitcnt vmcnt(0)
    s_barrier
    s_cmp_lg_u32 s3, 0
    s_cbranch_scc1 L_st_end_k34
    v_mov_b32 v24, 0
    v_mov_b32 v25, 1
    v_cmp_eq_u32 vcc, 0, v1
    s_and_saveexec_b64 s[42:43], vcc
    buffer_atomic_add v25, v24, s[56:59], 0 offen sc0 sc1
    s_waitcnt vmcnt(0)
    v_readfirstlane_b32 s41, v25
    s_cmp_eq_u32 s41, 55
    s_cbranch_scc0 L_k34_notlast
    v_mov_b32 v25, 1
    buffer_store_dword v25, v24, s[56:59], 0 offen offset:128 sc1
L_k34_notlast:
    s_mov_b64 exec, s[42:43]
    s_branch L_st_end_k34
L_moe_d:
    v_and_b32 v25, 15, v1
    s_lshl_b32 s41, s47, 6
    v_lshl_add_u32 v26, v25, 2, s41
    v_add_u32 v26, 64768, v26
    ds_read_b32 v31, v26
    s_waitcnt lgkmcnt(0)
    v_and_b32 v16, 7, v1
    v_cmp_eq_u32 s[48:49], 0, v16
    v_cmp_eq_u32 s[50:51], 1, v16
    v_cmp_eq_u32 s[52:53], 2, v16
    v_cmp_eq_u32 s[54:55], 3, v16
    v_cmp_eq_u32 s[56:57], 4, v16
    v_cmp_eq_u32 s[58:59], 5, v16
    v_cmp_eq_u32 s[60:61], 6, v16
    v_cmp_eq_u32 s[62:63], 7, v16
    v_max_u32 v16, v8, v9
    v_min_u32 v9, v8, v9
    v_mov_b32 v8, v16
    v_max_u32 v16, v10, v11
    v_min_u32 v11, v10, v11
    v_mov_b32 v10, v16
    v_max_u32 v16, v12, v13
    v_min_u32 v13, v12, v13
    v_mov_b32 v12, v16
    v_max_u32 v16, v14, v15
    v_min_u32 v15, v14, v15
    v_mov_b32 v14, v16
    v_max_u32 v16, v8, v10
    v_min_u32 v10, v8, v10
    v_mov_b32 v8, v16
    v_max_u32 v16, v9, v11
    v_min_u32 v11, v9, v11
    v_mov_b32 v9, v16
    v_max_u32 v16, v12, v14
    v_min_u32 v14, v12, v14
    v_mov_b32 v12, v16
    v_max_u32 v16, v13, v15
    v_min_u32 v15, v13, v15
    v_mov_b32 v13, v16
    v_max_u32 v16, v9, v10
    v_min_u32 v10, v9, v10
    v_mov_b32 v9, v16
    v_max_u32 v16, v13, v14
    v_min_u32 v14, v13, v14
    v_mov_b32 v13, v16
    v_max_u32 v16, v8, v12
    v_min_u32 v12, v8, v12
    v_mov_b32 v8, v16
    v_max_u32 v16, v11, v15
    v_min_u32 v15, v11, v15
    v_mov_b32 v11, v16
    v_max_u32 v16, v9, v13
    v_min_u32 v13, v9, v13
    v_mov_b32 v9, v16
    v_max_u32 v16, v10, v14
    v_min_u32 v14, v10, v14
    v_mov_b32 v10, v16
    v_max_u32 v16, v9, v12
    v_min_u32 v12, v9, v12
    v_mov_b32 v9, v16
    v_max_u32 v16, v11, v14
    v_min_u32 v14, v11, v14
    v_mov_b32 v11, v16
    v_max_u32 v16, v10, v12
    v_min_u32 v12, v10, v12
    v_mov_b32 v10, v16
    v_max_u32 v16, v11, v13
    v_min_u32 v13, v11, v13
    v_mov_b32 v11, v16
    v_max_u32 v16, v11, v12
    v_min_u32 v12, v11, v12
    v_mov_b32 v11, v16
    v_mov_b32 v17, 0
    v_mov_b32 v16, v8
    s_nop 1
    v_max_u32_dpp v16, v16, v16 row_ror:1 row_mask:0xf bank_mask:0xf
    s_mov_b32 s44, 0
    s_add_u32 m0, s46, 0
    s_nop 0
    buffer_load_dwordx4 v210, s[64:67], s44 offen lds
    s_nop 1
    v_max_u32_dpp v16, v16, v16 row_ror:2 row_mask:0xf bank_mask:0xf
    s_add_u32 s44, s44, s45
    s_add_u32 m0, s46, 1024
    s_nop 0
    buffer_load_dwordx4 v210, s[64:67], s44 offen lds
    s_nop 1
    v_max_u32_dpp v16, v16, v16 row_ror:4 row_mask:0xf bank_mask:0xf
    s_add_u32 s44, s44, s45
    s_add_u32 m0, s46, 2048
    s_nop 0
    buffer_load_dwordx4 v210, s[64:67], s44 offen lds
    s_nop 1
    v_max_u32_dpp v16, v16, v16 row_ror:8 row_mask:0xf bank_mask:0xf
    v_cndmask_b32_e64 v17, v17, v16, s[48:49]
    v_cmp_eq_u32 vcc, v8, v16
    s_nop 1
    v_cndmask_b32 v8, v8, v9, vcc
    v_mov_b32 v16, v8
    v_cndmask_b32 v9, v9, v10, vcc
    v_cndmask_b32 v10, v10, v11, vcc
    v_max_u32_dpp v16, v16, v16 row_ror:1 row_mask:0xf bank_mask:0xf
    s_add_u32 s44, s44, s45
    s_add_u32 m0, s46, 3072
    s_nop 0
    buffer_load_dwordx4 v210, s[64:67], s44 offen lds
    v_cndmask_b32 v11, v11, v12, vcc
    v_cndmask_b32 v12, v12, v13, vcc
    v_max_u32_dpp v16, v16, v16 row_ror:2 row_mask:0xf bank_mask:0xf
    v_cndmask_b32 v13, v13, v14, vcc
    v_cndmask_b32 v14, v14, v15, vcc
    v_max_u32_dpp v16, v16, v16 row_ror:4 row_mask:0xf bank_mask:0xf
    s_nop 1
    v_max_u32_dpp v16, v16, v16 row_ror:8 row_mask:0xf bank_mask:0xf
    v_cndmask_b32_e64 v17, v17, v16, s[50:51]
    v_cmp_eq_u32 vcc, v8, v16
    s_nop 1
    v_cndmask_b32 v8, v8, v9, vcc
    v_mov_b32 v16, v8
    v_cndmask_b32 v9, v9, v10, vcc
    v_cndmask_b32 v10, v10, v11, vcc
    v_max_u32_dpp v16, v16, v16 row_ror:1 row_mask:0xf bank_mask:0xf
    v_cndmask_b32 v11, v11, v12, vcc
    v_cndmask_b32 v12, v12, v13, vcc
    v_max_u32_dpp v16, v16, v16 row_ror:2 row_mask:0xf bank_mask:0xf
    s_add_u32 s44, s44, s45
    s_add_u32 m0, s46, 4096
    s_nop 0
    buffer_load_dwordx4 v210, s[64:67], s44 offen lds
    v_cndmask_b32 v13, v13, v14, vcc
    s_nop 0
    v_max_u32_dpp v16, v16, v16 row_ror:4 row_mask:0xf bank_mask:0xf
    s_nop 1
    v_max_u32_dpp v16, v16, v16 row_ror:8 row_mask:0xf bank_mask:0xf
    v_cndmask_b32_e64 v17, v17, v16, s[52:53]
    v_cmp_eq_u32 vcc, v8, v16
    s_nop 1
    v_cndmask_b32 v8, v8, v9, vcc
    v_mov_b32 v16, v8
    v_cndmask_b32 v9, v9, v10, vcc
    v_cndmask_b32 v10, v10, v11, vcc
    v_max_u32_dpp v16, v16, v16 row_ror:1 row_mask:0xf bank_mask:0xf
    v_cndmask_b32 v11, v11, v12, vcc
    v_cndmask_b32 v12, v12, v13, vcc
    v_max_u32_dpp v16, v16, v16 row_ror:2 row_mask:0xf bank_mask:0xf
    s_nop 1
    v_max_u32_dpp v16, v16, v16 row_ror:4 row_mask:0xf bank_mask:0xf
    s_add_u32 s44, s44, s45
    s_add_u32 m0, s46, 5120
    s_nop 0
    buffer_load_dwordx4 v210, s[64:67], s44 offen lds
    s_nop 1
    v_max_u32_dpp v16, v16, v16 row_ror:8 row_mask:0xf bank_mask:0xf
    v_cndmask_b32_e64 v17, v17, v16, s[54:55]
    v_cmp_eq_u32 vcc, v8, v16
    s_nop 1
    v_cndmask_b32 v8, v8, v9, vcc
    v_mov_b32 v16, v8
    v_cndmask_b32 v9, v9, v10, vcc
    v_cndmask_b32 v10, v10, v11, vcc
    v_max_u32_dpp v16, v16, v16 row_ror:1 row_mask:0xf bank_mask:0xf
    v_cndmask_b32 v11, v11, v12, vcc
    s_nop 0
    v_max_u32_dpp v16, v16, v16 row_ror:2 row_mask:0xf bank_mask:0xf
    s_nop 1
    v_max_u32_dpp v16, v16, v16 row_ror:4 row_mask:0xf bank_mask:0xf
    s_nop 1
    v_max_u32_dpp v16, v16, v16 row_ror:8 row_mask:0xf bank_mask:0xf
    v_cndmask_b32_e64 v17, v17, v16, s[56:57]
    v_cmp_eq_u32 vcc, v8, v16
    s_nop 1
    v_cndmask_b32 v8, v8, v9, vcc
    v_mov_b32 v16, v8
    v_cndmask_b32 v9, v9, v10, vcc
    v_cndmask_b32 v10, v10, v11, vcc
    v_max_u32_dpp v16, v16, v16 row_ror:1 row_mask:0xf bank_mask:0xf
    s_add_u32 s44, s44, s45
    s_add_u32 m0, s46, 6144
    s_nop 0
    buffer_load_dwordx4 v210, s[64:67], s44 offen lds
    s_nop 1
    v_max_u32_dpp v16, v16, v16 row_ror:2 row_mask:0xf bank_mask:0xf
    s_nop 1
    v_max_u32_dpp v16, v16, v16 row_ror:4 row_mask:0xf bank_mask:0xf
    s_nop 1
    v_max_u32_dpp v16, v16, v16 row_ror:8 row_mask:0xf bank_mask:0xf
    v_cndmask_b32_e64 v17, v17, v16, s[58:59]
    v_cmp_eq_u32 vcc, v8, v16
    s_nop 1
    v_cndmask_b32 v8, v8, v9, vcc
    v_mov_b32 v16, v8
    v_cndmask_b32 v9, v9, v10, vcc
    s_nop 0
    v_max_u32_dpp v16, v16, v16 row_ror:1 row_mask:0xf bank_mask:0xf
    s_nop 1
    v_max_u32_dpp v16, v16, v16 row_ror:2 row_mask:0xf bank_mask:0xf
    s_add_u32 s44, s44, s45
    s_add_u32 m0, s46, 7168
    s_nop 0
    buffer_load_dwordx4 v210, s[64:67], s44 offen lds
    s_nop 1
    v_max_u32_dpp v16, v16, v16 row_ror:4 row_mask:0xf bank_mask:0xf
    s_nop 1
    v_max_u32_dpp v16, v16, v16 row_ror:8 row_mask:0xf bank_mask:0xf
    v_cndmask_b32_e64 v17, v17, v16, s[60:61]
    v_cmp_eq_u32 vcc, v8, v16
    s_nop 1
    v_cndmask_b32 v8, v8, v9, vcc
    v_mov_b32 v16, v8
    s_nop 1
    v_max_u32_dpp v16, v16, v16 row_ror:1 row_mask:0xf bank_mask:0xf
    s_nop 1
    v_max_u32_dpp v16, v16, v16 row_ror:2 row_mask:0xf bank_mask:0xf
    s_nop 1
    v_max_u32_dpp v16, v16, v16 row_ror:4 row_mask:0xf bank_mask:0xf
    s_nop 1
    v_max_u32_dpp v16, v16, v16 row_ror:8 row_mask:0xf bank_mask:0xf
    v_cndmask_b32_e64 v17, v17, v16, s[62:63]
    v_lshrrev_b32 v16, 4, v0
    v_lshlrev_b32 v16, 5, v16
    v_and_b32 v18, 7, v1
    v_lshl_add_u32 v16, v18, 2, v16
    ds_write_b32 v16, v17 offset:57344
    s_waitcnt lgkmcnt(0)
    s_barrier
    v_and_b32 v16, 15, v1
    v_lshlrev_b32 v16, 5, v16
    ds_read_b128 v[8:11], v16 offset:57344
    ds_read_b128 v[12:15], v16 offset:57360
    v_mov_b32 v17, 0
    s_waitcnt lgkmcnt(0)
    v_mov_b32 v16, v8
    s_nop 1
    v_max_u32_dpp v16, v16, v16 row_ror:1 row_mask:0xf bank_mask:0xf
    s_add_u32 s44, s44, s45
    s_add_u32 m0, s46, 8192
    s_nop 0
    buffer_load_dwordx4 v210, s[64:67], s44 offen lds
    s_nop 1
    v_max_u32_dpp v16, v16, v16 row_ror:2 row_mask:0xf bank_mask:0xf
    s_nop 1
    v_max_u32_dpp v16, v16, v16 row_ror:4 row_mask:0xf bank_mask:0xf
    s_nop 1
    v_max_u32_dpp v16, v16, v16 row_ror:8 row_mask:0xf bank_mask:0xf
    s_add_u32 s44, s44, s45
    s_add_u32 m0, s46, 9216
    s_nop 0
    buffer_load_dwordx4 v210, s[64:67], s44 offen lds
    v_cndmask_b32_e64 v17, v17, v16, s[48:49]
    v_cmp_eq_u32 vcc, v8, v16
    s_nop 1
    v_cndmask_b32 v8, v8, v9, vcc
    v_mov_b32 v16, v8
    v_cndmask_b32 v9, v9, v10, vcc
    v_cndmask_b32 v10, v10, v11, vcc
    v_max_u32_dpp v16, v16, v16 row_ror:1 row_mask:0xf bank_mask:0xf
    v_cndmask_b32 v11, v11, v12, vcc
    v_cndmask_b32 v12, v12, v13, vcc
    v_max_u32_dpp v16, v16, v16 row_ror:2 row_mask:0xf bank_mask:0xf
    v_cndmask_b32 v13, v13, v14, vcc
    v_cndmask_b32 v14, v14, v15, vcc
    v_max_u32_dpp v16, v16, v16 row_ror:4 row_mask:0xf bank_mask:0xf
    s_nop 1
    v_max_u32_dpp v16, v16, v16 row_ror:8 row_mask:0xf bank_mask:0xf
    v_cndmask_b32_e64 v17, v17, v16, s[50:51]
    v_cmp_eq_u32 vcc, v8, v16
    s_nop 1
    v_cndmask_b32 v8, v8, v9, vcc
    v_mov_b32 v16, v8
    v_cndmask_b32 v9, v9, v10, vcc
    v_cndmask_b32 v10, v10, v11, vcc
    v_max_u32_dpp v16, v16, v16 row_ror:1 row_mask:0xf bank_mask:0xf
    s_add_u32 s44, s44, s45
    s_add_u32 m0, s46, 10240
    s_nop 0
    buffer_load_dwordx4 v210, s[64:67], s44 offen lds
    v_cndmask_b32 v11, v11, v12, vcc
    v_cndmask_b32 v12, v12, v13, vcc
    v_max_u32_dpp v16, v16, v16 row_ror:2 row_mask:0xf bank_mask:0xf
    v_cndmask_b32 v13, v13, v14, vcc
    s_nop 0
    v_max_u32_dpp v16, v16, v16 row_ror:4 row_mask:0xf bank_mask:0xf
    s_nop 1
    v_max_u32_dpp v16, v16, v16 row_ror:8 row_mask:0xf bank_mask:0xf
    v_cndmask_b32_e64 v17, v17, v16, s[52:53]
    v_cmp_eq_u32 vcc, v8, v16
    s_nop 1
    v_cndmask_b32 v8, v8, v9, vcc
    v_mov_b32 v16, v8
    v_cndmask_b32 v9, v9, v10, vcc
    v_cndmask_b32 v10, v10, v11, vcc
    v_max_u32_dpp v16, v16, v16 row_ror:1 row_mask:0xf bank_mask:0xf
    s_add_u32 s44, s44, s45
    s_add_u32 m0, s46, 11264
    s_nop 0
    buffer_load_dwordx4 v210, s[64:67], s44 offen lds
    v_cndmask_b32 v11, v11, v12, vcc
    v_cndmask_b32 v12, v12, v13, vcc
    v_max_u32_dpp v16, v16, v16 row_ror:2 row_mask:0xf bank_mask:0xf
    s_nop 1
    v_max_u32_dpp v16, v16, v16 row_ror:4 row_mask:0xf bank_mask:0xf
    s_nop 1
    v_max_u32_dpp v16, v16, v16 row_ror:8 row_mask:0xf bank_mask:0xf
    v_cndmask_b32_e64 v17, v17, v16, s[54:55]
    v_cmp_eq_u32 vcc, v8, v16
    s_nop 1
    v_cndmask_b32 v8, v8, v9, vcc
    v_mov_b32 v16, v8
    v_cndmask_b32 v9, v9, v10, vcc
    v_cndmask_b32 v10, v10, v11, vcc
    v_max_u32_dpp v16, v16, v16 row_ror:1 row_mask:0xf bank_mask:0xf
    v_cndmask_b32 v11, v11, v12, vcc
    s_nop 0
    v_max_u32_dpp v16, v16, v16 row_ror:2 row_mask:0xf bank_mask:0xf
    s_nop 1
    v_max_u32_dpp v16, v16, v16 row_ror:4 row_mask:0xf bank_mask:0xf
    s_add_u32 s44, s44, s45
    s_add_u32 m0, s46, 12288
    s_nop 0
    buffer_load_dwordx4 v210, s[64:67], s44 offen lds
    s_nop 1
    v_max_u32_dpp v16, v16, v16 row_ror:8 row_mask:0xf bank_mask:0xf
    v_cndmask_b32_e64 v17, v17, v16, s[56:57]
    v_cmp_eq_u32 vcc, v8, v16
    s_nop 1
    v_cndmask_b32 v8, v8, v9, vcc
    v_mov_b32 v16, v8
    v_cndmask_b32 v9, v9, v10, vcc
    v_cndmask_b32 v10, v10, v11, vcc
    v_max_u32_dpp v16, v16, v16 row_ror:1 row_mask:0xf bank_mask:0xf
    s_nop 1
    v_max_u32_dpp v16, v16, v16 row_ror:2 row_mask:0xf bank_mask:0xf
    s_nop 1
    v_max_u32_dpp v16, v16, v16 row_ror:4 row_mask:0xf bank_mask:0xf
    s_nop 1
    v_max_u32_dpp v16, v16, v16 row_ror:8 row_mask:0xf bank_mask:0xf
    v_cndmask_b32_e64 v17, v17, v16, s[58:59]
    v_cmp_eq_u32 vcc, v8, v16
    s_nop 1
    v_cndmask_b32 v8, v8, v9, vcc
    v_mov_b32 v16, v8
    v_cndmask_b32 v9, v9, v10, vcc
    s_nop 0
    v_max_u32_dpp v16, v16, v16 row_ror:1 row_mask:0xf bank_mask:0xf
    s_add_u32 s44, s44, s45
    s_add_u32 m0, s46, 13312
    s_nop 0
    buffer_load_dwordx4 v210, s[64:67], s44 offen lds
    s_nop 1
    v_max_u32_dpp v16, v16, v16 row_ror:2 row_mask:0xf bank_mask:0xf
    s_nop 1
    v_max_u32_dpp v16, v16, v16 row_ror:4 row_mask:0xf bank_mask:0xf
    s_nop 1
    v_max_u32_dpp v16, v16, v16 row_ror:8 row_mask:0xf bank_mask:0xf
    v_cndmask_b32_e64 v17, v17, v16, s[60:61]
    v_cmp_eq_u32 vcc, v8, v16
    s_nop 1
    v_cndmask_b32 v8, v8, v9, vcc
    v_mov_b32 v16, v8
    s_nop 1
    v_max_u32_dpp v16, v16, v16 row_ror:1 row_mask:0xf bank_mask:0xf
    s_nop 1
    v_max_u32_dpp v16, v16, v16 row_ror:2 row_mask:0xf bank_mask:0xf
    s_nop 1
    v_max_u32_dpp v16, v16, v16 row_ror:4 row_mask:0xf bank_mask:0xf
    s_nop 1
    v_max_u32_dpp v16, v16, v16 row_ror:8 row_mask:0xf bank_mask:0xf
    v_cndmask_b32_e64 v17, v17, v16, s[62:63]
    v_lshrrev_b32 v23, 4, v1
    v_and_b32 v23, 1, v23
    v_lshlrev_b32 v24, 4, v23
    v_add_u32 v21, 0, v24
    ds_bpermute_b32 v8, v21, v17
    v_add_u32 v21, 4, v24
    ds_bpermute_b32 v9, v21, v17
    v_add_u32 v21, 8, v24
    ds_bpermute_b32 v10, v21, v17
    v_add_u32 v21, 12, v24
    ds_bpermute_b32 v11, v21, v17
    s_waitcnt lgkmcnt(0)
    v_and_b32 v100, 0xffff, v8
    v_sub_u32 v100, 2047, v100
    v_mul_u32_u24 v104, 896, v100
    v_and_b32 v101, 0xffff, v9
    v_sub_u32 v101, 2047, v101
    v_mul_u32_u24 v105, 896, v101
    v_and_b32 v102, 0xffff, v10
    v_sub_u32 v102, 2047, v102
    v_mul_u32_u24 v106, 896, v102
    v_and_b32 v103, 0xffff, v11
    v_sub_u32 v103, 2047, v103
    v_mul_u32_u24 v107, 896, v103
    v_lshlrev_b32 v25, 1, v25
    v_add_u32 v25, s40, v25
    v_add_u32 v104, v104, v25
    v_add_u32 v105, v105, v25
    v_add_u32 v106, v106, v25
    v_add_u32 v107, v107, v25
    buffer_load_ushort v108, v104, s[28:31], 0 offen sc1
    buffer_load_ushort v109, v105, s[28:31], 0 offen sc1
    buffer_load_ushort v110, v106, s[28:31], 0 offen sc1
    buffer_load_ushort v111, v107, s[28:31], 0 offen sc1
    v_and_b32 v8, 0xffff0000, v8
    v_ashrrev_i32 v16, 31, v8
    v_not_b32 v16, v16
    v_or_b32 v16, 0x80000000, v16
    v_xor_b32 v8, v8, v16
    v_and_b32 v8, 0xffff0000, v8
    v_mul_f32 v12, 0xbfb8aa3b, v8
    v_and_b32 v9, 0xffff0000, v9
    v_ashrrev_i32 v16, 31, v9
    v_not_b32 v16, v16
    v_or_b32 v16, 0x80000000, v16
    v_xor_b32 v9, v9, v16
    v_and_b32 v9, 0xffff0000, v9
    v_mul_f32 v13, 0xbfb8aa3b, v9
    v_and_b32 v10, 0xffff0000, v10
    v_ashrrev_i32 v16, 31, v10
    v_not_b32 v16, v16
    v_or_b32 v16, 0x80000000, v16
    v_xor_b32 v10, v10, v16
    v_and_b32 v10, 0xffff0000, v10
    v_mul_f32 v14, 0xbfb8aa3b, v10
    v_and_b32 v11, 0xffff0000, v11
    v_ashrrev_i32 v16, 31, v11
    v_not_b32 v16, v16
    v_or_b32 v16, 0x80000000, v16
    v_xor_b32 v11, v11, v16
    v_and_b32 v11, 0xffff0000, v11
    v_mul_f32 v15, 0xbfb8aa3b, v11
    v_exp_f32 v12, v12
    v_exp_f32 v13, v13
    v_exp_f32 v14, v14
    v_exp_f32 v15, v15
    s_nop 0
    v_add_f32 v12, 1.0, v12
    v_add_f32 v13, 1.0, v13
    v_add_f32 v14, 1.0, v14
    v_add_f32 v15, 1.0, v15
    v_rcp_f32 v12, v12
    v_rcp_f32 v13, v13
    v_rcp_f32 v14, v14
    v_rcp_f32 v15, v15
    s_nop 0
    v_cvt_pk_bf16_f32 v12, v12, 0
    v_cvt_pk_bf16_f32 v13, v13, 0
    v_cvt_pk_bf16_f32 v14, v14, 0
    v_cvt_pk_bf16_f32 v15, v15, 0
    v_lshlrev_b32 v12, 16, v12
    v_lshlrev_b32 v13, 16, v13
    v_lshlrev_b32 v14, 16, v14
    v_lshlrev_b32 v15, 16, v15
    v_lshrrev_b32 v28, 4, v1
    v_lshlrev_b32 v28, 3, v28
    v_bfe_u32 v29, v1, 2, 2
    v_add_u32 v28, v28, v29
    v_lshlrev_b32 v28, 5, v28
    v_and_b32 v29, 3, v1
    v_lshl_add_u32 v28, v29, 3, v28
    v_add_u32 v28, s46, v28
    v_and_b32 v4, 7, v1
    v_mul_u32_u24 v22, 3584, v4
    v_lshrrev_b32 v23, 4, v1
    v_lshl_add_u32 v22, v23, 4, v22
    s_mul_i32 s41, s3, 896
    v_add_u32 v22, s41, v22
    s_waitcnt vmcnt(4)
    ds_read_b64_tr_b16 v[112:113], v28 offset:0
    ds_read_b64_tr_b16 v[114:115], v28 offset:128
    ds_read_b64_tr_b16 v[116:117], v28 offset:1024
    ds_read_b64_tr_b16 v[118:119], v28 offset:1152
    ds_read_b64_tr_b16 v[120:121], v28 offset:2048
    ds_read_b64_tr_b16 v[122:123], v28 offset:2176
    ds_read_b64_tr_b16 v[124:125], v28 offset:3072
    ds_read_b64_tr_b16 v[126:127], v28 offset:3200
    ds_read_b64_tr_b16 v[128:129], v28 offset:4096
    ds_read_b64_tr_b16 v[130:131], v28 offset:4224
    ds_read_b64_tr_b16 v[132:133], v28 offset:5120
    ds_read_b64_tr_b16 v[134:135], v28 offset:5248
    ds_read_b64_tr_b16 v[136:137], v28 offset:6144
    ds_read_b64_tr_b16 v[138:139], v28 offset:6272
    ds_read_b64_tr_b16 v[140:141], v28 offset:7168
    ds_read_b64_tr_b16 v[142:143], v28 offset:7296
    ds_read_b64_tr_b16 v[144:145], v28 offset:8192
    ds_read_b64_tr_b16 v[146:147], v28 offset:8320
    ds_read_b64_tr_b16 v[148:149], v28 offset:9216
    ds_read_b64_tr_b16 v[150:151], v28 offset:9344
    ds_read_b64_tr_b16 v[152:153], v28 offset:10240
    ds_read_b64_tr_b16 v[154:155], v28 offset:10368
    ds_read_b64_tr_b16 v[156:157], v28 offset:11264
    ds_read_b64_tr_b16 v[158:159], v28 offset:11392
    ds_read_b64_tr_b16 v[160:161], v28 offset:12288
    ds_read_b64_tr_b16 v[162:163], v28 offset:12416
    ds_read_b64_tr_b16 v[164:165], v28 offset:13312
    ds_read_b64_tr_b16 v[166:167], v28 offset:13440
    v_lshlrev_b32 v21, 6, v1
    s_mul_i32 s41, s3, 896
    s_add_u32 s41, s41, 25088
    v_add_u32 v21, s41, v21
    v_mov_b32 v23, 0x40000000
    v_cmp_gt_u32 vcc, 14, v1
    s_nop 1
    v_cndmask_b32 v21, v23, v21, vcc
L_k34_prepoll:
    buffer_load_dword v23, v21, s[20:23], 0 offen sc1
    s_waitcnt vmcnt(0)
    v_cmp_eq_u32 vcc, -1, v23
    s_nop 0
    s_cbranch_vccz L_k34_poll
    s_sleep 8
    s_branch L_k34_prepoll
L_k34_poll:
    buffer_load_dwordx4 v[32:35], v22, s[20:23], 0 offen offset:0 sc1
    buffer_load_dwordx4 v[36:39], v22, s[20:23], 0 offen offset:64 sc1
    buffer_load_dwordx4 v[40:43], v22, s[20:23], 0 offen offset:128 sc1
    buffer_load_dwordx4 v[44:47], v22, s[20:23], 0 offen offset:192 sc1
    buffer_load_dwordx4 v[48:51], v22, s[20:23], 0 offen offset:256 sc1
    buffer_load_dwordx4 v[52:55], v22, s[20:23], 0 offen offset:320 sc1
    buffer_load_dwordx4 v[56:59], v22, s[20:23], 0 offen offset:384 sc1
    buffer_load_dwordx4 v[60:63], v22, s[20:23], 0 offen offset:448 sc1
    buffer_load_dwordx4 v[64:67], v22, s[20:23], 0 offen offset:512 sc1
    buffer_load_dwordx4 v[68:71], v22, s[20:23], 0 offen offset:576 sc1
    buffer_load_dwordx4 v[72:75], v22, s[20:23], 0 offen offset:640 sc1
    buffer_load_dwordx4 v[76:79], v22, s[20:23], 0 offen offset:704 sc1
    buffer_load_dwordx4 v[80:83], v22, s[20:23], 0 offen offset:768 sc1
    buffer_load_dwordx4 v[84:87], v22, s[20:23], 0 offen offset:832 sc1
    s_waitcnt vmcnt(0)
    v_max3_u32 v21, v32, v33, v34
    v_max3_u32 v21, v21, v35, v36
    v_max3_u32 v21, v21, v37, v38
    v_max3_u32 v21, v21, v39, v40
    v_max3_u32 v21, v21, v41, v42
    v_max3_u32 v21, v21, v43, v44
    v_max3_u32 v21, v21, v45, v46
    v_max3_u32 v21, v21, v47, v48
    v_max3_u32 v21, v21, v49, v50
    v_max3_u32 v21, v21, v51, v52
    v_max3_u32 v21, v21, v53, v54
    v_max3_u32 v21, v21, v55, v56
    v_max3_u32 v21, v21, v57, v58
    v_max3_u32 v21, v21, v59, v60
    v_max3_u32 v21, v21, v61, v62
    v_max3_u32 v21, v21, v63, v64
    v_max3_u32 v21, v21, v65, v66
    v_max3_u32 v21, v21, v67, v68
    v_max3_u32 v21, v21, v69, v70
    v_max3_u32 v21, v21, v71, v72
    v_max3_u32 v21, v21, v73, v74
    v_max3_u32 v21, v21, v75, v76
    v_max3_u32 v21, v21, v77, v78
    v_max3_u32 v21, v21, v79, v80
    v_max3_u32 v21, v21, v81, v82
    v_max3_u32 v21, v21, v83, v84
    v_max3_u32 v21, v21, v85, v86
    v_max_u32 v21, v21, v87
    v_cmp_eq_u32 vcc, -1, v21
    s_nop 0
    s_cbranch_vccz L_k34_polled
    s_sleep 4
    s_branch L_k34_poll
L_k34_polled:
    s_waitcnt lgkmcnt(0)
    v_mfma_f32_16x16x32_bf16 v[172:175], v[32:35], v[112:115], 0
    v_mfma_f32_16x16x32_bf16 v[176:179], v[36:39], v[116:119], 0
    v_mfma_f32_16x16x32_bf16 v[172:175], v[40:43], v[120:123], v[172:175]
    v_mfma_f32_16x16x32_bf16 v[176:179], v[44:47], v[124:127], v[176:179]
    v_mfma_f32_16x16x32_bf16 v[172:175], v[48:51], v[128:131], v[172:175]
    v_mfma_f32_16x16x32_bf16 v[176:179], v[52:55], v[132:135], v[176:179]
    v_mfma_f32_16x16x32_bf16 v[172:175], v[56:59], v[136:139], v[172:175]
    v_mfma_f32_16x16x32_bf16 v[176:179], v[60:63], v[140:143], v[176:179]
    v_mfma_f32_16x16x32_bf16 v[172:175], v[64:67], v[144:147], v[172:175]
    v_mfma_f32_16x16x32_bf16 v[176:179], v[68:71], v[148:151], v[176:179]
    v_mfma_f32_16x16x32_bf16 v[172:175], v[72:75], v[152:155], v[172:175]
    v_mfma_f32_16x16x32_bf16 v[176:179], v[76:79], v[156:159], v[176:179]
    v_mfma_f32_16x16x32_bf16 v[172:175], v[80:83], v[160:163], v[172:175]
    v_mfma_f32_16x16x32_bf16 v[176:179], v[84:87], v[164:167], v[176:179]
    s_nop 7
    v_add_f32 v172, v172, v176
    v_add_f32 v173, v173, v177
    v_add_f32 v174, v174, v178
    v_add_f32 v175, v175, v179
    s_nop 7
    v_lshlrev_b32 v30, 4, v1
    s_lshl_b32 s41, s3, 10
    v_add_u32 v30, s41, v30
    ds_write_b128 v30, v[172:175] offset:58368
    s_waitcnt lgkmcnt(0)
    s_barrier
    s_cmp_lg_u32 s3, 0
    s_cbranch_scc1 L_st_end_k34
    ds_read_b128 v[176:179], v30 offset:59392
    ds_read_b128 v[180:183], v30 offset:60416
    ds_read_b128 v[184:187], v30 offset:61440
    s_waitcnt lgkmcnt(0)
    v_add_f32 v172, v172, v176
    v_add_f32 v180, v180, v184
    v_add_f32 v173, v173, v177
    v_add_f32 v181, v181, v185
    v_add_f32 v174, v174, v178
    v_add_f32 v182, v182, v186
    v_add_f32 v175, v175, v179
    v_add_f32 v183, v183, v187
    v_add_f32 v172, v172, v180
    v_add_f32 v173, v173, v181
    v_add_f32 v174, v174, v182
    v_add_f32 v175, v175, v183
    v_cvt_pk_bf16_f32 v188, v172, v173
    v_cvt_pk_bf16_f32 v189, v174, v175
    v_lshlrev_b32 v172, 16, v188
    v_and_b32 v173, 0xffff0000, v188
    v_lshlrev_b32 v174, 16, v189
    v_and_b32 v175, 0xffff0000, v189
    v_mul_f32 v172, v172, v12
    v_mul_f32 v173, v173, v13
    v_mul_f32 v174, v174, v14
    v_mul_f32 v175, v175, v15
    v_cvt_pk_bf16_f32 v188, v172, v173
    v_cvt_pk_bf16_f32 v189, v174, v175
    v_lshlrev_b32 v172, 16, v188
    v_and_b32 v173, 0xffff0000, v188
    v_lshlrev_b32 v174, 16, v189
    v_and_b32 v175, 0xffff0000, v189
    v_lshlrev_b32 v108, 16, v108
    v_fma_f32 v172, v172, v31, v108
    v_lshlrev_b32 v109, 16, v109
    v_fma_f32 v173, v173, v31, v109
    v_lshlrev_b32 v110, 16, v110
    v_fma_f32 v174, v174, v31, v110
    v_lshlrev_b32 v111, 16, v111
    v_fma_f32 v175, v175, v31, v111
    v_cvt_pk_bf16_f32 v188, v172, v173
    v_cvt_pk_bf16_f32 v189, v174, v175
    v_mov_b32 v27, 0x40000000
    v_cmp_gt_u32 vcc, 32, v1
    s_nop 1
    v_cndmask_b32 v104, v27, v104, vcc
    v_cndmask_b32 v105, v27, v105, vcc
    v_cndmask_b32 v106, v27, v106, vcc
    v_cndmask_b32 v107, v27, v107, vcc
    buffer_store_short v188, v104, s[28:31], 0 offen
    buffer_store_short_d16_hi v188, v105, s[28:31], 0 offen
    buffer_store_short v189, v106, s[28:31], 0 offen
    buffer_store_short_d16_hi v189, v107, s[28:31], 0 offen
L_st_end_k34:
    s_waitcnt vmcnt(0)
L_end_k1:
    s_endpgm
L_rare_f:
    s_call_b64 s[30:31], L_fb_0
    s_branch L_back_f
L_rare_a:
    s_call_b64 s[30:31], L_fb_1
    s_branch L_back_a
L_rare_b:
    s_call_b64 s[30:31], L_fb_0
    s_branch L_back_b
L_rare_c:
    s_call_b64 s[30:31], L_fb_1
    s_branch L_back_c
L_rare_d:
    s_call_b64 s[30:31], L_fb_0
    s_branch L_back_d
L_rare_p:
    s_call_b64 s[30:31], L_fb_1
    s_branch L_back_p
L_a2rare:
    buffer_load_dword v251, v250, s[88:91], 0 offen offset:64 sc1
    s_waitcnt vmcnt(0)
    v_readfirstlane_b32 s59, v251
    s_cmp_eq_u32 s59, 112
    s_cbranch_scc1 L_a2ok
    s_sleep 8
    s_branch L_a2rare
L_fb_0:
    s_nop 7
    s_nop 7
    v_max3_f32 v244, v128, v129, v130
    v_max3_f32 v244, v244, v131, v144
    v_max3_f32 v244, v244, v145, v146
    v_max_f32 v244, v244, v147
    v_mov_b32 v245, v244
    s_nop 1
    v_permlane16_swap_b32 v244, v245
    s_nop 1
    v_max_f32 v244, v244, v245
    v_mov_b32 v245, v244
    s_nop 1
    v_permlane32_swap_b32 v244, v245
    s_nop 1
    v_max_f32 v244, v244, v245
    v_max_f32 v244, 0, v244
    v_sub_f32 v192, v192, v244
    v_sub_f32 v193, v193, v244
    v_sub_f32 v194, v194, v244
    v_sub_f32 v195, v195, v244
    v_sub_f32 v245, 0, v244
    v_exp_f32 v245, v245
    s_nop 0
    v_mul_f32 v236, v228, v245
    v_accvgpr_read_b32 v246, a0
    v_mul_f32 v246, v246, v245
    v_accvgpr_write_b32 a0, v246
    v_accvgpr_read_b32 v247, a1
    v_mul_f32 v247, v247, v245
    v_accvgpr_write_b32 a1, v247
    v_accvgpr_read_b32 v248, a2
    v_mul_f32 v248, v248, v245
    v_accvgpr_write_b32 a2, v248
    v_accvgpr_read_b32 v249, a3
    v_mul_f32 v249, v249, v245
    v_accvgpr_write_b32 a3, v249
    v_accvgpr_read_b32 v246, a16
    v_mul_f32 v246, v246, v245
    v_accvgpr_write_b32 a16, v246
    v_accvgpr_read_b32 v247, a17
    v_mul_f32 v247, v247, v245
    v_accvgpr_write_b32 a17, v247
    v_accvgpr_read_b32 v248, a18
    v_mul_f32 v248, v248, v245
    v_accvgpr_write_b32 a18, v248
    v_accvgpr_read_b32 v249, a19
    v_mul_f32 v249, v249, v245
    v_accvgpr_write_b32 a19, v249
    v_accvgpr_read_b32 v246, a32
    v_mul_f32 v246, v246, v245
    v_accvgpr_write_b32 a32, v246
    v_accvgpr_read_b32 v247, a33
    v_mul_f32 v247, v247, v245
    v_accvgpr_write_b32 a33, v247
    v_accvgpr_read_b32 v248, a34
    v_mul_f32 v248, v248, v245
    v_accvgpr_write_b32 a34, v248
    v_accvgpr_read_b32 v249, a35
    v_mul_f32 v249, v249, v245
    v_accvgpr_write_b32 a35, v249
    v_accvgpr_read_b32 v246, a48
    v_mul_f32 v246, v246, v245
    v_accvgpr_write_b32 a48, v246
    v_accvgpr_read_b32 v247, a49
    v_mul_f32 v247, v247, v245
    v_accvgpr_write_b32 a49, v247
    v_accvgpr_read_b32 v248, a50
    v_mul_f32 v248, v248, v245
    v_accvgpr_write_b32 a50, v248
    v_accvgpr_read_b32 v249, a51
    v_mul_f32 v249, v249, v245
    v_accvgpr_write_b32 a51, v249
    v_accvgpr_read_b32 v246, a64
    v_mul_f32 v246, v246, v245
    v_accvgpr_write_b32 a64, v246
    v_accvgpr_read_b32 v247, a65
    v_mul_f32 v247, v247, v245
    v_accvgpr_write_b32 a65, v247
    v_accvgpr_read_b32 v248, a66
    v_mul_f32 v248, v248, v245
    v_accvgpr_write_b32 a66, v248
    v_accvgpr_read_b32 v249, a67
    v_mul_f32 v249, v249, v245
    v_accvgpr_write_b32 a67, v249
    v_accvgpr_read_b32 v246, a80
    v_mul_f32 v246, v246, v245
    v_accvgpr_write_b32 a80, v246
    v_accvgpr_read_b32 v247, a81
    v_mul_f32 v247, v247, v245
    v_accvgpr_write_b32 a81, v247
    v_accvgpr_read_b32 v248, a82
    v_mul_f32 v248, v248, v245
    v_accvgpr_write_b32 a82, v248
    v_accvgpr_read_b32 v249, a83
    v_mul_f32 v249, v249, v245
    v_accvgpr_write_b32 a83, v249
    v_accvgpr_read_b32 v246, a96
    v_mul_f32 v246, v246, v245
    v_accvgpr_write_b32 a96, v246
    v_accvgpr_read_b32 v247, a97
    v_mul_f32 v247, v247, v245
    v_accvgpr_write_b32 a97, v247
    v_accvgpr_read_b32 v248, a98
    v_mul_f32 v248, v248, v245
    v_accvgpr_write_b32 a98, v248
    v_accvgpr_read_b32 v249, a99
    v_mul_f32 v249, v249, v245
    v_accvgpr_write_b32 a99, v249
    v_accvgpr_read_b32 v246, a112
    v_mul_f32 v246, v246, v245
    v_accvgpr_write_b32 a112, v246
    v_accvgpr_read_b32 v247, a113
    v_mul_f32 v247, v247, v245
    v_accvgpr_write_b32 a113, v247
    v_accvgpr_read_b32 v248, a114
    v_mul_f32 v248, v248, v245
    v_accvgpr_write_b32 a114, v248
    v_accvgpr_read_b32 v249, a115
    v_mul_f32 v249, v249, v245
    v_accvgpr_write_b32 a115, v249
    v_accvgpr_read_b32 v246, a128
    v_mul_f32 v246, v246, v245
    v_accvgpr_write_b32 a128, v246
    v_accvgpr_read_b32 v247, a129
    v_mul_f32 v247, v247, v245
    v_accvgpr_write_b32 a129, v247
    v_accvgpr_read_b32 v248, a130
    v_mul_f32 v248, v248, v245
    v_accvgpr_write_b32 a130, v248
    v_accvgpr_read_b32 v249, a131
    v_mul_f32 v249, v249, v245
    v_accvgpr_write_b32 a131, v249
    v_accvgpr_read_b32 v246, a144
    v_mul_f32 v246, v246, v245
    v_accvgpr_write_b32 a144, v246
    v_accvgpr_read_b32 v247, a145
    v_mul_f32 v247, v247, v245
    v_accvgpr_write_b32 a145, v247
    v_accvgpr_read_b32 v248, a146
    v_mul_f32 v248, v248, v245
    v_accvgpr_write_b32 a146, v248
    v_accvgpr_read_b32 v249, a147
    v_mul_f32 v249, v249, v245
    v_accvgpr_write_b32 a147, v249
    v_accvgpr_read_b32 v246, a160
    v_mul_f32 v246, v246, v245
    v_accvgpr_write_b32 a160, v246
    v_accvgpr_read_b32 v247, a161
    v_mul_f32 v247, v247, v245
    v_accvgpr_write_b32 a161, v247
    v_accvgpr_read_b32 v248, a162
    v_mul_f32 v248, v248, v245
    v_accvgpr_write_b32 a162, v248
    v_accvgpr_read_b32 v249, a163
    v_mul_f32 v249, v249, v245
    v_accvgpr_write_b32 a163, v249
    v_accvgpr_read_b32 v246, a176
    v_mul_f32 v246, v246, v245
    v_accvgpr_write_b32 a176, v246
    v_accvgpr_read_b32 v247, a177
    v_mul_f32 v247, v247, v245
    v_accvgpr_write_b32 a177, v247
    v_accvgpr_read_b32 v248, a178
    v_mul_f32 v248, v248, v245
    v_accvgpr_write_b32 a178, v248
    v_accvgpr_read_b32 v249, a179
    v_mul_f32 v249, v249, v245
    v_accvgpr_write_b32 a179, v249
    v_accvgpr_read_b32 v246, a192
    v_mul_f32 v246, v246, v245
    v_accvgpr_write_b32 a192, v246
    v_accvgpr_read_b32 v247, a193
    v_mul_f32 v247, v247, v245
    v_accvgpr_write_b32 a193, v247
    v_accvgpr_read_b32 v248, a194
    v_mul_f32 v248, v248, v245
    v_accvgpr_write_b32 a194, v248
    v_accvgpr_read_b32 v249, a195
    v_mul_f32 v249, v249, v245
    v_accvgpr_write_b32 a195, v249
    v_accvgpr_read_b32 v246, a208
    v_mul_f32 v246, v246, v245
    v_accvgpr_write_b32 a208, v246
    v_accvgpr_read_b32 v247, a209
    v_mul_f32 v247, v247, v245
    v_accvgpr_write_b32 a209, v247
    v_accvgpr_read_b32 v248, a210
    v_mul_f32 v248, v248, v245
    v_accvgpr_write_b32 a210, v248
    v_accvgpr_read_b32 v249, a211
    v_mul_f32 v249, v249, v245
    v_accvgpr_write_b32 a211, v249
    v_accvgpr_read_b32 v246, a224
    v_mul_f32 v246, v246, v245
    v_accvgpr_write_b32 a224, v246
    v_accvgpr_read_b32 v247, a225
    v_mul_f32 v247, v247, v245
    v_accvgpr_write_b32 a225, v247
    v_accvgpr_read_b32 v248, a226
    v_mul_f32 v248, v248, v245
    v_accvgpr_write_b32 a226, v248
    v_accvgpr_read_b32 v249, a227
    v_mul_f32 v249, v249, v245
    v_accvgpr_write_b32 a227, v249
    v_accvgpr_read_b32 v246, a240
    v_mul_f32 v246, v246, v245
    v_accvgpr_write_b32 a240, v246
    v_accvgpr_read_b32 v247, a241
    v_mul_f32 v247, v247, v245
    v_accvgpr_write_b32 a241, v247
    v_accvgpr_read_b32 v248, a242
    v_mul_f32 v248, v248, v245
    v_accvgpr_write_b32 a242, v248
    v_accvgpr_read_b32 v249, a243
    v_mul_f32 v249, v249, v245
    v_accvgpr_write_b32 a243, v249
    v_sub_f32 v246, v128, v244
    v_sub_f32 v247, v129, v244
    v_exp_f32 v246, v246
    v_exp_f32 v247, v247
    s_nop 0
    v_add_f32 v236, v236, v246
    v_add_f32 v236, v236, v247
    v_cvt_pk_bf16_f32 v176, v246, v247
    v_sub_f32 v246, v130, v244
    v_sub_f32 v247, v131, v244
    v_exp_f32 v246, v246
    v_exp_f32 v247, v247
    s_nop 0
    v_add_f32 v236, v236, v246
    v_add_f32 v236, v236, v247
    v_cvt_pk_bf16_f32 v177, v246, v247
    v_sub_f32 v246, v144, v244
    v_sub_f32 v247, v145, v244
    v_exp_f32 v246, v246
    v_exp_f32 v247, v247
    s_nop 0
    v_add_f32 v236, v236, v246
    v_add_f32 v236, v236, v247
    v_cvt_pk_bf16_f32 v178, v246, v247
    v_sub_f32 v246, v146, v244
    v_sub_f32 v247, v147, v244
    v_exp_f32 v246, v246
    v_exp_f32 v247, v247
    s_nop 0
    v_add_f32 v236, v236, v246
    v_add_f32 v236, v236, v247
    v_cvt_pk_bf16_f32 v179, v246, v247
    v_max3_f32 v244, v132, v133, v134
    v_max3_f32 v244, v244, v135, v148
    v_max3_f32 v244, v244, v149, v150
    v_max_f32 v244, v244, v151
    v_mov_b32 v245, v244
    s_nop 1
    v_permlane16_swap_b32 v244, v245
    s_nop 1
    v_max_f32 v244, v244, v245
    v_mov_b32 v245, v244
    s_nop 1
    v_permlane32_swap_b32 v244, v245
    s_nop 1
    v_max_f32 v244, v244, v245
    v_max_f32 v244, 0, v244
    v_sub_f32 v196, v196, v244
    v_sub_f32 v197, v197, v244
    v_sub_f32 v198, v198, v244
    v_sub_f32 v199, v199, v244
    v_sub_f32 v245, 0, v244
    v_exp_f32 v245, v245
    s_nop 0
    v_mul_f32 v237, v229, v245
    v_accvgpr_read_b32 v246, a4
    v_mul_f32 v246, v246, v245
    v_accvgpr_write_b32 a4, v246
    v_accvgpr_read_b32 v247, a5
    v_mul_f32 v247, v247, v245
    v_accvgpr_write_b32 a5, v247
    v_accvgpr_read_b32 v248, a6
    v_mul_f32 v248, v248, v245
    v_accvgpr_write_b32 a6, v248
    v_accvgpr_read_b32 v249, a7
    v_mul_f32 v249, v249, v245
    v_accvgpr_write_b32 a7, v249
    v_accvgpr_read_b32 v246, a20
    v_mul_f32 v246, v246, v245
    v_accvgpr_write_b32 a20, v246
    v_accvgpr_read_b32 v247, a21
    v_mul_f32 v247, v247, v245
    v_accvgpr_write_b32 a21, v247
    v_accvgpr_read_b32 v248, a22
    v_mul_f32 v248, v248, v245
    v_accvgpr_write_b32 a22, v248
    v_accvgpr_read_b32 v249, a23
    v_mul_f32 v249, v249, v245
    v_accvgpr_write_b32 a23, v249
    v_accvgpr_read_b32 v246, a36
    v_mul_f32 v246, v246, v245
    v_accvgpr_write_b32 a36, v246
    v_accvgpr_read_b32 v247, a37
    v_mul_f32 v247, v247, v245
    v_accvgpr_write_b32 a37, v247
    v_accvgpr_read_b32 v248, a38
    v_mul_f32 v248, v248, v245
    v_accvgpr_write_b32 a38, v248
    v_accvgpr_read_b32 v249, a39
    v_mul_f32 v249, v249, v245
    v_accvgpr_write_b32 a39, v249
    v_accvgpr_read_b32 v246, a52
    v_mul_f32 v246, v246, v245
    v_accvgpr_write_b32 a52, v246
    v_accvgpr_read_b32 v247, a53
    v_mul_f32 v247, v247, v245
    v_accvgpr_write_b32 a53, v247
    v_accvgpr_read_b32 v248, a54
    v_mul_f32 v248, v248, v245
    v_accvgpr_write_b32 a54, v248
    v_accvgpr_read_b32 v249, a55
    v_mul_f32 v249, v249, v245
    v_accvgpr_write_b32 a55, v249
    v_accvgpr_read_b32 v246, a68
    v_mul_f32 v246, v246, v245
    v_accvgpr_write_b32 a68, v246
    v_accvgpr_read_b32 v247, a69
    v_mul_f32 v247, v247, v245
    v_accvgpr_write_b32 a69, v247
    v_accvgpr_read_b32 v248, a70
    v_mul_f32 v248, v248, v245
    v_accvgpr_write_b32 a70, v248
    v_accvgpr_read_b32 v249, a71
    v_mul_f32 v249, v249, v245
    v_accvgpr_write_b32 a71, v249
    v_accvgpr_read_b32 v246, a84
    v_mul_f32 v246, v246, v245
    v_accvgpr_write_b32 a84, v246
    v_accvgpr_read_b32 v247, a85
    v_mul_f32 v247, v247, v245
    v_accvgpr_write_b32 a85, v247
    v_accvgpr_read_b32 v248, a86
    v_mul_f32 v248, v248, v245
    v_accvgpr_write_b32 a86, v248
    v_accvgpr_read_b32 v249, a87
    v_mul_f32 v249, v249, v245
    v_accvgpr_write_b32 a87, v249
    v_accvgpr_read_b32 v246, a100
    v_mul_f32 v246, v246, v245
    v_accvgpr_write_b32 a100, v246
    v_accvgpr_read_b32 v247, a101
    v_mul_f32 v247, v247, v245
    v_accvgpr_write_b32 a101, v247
    v_accvgpr_read_b32 v248, a102
    v_mul_f32 v248, v248, v245
    v_accvgpr_write_b32 a102, v248
    v_accvgpr_read_b32 v249, a103
    v_mul_f32 v249, v249, v245
    v_accvgpr_write_b32 a103, v249
    v_accvgpr_read_b32 v246, a116
    v_mul_f32 v246, v246, v245
    v_accvgpr_write_b32 a116, v246
    v_accvgpr_read_b32 v247, a117
    v_mul_f32 v247, v247, v245
    v_accvgpr_write_b32 a117, v247
    v_accvgpr_read_b32 v248, a118
    v_mul_f32 v248, v248, v245
    v_accvgpr_write_b32 a118, v248
    v_accvgpr_read_b32 v249, a119
    v_mul_f32 v249, v249, v245
    v_accvgpr_write_b32 a119, v249
    v_accvgpr_read_b32 v246, a132
    v_mul_f32 v246, v246, v245
    v_accvgpr_write_b32 a132, v246
    v_accvgpr_read_b32 v247, a133
    v_mul_f32 v247, v247, v245
    v_accvgpr_write_b32 a133, v247
    v_accvgpr_read_b32 v248, a134
    v_mul_f32 v248, v248, v245
    v_accvgpr_write_b32 a134, v248
    v_accvgpr_read_b32 v249, a135
    v_mul_f32 v249, v249, v245
    v_accvgpr_write_b32 a135, v249
    v_accvgpr_read_b32 v246, a148
    v_mul_f32 v246, v246, v245
    v_accvgpr_write_b32 a148, v246
    v_accvgpr_read_b32 v247, a149
    v_mul_f32 v247, v247, v245
    v_accvgpr_write_b32 a149, v247
    v_accvgpr_read_b32 v248, a150
    v_mul_f32 v248, v248, v245
    v_accvgpr_write_b32 a150, v248
    v_accvgpr_read_b32 v249, a151
    v_mul_f32 v249, v249, v245
    v_accvgpr_write_b32 a151, v249
    v_accvgpr_read_b32 v246, a164
    v_mul_f32 v246, v246, v245
    v_accvgpr_write_b32 a164, v246
    v_accvgpr_read_b32 v247, a165
    v_mul_f32 v247, v247, v245
    v_accvgpr_write_b32 a165, v247
    v_accvgpr_read_b32 v248, a166
    v_mul_f32 v248, v248, v245
    v_accvgpr_write_b32 a166, v248
    v_accvgpr_read_b32 v249, a167
    v_mul_f32 v249, v249, v245
    v_accvgpr_write_b32 a167, v249
    v_accvgpr_read_b32 v246, a180
    v_mul_f32 v246, v246, v245
    v_accvgpr_write_b32 a180, v246
    v_accvgpr_read_b32 v247, a181
    v_mul_f32 v247, v247, v245
    v_accvgpr_write_b32 a181, v247
    v_accvgpr_read_b32 v248, a182
    v_mul_f32 v248, v248, v245
    v_accvgpr_write_b32 a182, v248
    v_accvgpr_read_b32 v249, a183
    v_mul_f32 v249, v249, v245
    v_accvgpr_write_b32 a183, v249
    v_accvgpr_read_b32 v246, a196
    v_mul_f32 v246, v246, v245
    v_accvgpr_write_b32 a196, v246
    v_accvgpr_read_b32 v247, a197
    v_mul_f32 v247, v247, v245
    v_accvgpr_write_b32 a197, v247
    v_accvgpr_read_b32 v248, a198
    v_mul_f32 v248, v248, v245
    v_accvgpr_write_b32 a198, v248
    v_accvgpr_read_b32 v249, a199
    v_mul_f32 v249, v249, v245
    v_accvgpr_write_b32 a199, v249
    v_accvgpr_read_b32 v246, a212
    v_mul_f32 v246, v246, v245
    v_accvgpr_write_b32 a212, v246
    v_accvgpr_read_b32 v247, a213
    v_mul_f32 v247, v247, v245
    v_accvgpr_write_b32 a213, v247
    v_accvgpr_read_b32 v248, a214
    v_mul_f32 v248, v248, v245
    v_accvgpr_write_b32 a214, v248
    v_accvgpr_read_b32 v249, a215
    v_mul_f32 v249, v249, v245
    v_accvgpr_write_b32 a215, v249
    v_accvgpr_read_b32 v246, a228
    v_mul_f32 v246, v246, v245
    v_accvgpr_write_b32 a228, v246
    v_accvgpr_read_b32 v247, a229
    v_mul_f32 v247, v247, v245
    v_accvgpr_write_b32 a229, v247
    v_accvgpr_read_b32 v248, a230
    v_mul_f32 v248, v248, v245
    v_accvgpr_write_b32 a230, v248
    v_accvgpr_read_b32 v249, a231
    v_mul_f32 v249, v249, v245
    v_accvgpr_write_b32 a231, v249
    v_accvgpr_read_b32 v246, a244
    v_mul_f32 v246, v246, v245
    v_accvgpr_write_b32 a244, v246
    v_accvgpr_read_b32 v247, a245
    v_mul_f32 v247, v247, v245
    v_accvgpr_write_b32 a245, v247
    v_accvgpr_read_b32 v248, a246
    v_mul_f32 v248, v248, v245
    v_accvgpr_write_b32 a246, v248
    v_accvgpr_read_b32 v249, a247
    v_mul_f32 v249, v249, v245
    v_accvgpr_write_b32 a247, v249
    v_sub_f32 v246, v132, v244
    v_sub_f32 v247, v133, v244
    v_exp_f32 v246, v246
    v_exp_f32 v247, v247
    s_nop 0
    v_add_f32 v237, v237, v246
    v_add_f32 v237, v237, v247
    v_cvt_pk_bf16_f32 v180, v246, v247
    v_sub_f32 v246, v134, v244
    v_sub_f32 v247, v135, v244
    v_exp_f32 v246, v246
    v_exp_f32 v247, v247
    s_nop 0
    v_add_f32 v237, v237, v246
    v_add_f32 v237, v237, v247
    v_cvt_pk_bf16_f32 v181, v246, v247
    v_sub_f32 v246, v148, v244
    v_sub_f32 v247, v149, v244
    v_exp_f32 v246, v246
    v_exp_f32 v247, v247
    s_nop 0
    v_add_f32 v237, v237, v246
    v_add_f32 v237, v237, v247
    v_cvt_pk_bf16_f32 v182, v246, v247
    v_sub_f32 v246, v150, v244
    v_sub_f32 v247, v151, v244
    v_exp_f32 v246, v246
    v_exp_f32 v247, v247
    s_nop 0
    v_add_f32 v237, v237, v246
    v_add_f32 v237, v237, v247
    v_cvt_pk_bf16_f32 v183, v246, v247
    v_max3_f32 v244, v136, v137, v138
    v_max3_f32 v244, v244, v139, v152
    v_max3_f32 v244, v244, v153, v154
    v_max_f32 v244, v244, v155
    v_mov_b32 v245, v244
    s_nop 1
    v_permlane16_swap_b32 v244, v245
    s_nop 1
    v_max_f32 v244, v244, v245
    v_mov_b32 v245, v244
    s_nop 1
    v_permlane32_swap_b32 v244, v245
    s_nop 1
    v_max_f32 v244, v244, v245
    v_max_f32 v244, 0, v244
    v_sub_f32 v200, v200, v244
    v_sub_f32 v201, v201, v244
    v_sub_f32 v202, v202, v244
    v_sub_f32 v203, v203, v244
    v_sub_f32 v245, 0, v244
    v_exp_f32 v245, v245
    s_nop 0
    v_mul_f32 v238, v230, v245
    v_accvgpr_read_b32 v246, a8
    v_mul_f32 v246, v246, v245
    v_accvgpr_write_b32 a8, v246
    v_accvgpr_read_b32 v247, a9
    v_mul_f32 v247, v247, v245
    v_accvgpr_write_b32 a9, v247
    v_accvgpr_read_b32 v248, a10
    v_mul_f32 v248, v248, v245
    v_accvgpr_write_b32 a10, v248
    v_accvgpr_read_b32 v249, a11
    v_mul_f32 v249, v249, v245
    v_accvgpr_write_b32 a11, v249
    v_accvgpr_read_b32 v246, a24
    v_mul_f32 v246, v246, v245
    v_accvgpr_write_b32 a24, v246
    v_accvgpr_read_b32 v247, a25
    v_mul_f32 v247, v247, v245
    v_accvgpr_write_b32 a25, v247
    v_accvgpr_read_b32 v248, a26
    v_mul_f32 v248, v248, v245
    v_accvgpr_write_b32 a26, v248
    v_accvgpr_read_b32 v249, a27
    v_mul_f32 v249, v249, v245
    v_accvgpr_write_b32 a27, v249
    v_accvgpr_read_b32 v246, a40
    v_mul_f32 v246, v246, v245
    v_accvgpr_write_b32 a40, v246
    v_accvgpr_read_b32 v247, a41
    v_mul_f32 v247, v247, v245
    v_accvgpr_write_b32 a41, v247
    v_accvgpr_read_b32 v248, a42
    v_mul_f32 v248, v248, v245
    v_accvgpr_write_b32 a42, v248
    v_accvgpr_read_b32 v249, a43
    v_mul_f32 v249, v249, v245
    v_accvgpr_write_b32 a43, v249
    v_accvgpr_read_b32 v246, a56
    v_mul_f32 v246, v246, v245
    v_accvgpr_write_b32 a56, v246
    v_accvgpr_read_b32 v247, a57
    v_mul_f32 v247, v247, v245
    v_accvgpr_write_b32 a57, v247
    v_accvgpr_read_b32 v248, a58
    v_mul_f32 v248, v248, v245
    v_accvgpr_write_b32 a58, v248
    v_accvgpr_read_b32 v249, a59
    v_mul_f32 v249, v249, v245
    v_accvgpr_write_b32 a59, v249
    v_accvgpr_read_b32 v246, a72
    v_mul_f32 v246, v246, v245
    v_accvgpr_write_b32 a72, v246
    v_accvgpr_read_b32 v247, a73
    v_mul_f32 v247, v247, v245
    v_accvgpr_write_b32 a73, v247
    v_accvgpr_read_b32 v248, a74
    v_mul_f32 v248, v248, v245
    v_accvgpr_write_b32 a74, v248
    v_accvgpr_read_b32 v249, a75
    v_mul_f32 v249, v249, v245
    v_accvgpr_write_b32 a75, v249
    v_accvgpr_read_b32 v246, a88
    v_mul_f32 v246, v246, v245
    v_accvgpr_write_b32 a88, v246
    v_accvgpr_read_b32 v247, a89
    v_mul_f32 v247, v247, v245
    v_accvgpr_write_b32 a89, v247
    v_accvgpr_read_b32 v248, a90
    v_mul_f32 v248, v248, v245
    v_accvgpr_write_b32 a90, v248
    v_accvgpr_read_b32 v249, a91
    v_mul_f32 v249, v249, v245
    v_accvgpr_write_b32 a91, v249
    v_accvgpr_read_b32 v246, a104
    v_mul_f32 v246, v246, v245
    v_accvgpr_write_b32 a104, v246
    v_accvgpr_read_b32 v247, a105
    v_mul_f32 v247, v247, v245
    v_accvgpr_write_b32 a105, v247
    v_accvgpr_read_b32 v248, a106
    v_mul_f32 v248, v248, v245
    v_accvgpr_write_b32 a106, v248
    v_accvgpr_read_b32 v249, a107
    v_mul_f32 v249, v249, v245
    v_accvgpr_write_b32 a107, v249
    v_accvgpr_read_b32 v246, a120
    v_mul_f32 v246, v246, v245
    v_accvgpr_write_b32 a120, v246
    v_accvgpr_read_b32 v247, a121
    v_mul_f32 v247, v247, v245
    v_accvgpr_write_b32 a121, v247
    v_accvgpr_read_b32 v248, a122
    v_mul_f32 v248, v248, v245
    v_accvgpr_write_b32 a122, v248
    v_accvgpr_read_b32 v249, a123
    v_mul_f32 v249, v249, v245
    v_accvgpr_write_b32 a123, v249
    v_accvgpr_read_b32 v246, a136
    v_mul_f32 v246, v246, v245
    v_accvgpr_write_b32 a136, v246
    v_accvgpr_read_b32 v247, a137
    v_mul_f32 v247, v247, v245
    v_accvgpr_write_b32 a137, v247
    v_accvgpr_read_b32 v248, a138
    v_mul_f32 v248, v248, v245
    v_accvgpr_write_b32 a138, v248
    v_accvgpr_read_b32 v249, a139
    v_mul_f32 v249, v249, v245
    v_accvgpr_write_b32 a139, v249
    v_accvgpr_read_b32 v246, a152
    v_mul_f32 v246, v246, v245
    v_accvgpr_write_b32 a152, v246
    v_accvgpr_read_b32 v247, a153
    v_mul_f32 v247, v247, v245
    v_accvgpr_write_b32 a153, v247
    v_accvgpr_read_b32 v248, a154
    v_mul_f32 v248, v248, v245
    v_accvgpr_write_b32 a154, v248
    v_accvgpr_read_b32 v249, a155
    v_mul_f32 v249, v249, v245
    v_accvgpr_write_b32 a155, v249
    v_accvgpr_read_b32 v246, a168
    v_mul_f32 v246, v246, v245
    v_accvgpr_write_b32 a168, v246
    v_accvgpr_read_b32 v247, a169
    v_mul_f32 v247, v247, v245
    v_accvgpr_write_b32 a169, v247
    v_accvgpr_read_b32 v248, a170
    v_mul_f32 v248, v248, v245
    v_accvgpr_write_b32 a170, v248
    v_accvgpr_read_b32 v249, a171
    v_mul_f32 v249, v249, v245
    v_accvgpr_write_b32 a171, v249
    v_accvgpr_read_b32 v246, a184
    v_mul_f32 v246, v246, v245
    v_accvgpr_write_b32 a184, v246
    v_accvgpr_read_b32 v247, a185
    v_mul_f32 v247, v247, v245
    v_accvgpr_write_b32 a185, v247
    v_accvgpr_read_b32 v248, a186
    v_mul_f32 v248, v248, v245
    v_accvgpr_write_b32 a186, v248
    v_accvgpr_read_b32 v249, a187
    v_mul_f32 v249, v249, v245
    v_accvgpr_write_b32 a187, v249
    v_accvgpr_read_b32 v246, a200
    v_mul_f32 v246, v246, v245
    v_accvgpr_write_b32 a200, v246
    v_accvgpr_read_b32 v247, a201
    v_mul_f32 v247, v247, v245
    v_accvgpr_write_b32 a201, v247
    v_accvgpr_read_b32 v248, a202
    v_mul_f32 v248, v248, v245
    v_accvgpr_write_b32 a202, v248
    v_accvgpr_read_b32 v249, a203
    v_mul_f32 v249, v249, v245
    v_accvgpr_write_b32 a203, v249
    v_accvgpr_read_b32 v246, a216
    v_mul_f32 v246, v246, v245
    v_accvgpr_write_b32 a216, v246
    v_accvgpr_read_b32 v247, a217
    v_mul_f32 v247, v247, v245
    v_accvgpr_write_b32 a217, v247
    v_accvgpr_read_b32 v248, a218
    v_mul_f32 v248, v248, v245
    v_accvgpr_write_b32 a218, v248
    v_accvgpr_read_b32 v249, a219
    v_mul_f32 v249, v249, v245
    v_accvgpr_write_b32 a219, v249
    v_accvgpr_read_b32 v246, a232
    v_mul_f32 v246, v246, v245
    v_accvgpr_write_b32 a232, v246
    v_accvgpr_read_b32 v247, a233
    v_mul_f32 v247, v247, v245
    v_accvgpr_write_b32 a233, v247
    v_accvgpr_read_b32 v248, a234
    v_mul_f32 v248, v248, v245
    v_accvgpr_write_b32 a234, v248
    v_accvgpr_read_b32 v249, a235
    v_mul_f32 v249, v249, v245
    v_accvgpr_write_b32 a235, v249
    v_accvgpr_read_b32 v246, a248
    v_mul_f32 v246, v246, v245
    v_accvgpr_write_b32 a248, v246
    v_accvgpr_read_b32 v247, a249
    v_mul_f32 v247, v247, v245
    v_accvgpr_write_b32 a249, v247
    v_accvgpr_read_b32 v248, a250
    v_mul_f32 v248, v248, v245
    v_accvgpr_write_b32 a250, v248
    v_accvgpr_read_b32 v249, a251
    v_mul_f32 v249, v249, v245
    v_accvgpr_write_b32 a251, v249
    v_sub_f32 v246, v136, v244
    v_sub_f32 v247, v137, v244
    v_exp_f32 v246, v246
    v_exp_f32 v247, v247
    s_nop 0
    v_add_f32 v238, v238, v246
    v_add_f32 v238, v238, v247
    v_cvt_pk_bf16_f32 v184, v246, v247
    v_sub_f32 v246, v138, v244
    v_sub_f32 v247, v139, v244
    v_exp_f32 v246, v246
    v_exp_f32 v247, v247
    s_nop 0
    v_add_f32 v238, v238, v246
    v_add_f32 v238, v238, v247
    v_cvt_pk_bf16_f32 v185, v246, v247
    v_sub_f32 v246, v152, v244
    v_sub_f32 v247, v153, v244
    v_exp_f32 v246, v246
    v_exp_f32 v247, v247
    s_nop 0
    v_add_f32 v238, v238, v246
    v_add_f32 v238, v238, v247
    v_cvt_pk_bf16_f32 v186, v246, v247
    v_sub_f32 v246, v154, v244
    v_sub_f32 v247, v155, v244
    v_exp_f32 v246, v246
    v_exp_f32 v247, v247
    s_nop 0
    v_add_f32 v238, v238, v246
    v_add_f32 v238, v238, v247
    v_cvt_pk_bf16_f32 v187, v246, v247
    v_max3_f32 v244, v140, v141, v142
    v_max3_f32 v244, v244, v143, v156
    v_max3_f32 v244, v244, v157, v158
    v_max_f32 v244, v244, v159
    v_mov_b32 v245, v244
    s_nop 1
    v_permlane16_swap_b32 v244, v245
    s_nop 1
    v_max_f32 v244, v244, v245
    v_mov_b32 v245, v244
    s_nop 1
    v_permlane32_swap_b32 v244, v245
    s_nop 1
    v_max_f32 v244, v244, v245
    v_max_f32 v244, 0, v244
    v_sub_f32 v204, v204, v244
    v_sub_f32 v205, v205, v244
    v_sub_f32 v206, v206, v244
    v_sub_f32 v207, v207, v244
    v_sub_f32 v245, 0, v244
    v_exp_f32 v245, v245
    s_nop 0
    v_mul_f32 v239, v231, v245
    v_accvgpr_read_b32 v246, a12
    v_mul_f32 v246, v246, v245
    v_accvgpr_write_b32 a12, v246
    v_accvgpr_read_b32 v247, a13
    v_mul_f32 v247, v247, v245
    v_accvgpr_write_b32 a13, v247
    v_accvgpr_read_b32 v248, a14
    v_mul_f32 v248, v248, v245
    v_accvgpr_write_b32 a14, v248
    v_accvgpr_read_b32 v249, a15
    v_mul_f32 v249, v249, v245
    v_accvgpr_write_b32 a15, v249
    v_accvgpr_read_b32 v246, a28
    v_mul_f32 v246, v246, v245
    v_accvgpr_write_b32 a28, v246
    v_accvgpr_read_b32 v247, a29
    v_mul_f32 v247, v247, v245
    v_accvgpr_write_b32 a29, v247
    v_accvgpr_read_b32 v248, a30
    v_mul_f32 v248, v248, v245
    v_accvgpr_write_b32 a30, v248
    v_accvgpr_read_b32 v249, a31
    v_mul_f32 v249, v249, v245
    v_accvgpr_write_b32 a31, v249
    v_accvgpr_read_b32 v246, a44
    v_mul_f32 v246, v246, v245
    v_accvgpr_write_b32 a44, v246
    v_accvgpr_read_b32 v247, a45
    v_mul_f32 v247, v247, v245
    v_accvgpr_write_b32 a45, v247
    v_accvgpr_read_b32 v248, a46
    v_mul_f32 v248, v248, v245
    v_accvgpr_write_b32 a46, v248
    v_accvgpr_read_b32 v249, a47
    v_mul_f32 v249, v249, v245
    v_accvgpr_write_b32 a47, v249
    v_accvgpr_read_b32 v246, a60
    v_mul_f32 v246, v246, v245
    v_accvgpr_write_b32 a60, v246
    v_accvgpr_read_b32 v247, a61
    v_mul_f32 v247, v247, v245
    v_accvgpr_write_b32 a61, v247
    v_accvgpr_read_b32 v248, a62
    v_mul_f32 v248, v248, v245
    v_accvgpr_write_b32 a62, v248
    v_accvgpr_read_b32 v249, a63
    v_mul_f32 v249, v249, v245
    v_accvgpr_write_b32 a63, v249
    v_accvgpr_read_b32 v246, a76
    v_mul_f32 v246, v246, v245
    v_accvgpr_write_b32 a76, v246
    v_accvgpr_read_b32 v247, a77
    v_mul_f32 v247, v247, v245
    v_accvgpr_write_b32 a77, v247
    v_accvgpr_read_b32 v248, a78
    v_mul_f32 v248, v248, v245
    v_accvgpr_write_b32 a78, v248
    v_accvgpr_read_b32 v249, a79
    v_mul_f32 v249, v249, v245
    v_accvgpr_write_b32 a79, v249
    v_accvgpr_read_b32 v246, a92
    v_mul_f32 v246, v246, v245
    v_accvgpr_write_b32 a92, v246
    v_accvgpr_read_b32 v247, a93
    v_mul_f32 v247, v247, v245
    v_accvgpr_write_b32 a93, v247
    v_accvgpr_read_b32 v248, a94
    v_mul_f32 v248, v248, v245
    v_accvgpr_write_b32 a94, v248
    v_accvgpr_read_b32 v249, a95
    v_mul_f32 v249, v249, v245
    v_accvgpr_write_b32 a95, v249
    v_accvgpr_read_b32 v246, a108
    v_mul_f32 v246, v246, v245
    v_accvgpr_write_b32 a108, v246
    v_accvgpr_read_b32 v247, a109
    v_mul_f32 v247, v247, v245
    v_accvgpr_write_b32 a109, v247
    v_accvgpr_read_b32 v248, a110
    v_mul_f32 v248, v248, v245
    v_accvgpr_write_b32 a110, v248
    v_accvgpr_read_b32 v249, a111
    v_mul_f32 v249, v249, v245
    v_accvgpr_write_b32 a111, v249
    v_accvgpr_read_b32 v246, a124
    v_mul_f32 v246, v246, v245
    v_accvgpr_write_b32 a124, v246
    v_accvgpr_read_b32 v247, a125
    v_mul_f32 v247, v247, v245
    v_accvgpr_write_b32 a125, v247
    v_accvgpr_read_b32 v248, a126
    v_mul_f32 v248, v248, v245
    v_accvgpr_write_b32 a126, v248
    v_accvgpr_read_b32 v249, a127
    v_mul_f32 v249, v249, v245
    v_accvgpr_write_b32 a127, v249
    v_accvgpr_read_b32 v246, a140
    v_mul_f32 v246, v246, v245
    v_accvgpr_write_b32 a140, v246
    v_accvgpr_read_b32 v247, a141
    v_mul_f32 v247, v247, v245
    v_accvgpr_write_b32 a141, v247
    v_accvgpr_read_b32 v248, a142
    v_mul_f32 v248, v248, v245
    v_accvgpr_write_b32 a142, v248
    v_accvgpr_read_b32 v249, a143
    v_mul_f32 v249, v249, v245
    v_accvgpr_write_b32 a143, v249
    v_accvgpr_read_b32 v246, a156
    v_mul_f32 v246, v246, v245
    v_accvgpr_write_b32 a156, v246
    v_accvgpr_read_b32 v247, a157
    v_mul_f32 v247, v247, v245
    v_accvgpr_write_b32 a157, v247
    v_accvgpr_read_b32 v248, a158
    v_mul_f32 v248, v248, v245
    v_accvgpr_write_b32 a158, v248
    v_accvgpr_read_b32 v249, a159
    v_mul_f32 v249, v249, v245
    v_accvgpr_write_b32 a159, v249
    v_accvgpr_read_b32 v246, a172
    v_mul_f32 v246, v246, v245
    v_accvgpr_write_b32 a172, v246
    v_accvgpr_read_b32 v247, a173
    v_mul_f32 v247, v247, v245
    v_accvgpr_write_b32 a173, v247
    v_accvgpr_read_b32 v248, a174
    v_mul_f32 v248, v248, v245
    v_accvgpr_write_b32 a174, v248
    v_accvgpr_read_b32 v249, a175
    v_mul_f32 v249, v249, v245
    v_accvgpr_write_b32 a175, v249
    v_accvgpr_read_b32 v246, a188
    v_mul_f32 v246, v246, v245
    v_accvgpr_write_b32 a188, v246
    v_accvgpr_read_b32 v247, a189
    v_mul_f32 v247, v247, v245
    v_accvgpr_write_b32 a189, v247
    v_accvgpr_read_b32 v248, a190
    v_mul_f32 v248, v248, v245
    v_accvgpr_write_b32 a190, v248
    v_accvgpr_read_b32 v249, a191
    v_mul_f32 v249, v249, v245
    v_accvgpr_write_b32 a191, v249
    v_accvgpr_read_b32 v246, a204
    v_mul_f32 v246, v246, v245
    v_accvgpr_write_b32 a204, v246
    v_accvgpr_read_b32 v247, a205
    v_mul_f32 v247, v247, v245
    v_accvgpr_write_b32 a205, v247
    v_accvgpr_read_b32 v248, a206
    v_mul_f32 v248, v248, v245
    v_accvgpr_write_b32 a206, v248
    v_accvgpr_read_b32 v249, a207
    v_mul_f32 v249, v249, v245
    v_accvgpr_write_b32 a207, v249
    v_accvgpr_read_b32 v246, a220
    v_mul_f32 v246, v246, v245
    v_accvgpr_write_b32 a220, v246
    v_accvgpr_read_b32 v247, a221
    v_mul_f32 v247, v247, v245
    v_accvgpr_write_b32 a221, v247
    v_accvgpr_read_b32 v248, a222
    v_mul_f32 v248, v248, v245
    v_accvgpr_write_b32 a222, v248
    v_accvgpr_read_b32 v249, a223
    v_mul_f32 v249, v249, v245
    v_accvgpr_write_b32 a223, v249
    v_accvgpr_read_b32 v246, a236
    v_mul_f32 v246, v246, v245
    v_accvgpr_write_b32 a236, v246
    v_accvgpr_read_b32 v247, a237
    v_mul_f32 v247, v247, v245
    v_accvgpr_write_b32 a237, v247
    v_accvgpr_read_b32 v248, a238
    v_mul_f32 v248, v248, v245
    v_accvgpr_write_b32 a238, v248
    v_accvgpr_read_b32 v249, a239
    v_mul_f32 v249, v249, v245
    v_accvgpr_write_b32 a239, v249
    v_accvgpr_read_b32 v246, a252
    v_mul_f32 v246, v246, v245
    v_accvgpr_write_b32 a252, v246
    v_accvgpr_read_b32 v247, a253
    v_mul_f32 v247, v247, v245
    v_accvgpr_write_b32 a253, v247
    v_accvgpr_read_b32 v248, a254
    v_mul_f32 v248, v248, v245
    v_accvgpr_write_b32 a254, v248
    v_accvgpr_read_b32 v249, a255
    v_mul_f32 v249, v249, v245
    v_accvgpr_write_b32 a255, v249
    v_sub_f32 v246, v140, v244
    v_sub_f32 v247, v141, v244
    v_exp_f32 v246, v246
    v_exp_f32 v247, v247
    s_nop 0
    v_add_f32 v239, v239, v246
    v_add_f32 v239, v239, v247
    v_cvt_pk_bf16_f32 v188, v246, v247
    v_sub_f32 v246, v142, v244
    v_sub_f32 v247, v143, v244
    v_exp_f32 v246, v246
    v_exp_f32 v247, v247
    s_nop 0
    v_add_f32 v239, v239, v246
    v_add_f32 v239, v239, v247
    v_cvt_pk_bf16_f32 v189, v246, v247
    v_sub_f32 v246, v156, v244
    v_sub_f32 v247, v157, v244
    v_exp_f32 v246, v246
    v_exp_f32 v247, v247
    s_nop 0
    v_add_f32 v239, v239, v246
    v_add_f32 v239, v239, v247
    v_cvt_pk_bf16_f32 v190, v246, v247
    v_sub_f32 v246, v158, v244
    v_sub_f32 v247, v159, v244
    v_exp_f32 v246, v246
    v_exp_f32 v247, v247
    s_nop 0
    v_add_f32 v239, v239, v246
    v_add_f32 v239, v239, v247
    v_cvt_pk_bf16_f32 v191, v246, v247
    s_nop 3
    s_setpc_b64 s[30:31]
L_fb_1:
    s_nop 7
    s_nop 7
    v_max3_f32 v244, v128, v129, v130
    v_max3_f32 v244, v244, v131, v144
    v_max3_f32 v244, v244, v145, v146
    v_max_f32 v244, v244, v147
    v_mov_b32 v245, v244
    s_nop 1
    v_permlane16_swap_b32 v244, v245
    s_nop 1
    v_max_f32 v244, v244, v245
    v_mov_b32 v245, v244
    s_nop 1
    v_permlane32_swap_b32 v244, v245
    s_nop 1
    v_max_f32 v244, v244, v245
    v_max_f32 v244, 0, v244
    v_sub_f32 v192, v192, v244
    v_sub_f32 v193, v193, v244
    v_sub_f32 v194, v194, v244
    v_sub_f32 v195, v195, v244
    v_sub_f32 v245, 0, v244
    v_exp_f32 v245, v245
    s_nop 0
    v_mul_f32 v228, v236, v245
    v_accvgpr_read_b32 v246, a0
    v_mul_f32 v246, v246, v245
    v_accvgpr_write_b32 a0, v246
    v_accvgpr_read_b32 v247, a1
    v_mul_f32 v247, v247, v245
    v_accvgpr_write_b32 a1, v247
    v_accvgpr_read_b32 v248, a2
    v_mul_f32 v248, v248, v245
    v_accvgpr_write_b32 a2, v248
    v_accvgpr_read_b32 v249, a3
    v_mul_f32 v249, v249, v245
    v_accvgpr_write_b32 a3, v249
    v_accvgpr_read_b32 v246, a16
    v_mul_f32 v246, v246, v245
    v_accvgpr_write_b32 a16, v246
    v_accvgpr_read_b32 v247, a17
    v_mul_f32 v247, v247, v245
    v_accvgpr_write_b32 a17, v247
    v_accvgpr_read_b32 v248, a18
    v_mul_f32 v248, v248, v245
    v_accvgpr_write_b32 a18, v248
    v_accvgpr_read_b32 v249, a19
    v_mul_f32 v249, v249, v245
    v_accvgpr_write_b32 a19, v249
    v_accvgpr_read_b32 v246, a32
    v_mul_f32 v246, v246, v245
    v_accvgpr_write_b32 a32, v246
    v_accvgpr_read_b32 v247, a33
    v_mul_f32 v247, v247, v245
    v_accvgpr_write_b32 a33, v247
    v_accvgpr_read_b32 v248, a34
    v_mul_f32 v248, v248, v245
    v_accvgpr_write_b32 a34, v248
    v_accvgpr_read_b32 v249, a35
    v_mul_f32 v249, v249, v245
    v_accvgpr_write_b32 a35, v249
    v_accvgpr_read_b32 v246, a48
    v_mul_f32 v246, v246, v245
    v_accvgpr_write_b32 a48, v246
    v_accvgpr_read_b32 v247, a49
    v_mul_f32 v247, v247, v245
    v_accvgpr_write_b32 a49, v247
    v_accvgpr_read_b32 v248, a50
    v_mul_f32 v248, v248, v245
    v_accvgpr_write_b32 a50, v248
    v_accvgpr_read_b32 v249, a51
    v_mul_f32 v249, v249, v245
    v_accvgpr_write_b32 a51, v249
    v_accvgpr_read_b32 v246, a64
    v_mul_f32 v246, v246, v245
    v_accvgpr_write_b32 a64, v246
    v_accvgpr_read_b32 v247, a65
    v_mul_f32 v247, v247, v245
    v_accvgpr_write_b32 a65, v247
    v_accvgpr_read_b32 v248, a66
    v_mul_f32 v248, v248, v245
    v_accvgpr_write_b32 a66, v248
    v_accvgpr_read_b32 v249, a67
    v_mul_f32 v249, v249, v245
    v_accvgpr_write_b32 a67, v249
    v_accvgpr_read_b32 v246, a80
    v_mul_f32 v246, v246, v245
    v_accvgpr_write_b32 a80, v246
    v_accvgpr_read_b32 v247, a81
    v_mul_f32 v247, v247, v245
    v_accvgpr_write_b32 a81, v247
    v_accvgpr_read_b32 v248, a82
    v_mul_f32 v248, v248, v245
    v_accvgpr_write_b32 a82, v248
    v_accvgpr_read_b32 v249, a83
    v_mul_f32 v249, v249, v245
    v_accvgpr_write_b32 a83, v249
    v_accvgpr_read_b32 v246, a96
    v_mul_f32 v246, v246, v245
    v_accvgpr_write_b32 a96, v246
    v_accvgpr_read_b32 v247, a97
    v_mul_f32 v247, v247, v245
    v_accvgpr_write_b32 a97, v247
    v_accvgpr_read_b32 v248, a98
    v_mul_f32 v248, v248, v245
    v_accvgpr_write_b32 a98, v248
    v_accvgpr_read_b32 v249, a99
    v_mul_f32 v249, v249, v245
    v_accvgpr_write_b32 a99, v249
    v_accvgpr_read_b32 v246, a112
    v_mul_f32 v246, v246, v245
    v_accvgpr_write_b32 a112, v246
    v_accvgpr_read_b32 v247, a113
    v_mul_f32 v247, v247, v245
    v_accvgpr_write_b32 a113, v247
    v_accvgpr_read_b32 v248, a114
    v_mul_f32 v248, v248, v245
    v_accvgpr_write_b32 a114, v248
    v_accvgpr_read_b32 v249, a115
    v_mul_f32 v249, v249, v245
    v_accvgpr_write_b32 a115, v249
    v_accvgpr_read_b32 v246, a128
    v_mul_f32 v246, v246, v245
    v_accvgpr_write_b32 a128, v246
    v_accvgpr_read_b32 v247, a129
    v_mul_f32 v247, v247, v245
    v_accvgpr_write_b32 a129, v247
    v_accvgpr_read_b32 v248, a130
    v_mul_f32 v248, v248, v245
    v_accvgpr_write_b32 a130, v248
    v_accvgpr_read_b32 v249, a131
    v_mul_f32 v249, v249, v245
    v_accvgpr_write_b32 a131, v249
    v_accvgpr_read_b32 v246, a144
    v_mul_f32 v246, v246, v245
    v_accvgpr_write_b32 a144, v246
    v_accvgpr_read_b32 v247, a145
    v_mul_f32 v247, v247, v245
    v_accvgpr_write_b32 a145, v247
    v_accvgpr_read_b32 v248, a146
    v_mul_f32 v248, v248, v245
    v_accvgpr_write_b32 a146, v248
    v_accvgpr_read_b32 v249, a147
    v_mul_f32 v249, v249, v245
    v_accvgpr_write_b32 a147, v249
    v_accvgpr_read_b32 v246, a160
    v_mul_f32 v246, v246, v245
    v_accvgpr_write_b32 a160, v246
    v_accvgpr_read_b32 v247, a161
    v_mul_f32 v247, v247, v245
    v_accvgpr_write_b32 a161, v247
    v_accvgpr_read_b32 v248, a162
    v_mul_f32 v248, v248, v245
    v_accvgpr_write_b32 a162, v248
    v_accvgpr_read_b32 v249, a163
    v_mul_f32 v249, v249, v245
    v_accvgpr_write_b32 a163, v249
    v_accvgpr_read_b32 v246, a176
    v_mul_f32 v246, v246, v245
    v_accvgpr_write_b32 a176, v246
    v_accvgpr_read_b32 v247, a177
    v_mul_f32 v247, v247, v245
    v_accvgpr_write_b32 a177, v247
    v_accvgpr_read_b32 v248, a178
    v_mul_f32 v248, v248, v245
    v_accvgpr_write_b32 a178, v248
    v_accvgpr_read_b32 v249, a179
    v_mul_f32 v249, v249, v245
    v_accvgpr_write_b32 a179, v249
    v_accvgpr_read_b32 v246, a192
    v_mul_f32 v246, v246, v245
    v_accvgpr_write_b32 a192, v246
    v_accvgpr_read_b32 v247, a193
    v_mul_f32 v247, v247, v245
    v_accvgpr_write_b32 a193, v247
    v_accvgpr_read_b32 v248, a194
    v_mul_f32 v248, v248, v245
    v_accvgpr_write_b32 a194, v248
    v_accvgpr_read_b32 v249, a195
    v_mul_f32 v249, v249, v245
    v_accvgpr_write_b32 a195, v249
    v_accvgpr_read_b32 v246, a208
    v_mul_f32 v246, v246, v245
    v_accvgpr_write_b32 a208, v246
    v_accvgpr_read_b32 v247, a209
    v_mul_f32 v247, v247, v245
    v_accvgpr_write_b32 a209, v247
    v_accvgpr_read_b32 v248, a210
    v_mul_f32 v248, v248, v245
    v_accvgpr_write_b32 a210, v248
    v_accvgpr_read_b32 v249, a211
    v_mul_f32 v249, v249, v245
    v_accvgpr_write_b32 a211, v249
    v_accvgpr_read_b32 v246, a224
    v_mul_f32 v246, v246, v245
    v_accvgpr_write_b32 a224, v246
    v_accvgpr_read_b32 v247, a225
    v_mul_f32 v247, v247, v245
    v_accvgpr_write_b32 a225, v247
    v_accvgpr_read_b32 v248, a226
    v_mul_f32 v248, v248, v245
    v_accvgpr_write_b32 a226, v248
    v_accvgpr_read_b32 v249, a227
    v_mul_f32 v249, v249, v245
    v_accvgpr_write_b32 a227, v249
    v_accvgpr_read_b32 v246, a240
    v_mul_f32 v246, v246, v245
    v_accvgpr_write_b32 a240, v246
    v_accvgpr_read_b32 v247, a241
    v_mul_f32 v247, v247, v245
    v_accvgpr_write_b32 a241, v247
    v_accvgpr_read_b32 v248, a242
    v_mul_f32 v248, v248, v245
    v_accvgpr_write_b32 a242, v248
    v_accvgpr_read_b32 v249, a243
    v_mul_f32 v249, v249, v245
    v_accvgpr_write_b32 a243, v249
    v_sub_f32 v246, v128, v244
    v_sub_f32 v247, v129, v244
    v_exp_f32 v246, v246
    v_exp_f32 v247, v247
    s_nop 0
    v_add_f32 v228, v228, v246
    v_add_f32 v228, v228, v247
    v_cvt_pk_bf16_f32 v160, v246, v247
    v_sub_f32 v246, v130, v244
    v_sub_f32 v247, v131, v244
    v_exp_f32 v246, v246
    v_exp_f32 v247, v247
    s_nop 0
    v_add_f32 v228, v228, v246
    v_add_f32 v228, v228, v247
    v_cvt_pk_bf16_f32 v161, v246, v247
    v_sub_f32 v246, v144, v244
    v_sub_f32 v247, v145, v244
    v_exp_f32 v246, v246
    v_exp_f32 v247, v247
    s_nop 0
    v_add_f32 v228, v228, v246
    v_add_f32 v228, v228, v247
    v_cvt_pk_bf16_f32 v162, v246, v247
    v_sub_f32 v246, v146, v244
    v_sub_f32 v247, v147, v244
    v_exp_f32 v246, v246
    v_exp_f32 v247, v247
    s_nop 0
    v_add_f32 v228, v228, v246
    v_add_f32 v228, v228, v247
    v_cvt_pk_bf16_f32 v163, v246, v247
    v_max3_f32 v244, v132, v133, v134
    v_max3_f32 v244, v244, v135, v148
    v_max3_f32 v244, v244, v149, v150
    v_max_f32 v244, v244, v151
    v_mov_b32 v245, v244
    s_nop 1
    v_permlane16_swap_b32 v244, v245
    s_nop 1
    v_max_f32 v244, v244, v245
    v_mov_b32 v245, v244
    s_nop 1
    v_permlane32_swap_b32 v244, v245
    s_nop 1
    v_max_f32 v244, v244, v245
    v_max_f32 v244, 0, v244
    v_sub_f32 v196, v196, v244
    v_sub_f32 v197, v197, v244
    v_sub_f32 v198, v198, v244
    v_sub_f32 v199, v199, v244
    v_sub_f32 v245, 0, v244
    v_exp_f32 v245, v245
    s_nop 0
    v_mul_f32 v229, v237, v245
    v_accvgpr_read_b32 v246, a4
    v_mul_f32 v246, v246, v245
    v_accvgpr_write_b32 a4, v246
    v_accvgpr_read_b32 v247, a5
    v_mul_f32 v247, v247, v245
    v_accvgpr_write_b32 a5, v247
    v_accvgpr_read_b32 v248, a6
    v_mul_f32 v248, v248, v245
    v_accvgpr_write_b32 a6, v248
    v_accvgpr_read_b32 v249, a7
    v_mul_f32 v249, v249, v245
    v_accvgpr_write_b32 a7, v249
    v_accvgpr_read_b32 v246, a20
    v_mul_f32 v246, v246, v245
    v_accvgpr_write_b32 a20, v246
    v_accvgpr_read_b32 v247, a21
    v_mul_f32 v247, v247, v245
    v_accvgpr_write_b32 a21, v247
    v_accvgpr_read_b32 v248, a22
    v_mul_f32 v248, v248, v245
    v_accvgpr_write_b32 a22, v248
    v_accvgpr_read_b32 v249, a23
    v_mul_f32 v249, v249, v245
    v_accvgpr_write_b32 a23, v249
    v_accvgpr_read_b32 v246, a36
    v_mul_f32 v246, v246, v245
    v_accvgpr_write_b32 a36, v246
    v_accvgpr_read_b32 v247, a37
    v_mul_f32 v247, v247, v245
    v_accvgpr_write_b32 a37, v247
    v_accvgpr_read_b32 v248, a38
    v_mul_f32 v248, v248, v245
    v_accvgpr_write_b32 a38, v248
    v_accvgpr_read_b32 v249, a39
    v_mul_f32 v249, v249, v245
    v_accvgpr_write_b32 a39, v249
    v_accvgpr_read_b32 v246, a52
    v_mul_f32 v246, v246, v245
    v_accvgpr_write_b32 a52, v246
    v_accvgpr_read_b32 v247, a53
    v_mul_f32 v247, v247, v245
    v_accvgpr_write_b32 a53, v247
    v_accvgpr_read_b32 v248, a54
    v_mul_f32 v248, v248, v245
    v_accvgpr_write_b32 a54, v248
    v_accvgpr_read_b32 v249, a55
    v_mul_f32 v249, v249, v245
    v_accvgpr_write_b32 a55, v249
    v_accvgpr_read_b32 v246, a68
    v_mul_f32 v246, v246, v245
    v_accvgpr_write_b32 a68, v246
    v_accvgpr_read_b32 v247, a69
    v_mul_f32 v247, v247, v245
    v_accvgpr_write_b32 a69, v247
    v_accvgpr_read_b32 v248, a70
    v_mul_f32 v248, v248, v245
    v_accvgpr_write_b32 a70, v248
    v_accvgpr_read_b32 v249, a71
    v_mul_f32 v249, v249, v245
    v_accvgpr_write_b32 a71, v249
    v_accvgpr_read_b32 v246, a84
    v_mul_f32 v246, v246, v245
    v_accvgpr_write_b32 a84, v246
    v_accvgpr_read_b32 v247, a85
    v_mul_f32 v247, v247, v245
    v_accvgpr_write_b32 a85, v247
    v_accvgpr_read_b32 v248, a86
    v_mul_f32 v248, v248, v245
    v_accvgpr_write_b32 a86, v248
    v_accvgpr_read_b32 v249, a87
    v_mul_f32 v249, v249, v245
    v_accvgpr_write_b32 a87, v249
    v_accvgpr_read_b32 v246, a100
    v_mul_f32 v246, v246, v245
    v_accvgpr_write_b32 a100, v246
    v_accvgpr_read_b32 v247, a101
    v_mul_f32 v247, v247, v245
    v_accvgpr_write_b32 a101, v247
    v_accvgpr_read_b32 v248, a102
    v_mul_f32 v248, v248, v245
    v_accvgpr_write_b32 a102, v248
    v_accvgpr_read_b32 v249, a103
    v_mul_f32 v249, v249, v245
    v_accvgpr_write_b32 a103, v249
    v_accvgpr_read_b32 v246, a116
    v_mul_f32 v246, v246, v245
    v_accvgpr_write_b32 a116, v246
    v_accvgpr_read_b32 v247, a117
    v_mul_f32 v247, v247, v245
    v_accvgpr_write_b32 a117, v247
    v_accvgpr_read_b32 v248, a118
    v_mul_f32 v248, v248, v245
    v_accvgpr_write_b32 a118, v248
    v_accvgpr_read_b32 v249, a119
    v_mul_f32 v249, v249, v245
    v_accvgpr_write_b32 a119, v249
    v_accvgpr_read_b32 v246, a132
    v_mul_f32 v246, v246, v245
    v_accvgpr_write_b32 a132, v246
    v_accvgpr_read_b32 v247, a133
    v_mul_f32 v247, v247, v245
    v_accvgpr_write_b32 a133, v247
    v_accvgpr_read_b32 v248, a134
    v_mul_f32 v248, v248, v245
    v_accvgpr_write_b32 a134, v248
    v_accvgpr_read_b32 v249, a135
    v_mul_f32 v249, v249, v245
    v_accvgpr_write_b32 a135, v249
    v_accvgpr_read_b32 v246, a148
    v_mul_f32 v246, v246, v245
    v_accvgpr_write_b32 a148, v246
    v_accvgpr_read_b32 v247, a149
    v_mul_f32 v247, v247, v245
    v_accvgpr_write_b32 a149, v247
    v_accvgpr_read_b32 v248, a150
    v_mul_f32 v248, v248, v245
    v_accvgpr_write_b32 a150, v248
    v_accvgpr_read_b32 v249, a151
    v_mul_f32 v249, v249, v245
    v_accvgpr_write_b32 a151, v249
    v_accvgpr_read_b32 v246, a164
    v_mul_f32 v246, v246, v245
    v_accvgpr_write_b32 a164, v246
    v_accvgpr_read_b32 v247, a165
    v_mul_f32 v247, v247, v245
    v_accvgpr_write_b32 a165, v247
    v_accvgpr_read_b32 v248, a166
    v_mul_f32 v248, v248, v245
    v_accvgpr_write_b32 a166, v248
    v_accvgpr_read_b32 v249, a167
    v_mul_f32 v249, v249, v245
    v_accvgpr_write_b32 a167, v249
    v_accvgpr_read_b32 v246, a180
    v_mul_f32 v246, v246, v245
    v_accvgpr_write_b32 a180, v246
    v_accvgpr_read_b32 v247, a181
    v_mul_f32 v247, v247, v245
    v_accvgpr_write_b32 a181, v247
    v_accvgpr_read_b32 v248, a182
    v_mul_f32 v248, v248, v245
    v_accvgpr_write_b32 a182, v248
    v_accvgpr_read_b32 v249, a183
    v_mul_f32 v249, v249, v245
    v_accvgpr_write_b32 a183, v249
    v_accvgpr_read_b32 v246, a196
    v_mul_f32 v246, v246, v245
    v_accvgpr_write_b32 a196, v246
    v_accvgpr_read_b32 v247, a197
    v_mul_f32 v247, v247, v245
    v_accvgpr_write_b32 a197, v247
    v_accvgpr_read_b32 v248, a198
    v_mul_f32 v248, v248, v245
    v_accvgpr_write_b32 a198, v248
    v_accvgpr_read_b32 v249, a199
    v_mul_f32 v249, v249, v245
    v_accvgpr_write_b32 a199, v249
    v_accvgpr_read_b32 v246, a212
    v_mul_f32 v246, v246, v245
    v_accvgpr_write_b32 a212, v246
    v_accvgpr_read_b32 v247, a213
    v_mul_f32 v247, v247, v245
    v_accvgpr_write_b32 a213, v247
    v_accvgpr_read_b32 v248, a214
    v_mul_f32 v248, v248, v245
    v_accvgpr_write_b32 a214, v248
    v_accvgpr_read_b32 v249, a215
    v_mul_f32 v249, v249, v245
    v_accvgpr_write_b32 a215, v249
    v_accvgpr_read_b32 v246, a228
    v_mul_f32 v246, v246, v245
    v_accvgpr_write_b32 a228, v246
    v_accvgpr_read_b32 v247, a229
    v_mul_f32 v247, v247, v245
    v_accvgpr_write_b32 a229, v247
    v_accvgpr_read_b32 v248, a230
    v_mul_f32 v248, v248, v245
    v_accvgpr_write_b32 a230, v248
    v_accvgpr_read_b32 v249, a231
    v_mul_f32 v249, v249, v245
    v_accvgpr_write_b32 a231, v249
    v_accvgpr_read_b32 v246, a244
    v_mul_f32 v246, v246, v245
    v_accvgpr_write_b32 a244, v246
    v_accvgpr_read_b32 v247, a245
    v_mul_f32 v247, v247, v245
    v_accvgpr_write_b32 a245, v247
    v_accvgpr_read_b32 v248, a246
    v_mul_f32 v248, v248, v245
    v_accvgpr_write_b32 a246, v248
    v_accvgpr_read_b32 v249, a247
    v_mul_f32 v249, v249, v245
    v_accvgpr_write_b32 a247, v249
    v_sub_f32 v246, v132, v244
    v_sub_f32 v247, v133, v244
    v_exp_f32 v246, v246
    v_exp_f32 v247, v247
    s_nop 0
    v_add_f32 v229, v229, v246
    v_add_f32 v229, v229, v247
    v_cvt_pk_bf16_f32 v164, v246, v247
    v_sub_f32 v246, v134, v244
    v_sub_f32 v247, v135, v244
    v_exp_f32 v246, v246
    v_exp_f32 v247, v247
    s_nop 0
    v_add_f32 v229, v229, v246
    v_add_f32 v229, v229, v247
    v_cvt_pk_bf16_f32 v165, v246, v247
    v_sub_f32 v246, v148, v244
    v_sub_f32 v247, v149, v244
    v_exp_f32 v246, v246
    v_exp_f32 v247, v247
    s_nop 0
    v_add_f32 v229, v229, v246
    v_add_f32 v229, v229, v247
    v_cvt_pk_bf16_f32 v166, v246, v247
    v_sub_f32 v246, v150, v244
    v_sub_f32 v247, v151, v244
    v_exp_f32 v246, v246
    v_exp_f32 v247, v247
    s_nop 0
    v_add_f32 v229, v229, v246
    v_add_f32 v229, v229, v247
    v_cvt_pk_bf16_f32 v167, v246, v247
    v_max3_f32 v244, v136, v137, v138
    v_max3_f32 v244, v244, v139, v152
    v_max3_f32 v244, v244, v153, v154
    v_max_f32 v244, v244, v155
    v_mov_b32 v245, v244
    s_nop 1
    v_permlane16_swap_b32 v244, v245
    s_nop 1
    v_max_f32 v244, v244, v245
    v_mov_b32 v245, v244
    s_nop 1
    v_permlane32_swap_b32 v244, v245
    s_nop 1
    v_max_f32 v244, v244, v245
    v_max_f32 v244, 0, v244
    v_sub_f32 v200, v200, v244
    v_sub_f32 v201, v201, v244
    v_sub_f32 v202, v202, v244
    v_sub_f32 v203, v203, v244
    v_sub_f32 v245, 0, v244
    v_exp_f32 v245, v245
    s_nop 0
    v_mul_f32 v230, v238, v245
    v_accvgpr_read_b32 v246, a8
    v_mul_f32 v246, v246, v245
    v_accvgpr_write_b32 a8, v246
    v_accvgpr_read_b32 v247, a9
    v_mul_f32 v247, v247, v245
    v_accvgpr_write_b32 a9, v247
    v_accvgpr_read_b32 v248, a10
    v_mul_f32 v248, v248, v245
    v_accvgpr_write_b32 a10, v248
    v_accvgpr_read_b32 v249, a11
    v_mul_f32 v249, v249, v245
    v_accvgpr_write_b32 a11, v249
    v_accvgpr_read_b32 v246, a24
    v_mul_f32 v246, v246, v245
    v_accvgpr_write_b32 a24, v246
    v_accvgpr_read_b32 v247, a25
    v_mul_f32 v247, v247, v245
    v_accvgpr_write_b32 a25, v247
    v_accvgpr_read_b32 v248, a26
    v_mul_f32 v248, v248, v245
    v_accvgpr_write_b32 a26, v248
    v_accvgpr_read_b32 v249, a27
    v_mul_f32 v249, v249, v245
    v_accvgpr_write_b32 a27, v249
    v_accvgpr_read_b32 v246, a40
    v_mul_f32 v246, v246, v245
    v_accvgpr_write_b32 a40, v246
    v_accvgpr_read_b32 v247, a41
    v_mul_f32 v247, v247, v245
    v_accvgpr_write_b32 a41, v247
    v_accvgpr_read_b32 v248, a42
    v_mul_f32 v248, v248, v245
    v_accvgpr_write_b32 a42, v248
    v_accvgpr_read_b32 v249, a43
    v_mul_f32 v249, v249, v245
    v_accvgpr_write_b32 a43, v249
    v_accvgpr_read_b32 v246, a56
    v_mul_f32 v246, v246, v245
    v_accvgpr_write_b32 a56, v246
    v_accvgpr_read_b32 v247, a57
    v_mul_f32 v247, v247, v245
    v_accvgpr_write_b32 a57, v247
    v_accvgpr_read_b32 v248, a58
    v_mul_f32 v248, v248, v245
    v_accvgpr_write_b32 a58, v248
    v_accvgpr_read_b32 v249, a59
    v_mul_f32 v249, v249, v245
    v_accvgpr_write_b32 a59, v249
    v_accvgpr_read_b32 v246, a72
    v_mul_f32 v246, v246, v245
    v_accvgpr_write_b32 a72, v246
    v_accvgpr_read_b32 v247, a73
    v_mul_f32 v247, v247, v245
    v_accvgpr_write_b32 a73, v247
    v_accvgpr_read_b32 v248, a74
    v_mul_f32 v248, v248, v245
    v_accvgpr_write_b32 a74, v248
    v_accvgpr_read_b32 v249, a75
    v_mul_f32 v249, v249, v245
    v_accvgpr_write_b32 a75, v249
    v_accvgpr_read_b32 v246, a88
    v_mul_f32 v246, v246, v245
    v_accvgpr_write_b32 a88, v246
    v_accvgpr_read_b32 v247, a89
    v_mul_f32 v247, v247, v245
    v_accvgpr_write_b32 a89, v247
    v_accvgpr_read_b32 v248, a90
    v_mul_f32 v248, v248, v245
    v_accvgpr_write_b32 a90, v248
    v_accvgpr_read_b32 v249, a91
    v_mul_f32 v249, v249, v245
    v_accvgpr_write_b32 a91, v249
    v_accvgpr_read_b32 v246, a104
    v_mul_f32 v246, v246, v245
    v_accvgpr_write_b32 a104, v246
    v_accvgpr_read_b32 v247, a105
    v_mul_f32 v247, v247, v245
    v_accvgpr_write_b32 a105, v247
    v_accvgpr_read_b32 v248, a106
    v_mul_f32 v248, v248, v245
    v_accvgpr_write_b32 a106, v248
    v_accvgpr_read_b32 v249, a107
    v_mul_f32 v249, v249, v245
    v_accvgpr_write_b32 a107, v249
    v_accvgpr_read_b32 v246, a120
    v_mul_f32 v246, v246, v245
    v_accvgpr_write_b32 a120, v246
    v_accvgpr_read_b32 v247, a121
    v_mul_f32 v247, v247, v245
    v_accvgpr_write_b32 a121, v247
    v_accvgpr_read_b32 v248, a122
    v_mul_f32 v248, v248, v245
    v_accvgpr_write_b32 a122, v248
    v_accvgpr_read_b32 v249, a123
    v_mul_f32 v249, v249, v245
    v_accvgpr_write_b32 a123, v249
    v_accvgpr_read_b32 v246, a136
    v_mul_f32 v246, v246, v245
    v_accvgpr_write_b32 a136, v246
    v_accvgpr_read_b32 v247, a137
    v_mul_f32 v247, v247, v245
    v_accvgpr_write_b32 a137, v247
    v_accvgpr_read_b32 v248, a138
    v_mul_f32 v248, v248, v245
    v_accvgpr_write_b32 a138, v248
    v_accvgpr_read_b32 v249, a139
    v_mul_f32 v249, v249, v245
    v_accvgpr_write_b32 a139, v249
    v_accvgpr_read_b32 v246, a152
    v_mul_f32 v246, v246, v245
    v_accvgpr_write_b32 a152, v246
    v_accvgpr_read_b32 v247, a153
    v_mul_f32 v247, v247, v245
    v_accvgpr_write_b32 a153, v247
    v_accvgpr_read_b32 v248, a154
    v_mul_f32 v248, v248, v245
    v_accvgpr_write_b32 a154, v248
    v_accvgpr_read_b32 v249, a155
    v_mul_f32 v249, v249, v245
    v_accvgpr_write_b32 a155, v249
    v_accvgpr_read_b32 v246, a168
    v_mul_f32 v246, v246, v245
    v_accvgpr_write_b32 a168, v246
    v_accvgpr_read_b32 v247, a169
    v_mul_f32 v247, v247, v245
    v_accvgpr_write_b32 a169, v247
    v_accvgpr_read_b32 v248, a170
    v_mul_f32 v248, v248, v245
    v_accvgpr_write_b32 a170, v248
    v_accvgpr_read_b32 v249, a171
    v_mul_f32 v249, v249, v245
    v_accvgpr_write_b32 a171, v249
    v_accvgpr_read_b32 v246, a184
    v_mul_f32 v246, v246, v245
    v_accvgpr_write_b32 a184, v246
    v_accvgpr_read_b32 v247, a185
    v_mul_f32 v247, v247, v245
    v_accvgpr_write_b32 a185, v247
    v_accvgpr_read_b32 v248, a186
    v_mul_f32 v248, v248, v245
    v_accvgpr_write_b32 a186, v248
    v_accvgpr_read_b32 v249, a187
    v_mul_f32 v249, v249, v245
    v_accvgpr_write_b32 a187, v249
    v_accvgpr_read_b32 v246, a200
    v_mul_f32 v246, v246, v245
    v_accvgpr_write_b32 a200, v246
    v_accvgpr_read_b32 v247, a201
    v_mul_f32 v247, v247, v245
    v_accvgpr_write_b32 a201, v247
    v_accvgpr_read_b32 v248, a202
    v_mul_f32 v248, v248, v245
    v_accvgpr_write_b32 a202, v248
    v_accvgpr_read_b32 v249, a203
    v_mul_f32 v249, v249, v245
    v_accvgpr_write_b32 a203, v249
    v_accvgpr_read_b32 v246, a216
    v_mul_f32 v246, v246, v245
    v_accvgpr_write_b32 a216, v246
    v_accvgpr_read_b32 v247, a217
    v_mul_f32 v247, v247, v245
    v_accvgpr_write_b32 a217, v247
    v_accvgpr_read_b32 v248, a218
    v_mul_f32 v248, v248, v245
    v_accvgpr_write_b32 a218, v248
    v_accvgpr_read_b32 v249, a219
    v_mul_f32 v249, v249, v245
    v_accvgpr_write_b32 a219, v249
    v_accvgpr_read_b32 v246, a232
    v_mul_f32 v246, v246, v245
    v_accvgpr_write_b32 a232, v246
    v_accvgpr_read_b32 v247, a233
    v_mul_f32 v247, v247, v245
    v_accvgpr_write_b32 a233, v247
    v_accvgpr_read_b32 v248, a234
    v_mul_f32 v248, v248, v245
    v_accvgpr_write_b32 a234, v248
    v_accvgpr_read_b32 v249, a235
    v_mul_f32 v249, v249, v245
    v_accvgpr_write_b32 a235, v249
    v_accvgpr_read_b32 v246, a248
    v_mul_f32 v246, v246, v245
    v_accvgpr_write_b32 a248, v246
    v_accvgpr_read_b32 v247, a249
    v_mul_f32 v247, v247, v245
    v_accvgpr_write_b32 a249, v247
    v_accvgpr_read_b32 v248, a250
    v_mul_f32 v248, v248, v245
    v_accvgpr_write_b32 a250, v248
    v_accvgpr_read_b32 v249, a251
    v_mul_f32 v249, v249, v245
    v_accvgpr_write_b32 a251, v249
    v_sub_f32 v246, v136, v244
    v_sub_f32 v247, v137, v244
    v_exp_f32 v246, v246
    v_exp_f32 v247, v247
    s_nop 0
    v_add_f32 v230, v230, v246
    v_add_f32 v230, v230, v247
    v_cvt_pk_bf16_f32 v168, v246, v247
    v_sub_f32 v246, v138, v244
    v_sub_f32 v247, v139, v244
    v_exp_f32 v246, v246
    v_exp_f32 v247, v247
    s_nop 0
    v_add_f32 v230, v230, v246
    v_add_f32 v230, v230, v247
    v_cvt_pk_bf16_f32 v169, v246, v247
    v_sub_f32 v246, v152, v244
    v_sub_f32 v247, v153, v244
    v_exp_f32 v246, v246
    v_exp_f32 v247, v247
    s_nop 0
    v_add_f32 v230, v230, v246
    v_add_f32 v230, v230, v247
    v_cvt_pk_bf16_f32 v170, v246, v247
    v_sub_f32 v246, v154, v244
    v_sub_f32 v247, v155, v244
    v_exp_f32 v246, v246
    v_exp_f32 v247, v247
    s_nop 0
    v_add_f32 v230, v230, v246
    v_add_f32 v230, v230, v247
    v_cvt_pk_bf16_f32 v171, v246, v247
    v_max3_f32 v244, v140, v141, v142
    v_max3_f32 v244, v244, v143, v156
    v_max3_f32 v244, v244, v157, v158
    v_max_f32 v244, v244, v159
    v_mov_b32 v245, v244
    s_nop 1
    v_permlane16_swap_b32 v244, v245
    s_nop 1
    v_max_f32 v244, v244, v245
    v_mov_b32 v245, v244
    s_nop 1
    v_permlane32_swap_b32 v244, v245
    s_nop 1
    v_max_f32 v244, v244, v245
    v_max_f32 v244, 0, v244
    v_sub_f32 v204, v204, v244
    v_sub_f32 v205, v205, v244
    v_sub_f32 v206, v206, v244
    v_sub_f32 v207, v207, v244
    v_sub_f32 v245, 0, v244
    v_exp_f32 v245, v245
    s_nop 0
    v_mul_f32 v231, v239, v245
    v_accvgpr_read_b32 v246, a12
    v_mul_f32 v246, v246, v245
    v_accvgpr_write_b32 a12, v246
    v_accvgpr_read_b32 v247, a13
    v_mul_f32 v247, v247, v245
    v_accvgpr_write_b32 a13, v247
    v_accvgpr_read_b32 v248, a14
    v_mul_f32 v248, v248, v245
    v_accvgpr_write_b32 a14, v248
    v_accvgpr_read_b32 v249, a15
    v_mul_f32 v249, v249, v245
    v_accvgpr_write_b32 a15, v249
    v_accvgpr_read_b32 v246, a28
    v_mul_f32 v246, v246, v245
    v_accvgpr_write_b32 a28, v246
    v_accvgpr_read_b32 v247, a29
    v_mul_f32 v247, v247, v245
    v_accvgpr_write_b32 a29, v247
    v_accvgpr_read_b32 v248, a30
    v_mul_f32 v248, v248, v245
    v_accvgpr_write_b32 a30, v248
    v_accvgpr_read_b32 v249, a31
    v_mul_f32 v249, v249, v245
    v_accvgpr_write_b32 a31, v249
    v_accvgpr_read_b32 v246, a44
    v_mul_f32 v246, v246, v245
    v_accvgpr_write_b32 a44, v246
    v_accvgpr_read_b32 v247, a45
    v_mul_f32 v247, v247, v245
    v_accvgpr_write_b32 a45, v247
    v_accvgpr_read_b32 v248, a46
    v_mul_f32 v248, v248, v245
    v_accvgpr_write_b32 a46, v248
    v_accvgpr_read_b32 v249, a47
    v_mul_f32 v249, v249, v245
    v_accvgpr_write_b32 a47, v249
    v_accvgpr_read_b32 v246, a60
    v_mul_f32 v246, v246, v245
    v_accvgpr_write_b32 a60, v246
    v_accvgpr_read_b32 v247, a61
    v_mul_f32 v247, v247, v245
    v_accvgpr_write_b32 a61, v247
    v_accvgpr_read_b32 v248, a62
    v_mul_f32 v248, v248, v245
    v_accvgpr_write_b32 a62, v248
    v_accvgpr_read_b32 v249, a63
    v_mul_f32 v249, v249, v245
    v_accvgpr_write_b32 a63, v249
    v_accvgpr_read_b32 v246, a76
    v_mul_f32 v246, v246, v245
    v_accvgpr_write_b32 a76, v246
    v_accvgpr_read_b32 v247, a77
    v_mul_f32 v247, v247, v245
    v_accvgpr_write_b32 a77, v247
    v_accvgpr_read_b32 v248, a78
    v_mul_f32 v248, v248, v245
    v_accvgpr_write_b32 a78, v248
    v_accvgpr_read_b32 v249, a79
    v_mul_f32 v249, v249, v245
    v_accvgpr_write_b32 a79, v249
    v_accvgpr_read_b32 v246, a92
    v_mul_f32 v246, v246, v245
    v_accvgpr_write_b32 a92, v246
    v_accvgpr_read_b32 v247, a93
    v_mul_f32 v247, v247, v245
    v_accvgpr_write_b32 a93, v247
    v_accvgpr_read_b32 v248, a94
    v_mul_f32 v248, v248, v245
    v_accvgpr_write_b32 a94, v248
    v_accvgpr_read_b32 v249, a95
    v_mul_f32 v249, v249, v245
    v_accvgpr_write_b32 a95, v249
    v_accvgpr_read_b32 v246, a108
    v_mul_f32 v246, v246, v245
    v_accvgpr_write_b32 a108, v246
    v_accvgpr_read_b32 v247, a109
    v_mul_f32 v247, v247, v245
    v_accvgpr_write_b32 a109, v247
    v_accvgpr_read_b32 v248, a110
    v_mul_f32 v248, v248, v245
    v_accvgpr_write_b32 a110, v248
    v_accvgpr_read_b32 v249, a111
    v_mul_f32 v249, v249, v245
    v_accvgpr_write_b32 a111, v249
    v_accvgpr_read_b32 v246, a124
    v_mul_f32 v246, v246, v245
    v_accvgpr_write_b32 a124, v246
    v_accvgpr_read_b32 v247, a125
    v_mul_f32 v247, v247, v245
    v_accvgpr_write_b32 a125, v247
    v_accvgpr_read_b32 v248, a126
    v_mul_f32 v248, v248, v245
    v_accvgpr_write_b32 a126, v248
    v_accvgpr_read_b32 v249, a127
    v_mul_f32 v249, v249, v245
    v_accvgpr_write_b32 a127, v249
    v_accvgpr_read_b32 v246, a140
    v_mul_f32 v246, v246, v245
    v_accvgpr_write_b32 a140, v246
    v_accvgpr_read_b32 v247, a141
    v_mul_f32 v247, v247, v245
    v_accvgpr_write_b32 a141, v247
    v_accvgpr_read_b32 v248, a142
    v_mul_f32 v248, v248, v245
    v_accvgpr_write_b32 a142, v248
    v_accvgpr_read_b32 v249, a143
    v_mul_f32 v249, v249, v245
    v_accvgpr_write_b32 a143, v249
    v_accvgpr_read_b32 v246, a156
    v_mul_f32 v246, v246, v245
    v_accvgpr_write_b32 a156, v246
    v_accvgpr_read_b32 v247, a157
    v_mul_f32 v247, v247, v245
    v_accvgpr_write_b32 a157, v247
    v_accvgpr_read_b32 v248, a158
    v_mul_f32 v248, v248, v245
    v_accvgpr_write_b32 a158, v248
    v_accvgpr_read_b32 v249, a159
    v_mul_f32 v249, v249, v245
    v_accvgpr_write_b32 a159, v249
    v_accvgpr_read_b32 v246, a172
    v_mul_f32 v246, v246, v245
    v_accvgpr_write_b32 a172, v246
    v_accvgpr_read_b32 v247, a173
    v_mul_f32 v247, v247, v245
    v_accvgpr_write_b32 a173, v247
    v_accvgpr_read_b32 v248, a174
    v_mul_f32 v248, v248, v245
    v_accvgpr_write_b32 a174, v248
    v_accvgpr_read_b32 v249, a175
    v_mul_f32 v249, v249, v245
    v_accvgpr_write_b32 a175, v249
    v_accvgpr_read_b32 v246, a188
    v_mul_f32 v246, v246, v245
    v_accvgpr_write_b32 a188, v246
    v_accvgpr_read_b32 v247, a189
    v_mul_f32 v247, v247, v245
    v_accvgpr_write_b32 a189, v247
    v_accvgpr_read_b32 v248, a190
    v_mul_f32 v248, v248, v245
    v_accvgpr_write_b32 a190, v248
    v_accvgpr_read_b32 v249, a191
    v_mul_f32 v249, v249, v245
    v_accvgpr_write_b32 a191, v249
    v_accvgpr_read_b32 v246, a204
    v_mul_f32 v246, v246, v245
    v_accvgpr_write_b32 a204, v246
    v_accvgpr_read_b32 v247, a205
    v_mul_f32 v247, v247, v245
    v_accvgpr_write_b32 a205, v247
    v_accvgpr_read_b32 v248, a206
    v_mul_f32 v248, v248, v245
    v_accvgpr_write_b32 a206, v248
    v_accvgpr_read_b32 v249, a207
    v_mul_f32 v249, v249, v245
    v_accvgpr_write_b32 a207, v249
    v_accvgpr_read_b32 v246, a220
    v_mul_f32 v246, v246, v245
    v_accvgpr_write_b32 a220, v246
    v_accvgpr_read_b32 v247, a221
    v_mul_f32 v247, v247, v245
    v_accvgpr_write_b32 a221, v247
    v_accvgpr_read_b32 v248, a222
    v_mul_f32 v248, v248, v245
    v_accvgpr_write_b32 a222, v248
    v_accvgpr_read_b32 v249, a223
    v_mul_f32 v249, v249, v245
    v_accvgpr_write_b32 a223, v249
    v_accvgpr_read_b32 v246, a236
    v_mul_f32 v246, v246, v245
    v_accvgpr_write_b32 a236, v246
    v_accvgpr_read_b32 v247, a237
    v_mul_f32 v247, v247, v245
    v_accvgpr_write_b32 a237, v247
    v_accvgpr_read_b32 v248, a238
    v_mul_f32 v248, v248, v245
    v_accvgpr_write_b32 a238, v248
    v_accvgpr_read_b32 v249, a239
    v_mul_f32 v249, v249, v245
    v_accvgpr_write_b32 a239, v249
    v_accvgpr_read_b32 v246, a252
    v_mul_f32 v246, v246, v245
    v_accvgpr_write_b32 a252, v246
    v_accvgpr_read_b32 v247, a253
    v_mul_f32 v247, v247, v245
    v_accvgpr_write_b32 a253, v247
    v_accvgpr_read_b32 v248, a254
    v_mul_f32 v248, v248, v245
    v_accvgpr_write_b32 a254, v248
    v_accvgpr_read_b32 v249, a255
    v_mul_f32 v249, v249, v245
    v_accvgpr_write_b32 a255, v249
    v_sub_f32 v246, v140, v244
    v_sub_f32 v247, v141, v244
    v_exp_f32 v246, v246
    v_exp_f32 v247, v247
    s_nop 0
    v_add_f32 v231, v231, v246
    v_add_f32 v231, v231, v247
    v_cvt_pk_bf16_f32 v172, v246, v247
    v_sub_f32 v246, v142, v244
    v_sub_f32 v247, v143, v244
    v_exp_f32 v246, v246
    v_exp_f32 v247, v247
    s_nop 0
    v_add_f32 v231, v231, v246
    v_add_f32 v231, v231, v247
    v_cvt_pk_bf16_f32 v173, v246, v247
    v_sub_f32 v246, v156, v244
    v_sub_f32 v247, v157, v244
    v_exp_f32 v246, v246
    v_exp_f32 v247, v247
    s_nop 0
    v_add_f32 v231, v231, v246
    v_add_f32 v231, v231, v247
    v_cvt_pk_bf16_f32 v174, v246, v247
    v_sub_f32 v246, v158, v244
    v_sub_f32 v247, v159, v244
    v_exp_f32 v246, v246
    v_exp_f32 v247, v247
    s_nop 0
    v_add_f32 v231, v231, v246
    v_add_f32 v231, v231, v247
    v_cvt_pk_bf16_f32 v175, v246, v247
    s_nop 3
    s_setpc_b64 s[30:31]
.section .rodata,"a"
.p2align 6
.amdhsa_kernel adaLN_cond__gqa_block_cached__moe_arch_mod__prompt_kernel
  .amdhsa_next_free_vgpr 512
  .amdhsa_next_free_sgpr 102
  .amdhsa_accum_offset 256
  .amdhsa_group_segment_fixed_size 0
  .amdhsa_kernarg_size 120
  .amdhsa_user_sgpr_count 2
  .amdhsa_user_sgpr_kernarg_segment_ptr 1
  .amdhsa_system_sgpr_workgroup_id_x 1
  .amdhsa_float_denorm_mode_32 3
.end_amdhsa_kernel
```
